```python
import torch

def _softmax(x, axis=-1):
    return torch.softmax(x, dim=axis)
def _gelu(x):
    return torch.nn.functional.gelu(x, approximate="tanh")
def _silu(x):
    return torch.nn.functional.silu(x)
def _sigmoid(x):
    return torch.sigmoid(x)
def _layernorm(x, axis=-1, eps=1e-5):
    m = x.mean(dim=axis, keepdim=True)
    v = x.var(dim=axis, keepdim=True, unbiased=False)
    return (x - m) / torch.sqrt(v + eps)
def _scatter_add(tgt, idx, src, axis=0):
    return tgt.clone().index_add_(axis, idx, src)
def _segment_sum(src, seg, n):
    out = torch.zeros((n,) + src.shape[1:], dtype=src.dtype)
    return out.index_add_(0, seg, src)
def _pad(x, pw):
    flat = tuple(v for pair in reversed(pw) for v in pair)
    return torch.nn.functional.pad(x, flat)

kernel_name = 'interleave_layers__linear_kernel_hedgehog__mixer_channel_mlp__prompt'

def setup_inputs():

    _w = (lambda a: (lambda t: t.to(torch.bfloat16) if t.is_floating_point() else t)(torch.as_tensor(a)))
    def _A_setup():
        B, S, D, H = 1, 2048, 512, 32
        Dh = D // H
        return {
            "x": _w((lambda *s: torch.randn(*s, dtype=torch.bfloat16) * 0.05)(B, S, D)),
            "wqkv": _w((lambda *s: torch.randn(*s, dtype=torch.bfloat16) * 0.4)(D, 3 * D)),
            "w_phi": _w((lambda *s: torch.randn(*s, dtype=torch.bfloat16) * 0.4)(H, Dh, Dh) * (Dh ** -0.5)),
            "wo": _w((lambda *s: torch.randn(*s, dtype=torch.bfloat16) * 0.05)(D, D)),
        }
    _A_in = _A_setup()

    def _B_setup():
        B, S, D, F = 1, 2048, 512, 1376
        return {
            "x": _w((lambda *s: torch.randn(*s, dtype=torch.bfloat16) * 0.05)(B, S, D)),
            "w1": _w((lambda *s: torch.randn(*s, dtype=torch.bfloat16) * 3.2)(D, F) * (D ** -0.5)),
            "b1": _w((lambda *s: torch.randn(*s, dtype=torch.bfloat16) * 0.8)(F)),
            "w2": _w((lambda *s: torch.randn(*s, dtype=torch.bfloat16) * 0.8)(F, D) * (F ** -0.5)),
            "b2": _w((lambda *s: torch.randn(*s, dtype=torch.bfloat16) * 0.8)(D)),
        }
    _B_in = _B_setup()

    return {
        "A_x": _A_in["x"],
        "A_wqkv": _A_in["wqkv"],
        "A_w_phi": _A_in["w_phi"],
        "A_wo": _A_in["wo"],
        "B_x": _B_in["x"],
        "B_w1": _B_in["w1"],
        "B_b1": _B_in["b1"],
        "B_w2": _B_in["w2"],
        "B_b2": _B_in["b2"],
    }

def reference(A_x, A_wqkv, A_w_phi, A_wo, B_x, B_w1, B_b1, B_w2, B_b2):
    def _A_ref(x, wqkv, w_phi, wo):
        B, S, D = x.shape
        H = 32; Dh = D // H
        qkv = (lambda x, *d: x.permute(*d))((x @ wqkv).reshape(B, S, 3, H, Dh), 2, 0, 3, 1, 4)
        q, k, v = qkv[0], qkv[1], qkv[2]
        pq = torch.einsum("bhsd,hdf->bhsf", q, w_phi)
        pk = torch.einsum("bhsd,hdf->bhsf", k, w_phi)
        phi_q = torch.concatenate([_softmax(pq, axis=-1), _softmax(-pq, axis=-1)], axis=-1)
        phi_k = torch.concatenate([_softmax(pk, axis=-1), _softmax(-pk, axis=-1)], axis=-1)
        kv = torch.einsum("bhsf,bhsd->bhfd", phi_k, v)
        z  = torch.einsum("bhsf->bhf", phi_k)
        num = torch.einsum("bhqf,bhfd->bhqd", phi_q, kv)
        den = torch.einsum("bhqf,bhf->bhq", phi_q, z)[..., None] + 1e-6
        o = num / den
        return (lambda x, *d: x.permute(*d))(o, 0, 2, 1, 3).reshape(B, S, D) @ wo

    def _B_ref(x, w1, b1, w2, b2):
        y = _layernorm(x, axis=-1)
        h = _gelu(torch.einsum("bsd,df->bsf", y, w1) + b1)
        return torch.einsum("bsf,fd->bsd", h, w2) + b2

    x = A_x
    x = x + _A_ref(_layernorm(x, axis=-1), A_wqkv, A_w_phi, A_wo)
    x = x + _B_ref(_layernorm(x, axis=-1), B_w1, B_b1, B_w2, B_b2)
    x = x + _A_ref(_layernorm(x, axis=-1), A_wqkv, A_w_phi, A_wo)
    x = x + _B_ref(_layernorm(x, axis=-1), B_w1, B_b1, B_w2, B_b2)
    return x
```

```asm
; @launch grid=(256,1,1) block=(256,1,1) lds=161792
.amdgcn_target "amdgcn-amd-amdhsa--gfx950"
.text
.globl interleave_layers__linear_kernel_hedgehog__mixer_channel_mlp__prompt_kernel
.p2align 8
.type interleave_layers__linear_kernel_hedgehog__mixer_channel_mlp__prompt_kernel,@function
interleave_layers__linear_kernel_hedgehog__mixer_channel_mlp__prompt_kernel:
    s_cmp_ge_u32 s2, 256
    s_cbranch_scc1 M_done
    s_load_dwordx16 s[48:63], s[0:1], 0
    s_load_dwordx8 s[64:71], s[0:1], 64
    s_getpc_b64 s[88:89]
    s_lshr_b32 s34, s2, 3
    s_and_b32 s32, s2, 7
    v_lshlrev_b32 v5, 5, v0
    v_add_lshl_u32 v5, v5, s34, 7
    v_min_u32 v5, M_done-interleave_layers__linear_kernel_hedgehog__mixer_channel_mlp__prompt_kernel-128, v5
    v_cmp_gt_u32 vcc, 16, v0
    s_lshl_b32 s35, s32, 5
    s_add_u32 s35, s35, s34
    s_lshl_b32 s35, s35, 13
    s_mul_i32 s36, s2, 6144
    s_and_saveexec_b64 s[74:75], vcc
    s_cbranch_execz L_nowarm
    global_load_dword v214, v5, s[88:89]
L_nowarm:
    s_mov_b64 exec, -1
    v_lshl_add_u32 v212, v0, 7, s35
    v_lshl_add_u32 v213, v0, 7, s36
    s_add_u32 s10, s35, 8192
    s_mov_b32 s11, 0x20000
    s_add_u32 s78, s36, 6144
    s_mov_b32 s79, 0x20000
    s_waitcnt lgkmcnt(0)
    s_mov_b64 s[76:77], s[50:51]
    s_mov_b64 s[8:9], s[48:49]
    buffer_load_dword v213, v213, s[76:79], 0 offen
    buffer_load_dword v212, v212, s[8:11], 0 offen
    s_mov_b64 s[4:5], s[70:71]
    v_lshrrev_b32 v6, 6, v0
    v_and_b32 v1, 63, v0
    v_readfirstlane_b32 s28, v6
    v_lshlrev_b32 v1, 4, v1
    s_and_b32 s29, s34, 7
    s_lshr_b32 s34, s34, 3
    s_lshl_b32 s30, s32, 2
    s_add_u32 s30, s30, s34
    s_lshl_b32 s33, s28, 8
    s_add_u32 s33, s33, s2
    s_mov_b32 s83, 0x20000
    s_lshl_b32 s31, s29, 2
    s_add_u32 s31, s31, s28
    s_sub_u32 s92, s31, s29
    s_cmp_lt_u32 s28, 3
    s_cselect_b32 s92, s92, 31
    v_lshrrev_b32 v232, 8, v1
    v_lshlrev_b32 v232, 7, v232
    v_bfe_u32 v6, v1, 4, 2
    v_lshl_add_u32 v232, v6, 3, v232
    s_lshl_b32 s34, s31, 9
    v_add_u32 v232, s34, v232
    s_lshl_b32 s34, s31, 5
    v_lshrrev_b32 v6, 8, v1
    v_lshl_add_u32 v218, v6, 3, s34
    s_lshl_b32 s34, s92, 5
    v_lshl_add_u32 v219, v6, 3, s34
    s_lshl_b32 s34, s29, 1
    s_and_b32 s35, s28, 1
    s_add_u32 s34, s34, s35
    s_lshl_b32 s34, s34, 6
    v_lshl_add_u32 v215, v6, 4, s34
    s_mov_b32 s18, 16384
    s_mov_b32 s19, 0x20000
    s_mov_b32 s22, 2752
    s_mov_b32 s23, 0x20000
    s_mov_b32 s26, 1024
    s_mov_b32 s27, 0x20000
    s_mov_b64 s[16:17], s[52:53]
    s_mov_b64 s[20:21], s[60:61]
    s_mov_b64 s[24:25], s[64:65]
    buffer_load_dwordx2 v[224:225], v232, s[16:19], 0 offen
    buffer_load_dwordx2 v[226:227], v232, s[16:19], 0 offen offset:32
    buffer_load_dwordx2 v[228:229], v232, s[16:19], 0 offen offset:64
    buffer_load_dwordx2 v[230:231], v232, s[16:19], 0 offen offset:96
    buffer_load_dwordx2 v[246:247], v218, s[20:23], 0 offen
    buffer_load_dwordx2 v[250:251], v218, s[20:23], 0 offen offset:1024
    buffer_load_dwordx2 v[254:255], v219, s[20:23], 0 offen offset:2048
    buffer_load_dwordx4 v[240:243], v215, s[24:27], 0 offen
    s_load_dword s45, s[4:5], 0
    s_cmp_lt_u32 s33, 480
    s_cselect_b32 s35, 352, 0
    s_cselect_b32 s36, 0, 480
    s_add_u32 s35, s35, s36
    s_sub_u32 s99, s33, s35
    s_cmp_lt_u32 s33, 480
    s_cselect_b32 s35, 16, 43
    s_mov_b32 s36, 2039808
    s_cselect_b32 s36, 1515520, s36
    s_lshl_b32 s82, s35, 15
    s_and_b32 s100, s99, 7
    s_lshr_b32 s101, s99, 3
    s_mul_i32 s35, s35, s100
    s_add_u32 s35, s35, s101
    s_lshl_b32 s35, s35, 12
    s_add_u32 s36, s36, s35
    s_cmp_lt_u32 s33, 824
    s_cselect_b32 s36, s36, 1879048192
    s_cselect_b32 s82, s82, 0
    s_cselect_b32 s101, s101, 0
    s_lshr_b32 s99, s33, 4
    s_and_b32 s34, s33, 15
    s_lshl_b32 s35, s99, 6
    s_add_u32 s35, s35, s34
    s_lshl_b32 s35, s35, 10
    s_add_u32 s35, s35, 73728
    s_cmp_lt_u32 s33, 352
    s_cselect_b32 s82, 1409024, s82
    s_cselect_b32 s100, s99, s100
    s_cselect_b32 s101, s34, s101
    s_cselect_b32 s36, s35, s36
    s_movk_i32 s34, 1024
    s_cselect_b32 s87, 16384, s34
    s_cselect_b32 s34, 2752, s34
    s_cselect_b32 s99, 3, 4
    s_cselect_b32 s35, 32, 8
    v_add_u32 v211, s36, v1
    v_bfe_u32 v209, v1, 4, 2
    v_lshlrev_b32 v209, s99, v209
    v_bfe_u32 v210, v1, 6, 2
    v_lshl_add_u32 v209, v210, 7, v209
    v_lshrrev_b32 v210, 8, v1
    v_lshl_add_u32 v209, v210, 10, v209
    s_lshl_b32 s99, s28, 12
    s_add_u32 s99, s99, 131072
    v_add_u32 v209, s99, v209
    v_add_u32 v210, s35, v209
    s_lshl_b32 s101, s101, 5
    v_lshrrev_b32 v208, 7, v1
    v_add_u32 v208, s101, v208
    v_mul_u32_u24 v208, s34, v208
    v_and_b32 v6, 0x70, v1
    s_lshl_b32 s100, s100, 7
    v_add3_u32 v208, v208, v6, s100
    s_lshl_b32 s100, s34, 3
    s_cmp_lt_u32 s33, 480
    s_cselect_b64 s[80:81], s[54:55], s[62:63]
    s_cmp_lt_u32 s33, 352
    s_cselect_b64 s[80:81], s[58:59], s[80:81]
    s_add_u32 m0, s99, 0
    s_nop 0
    buffer_load_dwordx4 v208, s[80:83], 0 offen lds
    s_add_u32 m0, s99, 1024
    v_add_u32 v208, s100, v208
    buffer_load_dwordx4 v208, s[80:83], 0 offen lds
    s_add_u32 m0, s99, 2048
    v_add_u32 v208, s100, v208
    buffer_load_dwordx4 v208, s[80:83], 0 offen lds
    s_add_u32 m0, s99, 3072
    v_add_u32 v208, s100, v208
    buffer_load_dwordx4 v208, s[80:83], 0 offen lds
    v_lshrrev_b32 v217, 3, s2
    v_and_b32 v216, 15, v0
    v_lshl_add_u32 v216, v216, 5, v217
    v_mul_u32_u24 v216, 3072, v216
    v_lshrrev_b32 v217, 4, v0
    v_lshl_add_u32 v216, v217, 10, v216
    v_add_u32 v217, 1, v217
    v_lshrrev_b32 v217, 2, v217
    v_lshl_add_u32 v216, v217, 22, v216
    s_mov_b32 s78, 1572864
    s_mov_b64 s[12:13], s[66:67]
    s_getreg_b32 s3, hwreg(HW_REG_XCC_ID, 0, 3)
    s_lshl_b32 s44, s30, 16
    s_lshl_b32 s47, s28, 10
    s_lshl_b32 s63, s28, 14
    s_mov_b32 s10, 2097152
    s_mov_b32 s78, 1572864
    v_lshrrev_b32 v5, 8, v1
    v_lshrrev_b32 v6, 1, v5
    v_xor_b32 v143, v5, v6
    v_and_b32 v143, 1, v143
    v_lshl_or_b32 v143, v143, 1, v6
    v_lshlrev_b32 v143, 4, v143
    v_and_b32 v6, 48, v1
    v_xor_b32 v143, v143, v6
    v_lshrrev_b32 v6, 6, v1
    v_lshl_add_u32 v143, v6, 10, v143
    s_add_u32 s34, s63, s44
    v_add_u32 v143, s34, v143
    v_and_b32 v5, 1, v5
    s_and_b32 s34, s28, 1
    s_lshl_b32 s34, s34, 1
    v_or_b32 v5, s34, v5
    v_lshlrev_b32 v5, 5, v5
    v_and_b32 v6, 0x70, v1
    v_xor_b32 v5, v5, v6
    v_lshrrev_b32 v6, 7, v1
    s_lshl_b32 s34, s28, 3
    v_add_u32 v6, s34, v6
    v_mul_u32_u24 v6, 3072, v6
    s_lshl_b32 s34, s29, 7
    v_add3_u32 v142, v6, v5, s34
    s_add_u32 m0, s63, 0
    s_nop 0
    buffer_load_dwordx4 v143, s[8:11], 0 offen lds
    s_add_u32 m0, s63, 960
    s_nop 0
    buffer_load_dwordx4 v143, s[8:11], 0 offen offset:64 lds
    s_mov_b32 s6, 36085760
    s_mov_b32 s7, 0x20000
    s_mov_b32 s14, 2097152
    s_mov_b32 s15, 0x20000
    v_bfe_u32 v3, v1, 4, 5
    s_lshl_b32 s34, s30, 7
    s_add_u32 s34, s34, 69632
    v_lshl_add_u32 v3, v3, 2, s34
    v_mov_b32 v222, v3
    s_lshl_b32 s34, s33, 6
    s_add_u32 s34, s34, 4096
    v_writelane_b32 v222, s34, 8
    buffer_load_dword v222, v222, s[4:7], 0 offen sc1
    v_mov_b32 v234, -1
    v_mov_b32 v235, -1
    v_mov_b32 v236, -1
    v_mov_b32 v237, -1
    s_lshl_b32 s34, s31, 5
    s_add_u32 s34, s34, s30
    s_lshl_b32 s34, s34, 10
    s_add_u32 s34, s34, 33071104
    v_add_u32 v239, s34, v1
    s_lshl_b32 s34, s33, 10
    s_add_u32 s34, s34, 34775040
    s_cmp_ge_u32 s33, 384
    s_cselect_b32 s34, s34, 1879048192
    v_add_u32 v238, s34, v1
    v_lshrrev_b32 v223, 8, v1
    v_lshlrev_b32 v223, 4, v223
    s_add_u32 s34, s47, 148480
    v_add_u32 v223, s34, v223
    s_cmp_lt_u32 s33, 480
    s_cselect_b32 s34, 128, 0
    s_add_u32 s34, s34, s33
    s_sub_u32 s34, s34, 480
    s_and_b32 s35, s34, 7
    s_lshr_b32 s34, s34, 3
    s_lshl_b32 s35, s35, 1
    s_sub_u32 s35, s34, s35
    s_and_b32 s35, s35, 15
    s_lshr_b32 s36, s34, 4
    s_mul_i32 s37, s36, 14
    s_add_u32 s37, s37, s35
    s_add_u32 s37, s37, 2
    s_cmp_lt_u32 s34, 32
    s_cselect_b32 s37, s37, s34
    s_cselect_b32 s38, s35, 2
    s_sub_u32 s37, s37, 4
    s_lshl_b32 s36, s36, 1
    s_add_u32 s36, s36, s35
    s_mul_i32 s36, s36, 11
    s_mul_i32 s91, s37, 26
    s_lshr_b32 s91, s91, 8
    s_add_u32 s37, s37, s91
    s_add_u32 s37, s37, 1
    s_cmp_lt_u32 s38, 2
    s_cselect_b32 s37, s36, s37
    s_cmp_lt_u32 s33, 480
    s_cselect_b32 s37, s35, s37
    s_sub_u32 s37, s37, s34
    s_lshl_b32 s37, s37, 12
    s_sub_u32 s34, s33, 352
    s_cmp_lt_u32 s34, 472
    s_cselect_b32 s37, s37, 0
    v_add_u32 v211, s37, v211
    s_mov_b32 s41, 0xffff0000
    s_mov_b32 s64, 0x000f000f
    s_mov_b32 s65, 0x000f000f
    s_mov_b32 s66, 0x00f000f0
    s_mov_b32 s67, 0x00f000f0
    s_mov_b32 s68, 0x0f000f00
    s_mov_b32 s69, 0x0f000f00
    s_mov_b32 s70, 0xf000f000
    s_mov_b32 s71, 0xf000f000
    s_mov_b32 s84, 0x05040100
    s_mov_b32 s85, 0x07060302
    s_mov_b32 s48, 4096
    s_mov_b32 s49, 8192
    s_mov_b32 s50, 12288
    s_mov_b32 s51, 16384
    s_mov_b32 s52, 20480
    s_mov_b32 s53, 24576
    s_mov_b32 s54, 28672
    s_mov_b32 s55, 32768
    s_mov_b32 s56, 36864
    s_mov_b32 s57, 40960
    s_mov_b32 s58, 45056
    s_mov_b32 s40, 0x3f803f80
    s_movk_i32 s34, 9
    s_cmp_lt_u32 s28, 3
    s_addc_u32 s34, s34, 0
    s_lshl_b32 s39, s34, 10
    s_mov_b32 s74, 0xbdd2d3e8
    s_mov_b32 s75, 0xc0135761
    s_lshl_b64 s[72:73], 1, s31
    s_lshl_b32 s34, s31, 14
    s_lshl_b32 s98, s29, 3
    s_add_u32 s98, s98, s28
    s_lshl_b32 s98, s98, 13
    s_add_u32 s98, s98, 1515520
    s_add_u32 s93, s34, 73728
    s_add_u32 s94, s34, 598016
    s_lshl_b32 s34, s92, 14
    s_add_u32 s95, s34, 1122304
    s_cmp_lt_u32 s92, 22
    s_cselect_b32 s95, s95, 1879048192
    s_mul_i32 s34, s29, 43
    s_mul_i32 s35, s28, 11
    s_add_u32 s34, s34, s35
    s_lshl_b32 s34, s34, 12
    s_add_u32 s96, s34, 2039808
    s_andn2_b32 s34, 1, s28
    s_lshl_b32 s34, s34, 11
    s_add_u32 s96, s96, s34
    s_cmp_lt_u32 s28, 3
    s_cselect_b32 s97, s96, 1879048192
    s_mul_i32 s86, s30, 176128
    v_bfe_u32 v5, v1, 7, 2
    v_xor_b32 v5, s28, v5
    v_lshlrev_b32 v5, 5, v5
    v_bfe_u32 v6, v1, 6, 2
    v_lshl_add_u32 v5, v6, 7, v5
    v_lshrrev_b32 v6, 8, v1
    v_lshl_add_u32 v5, v6, 10, v5
    v_bfe_u32 v6, v1, 4, 2
    v_lshl_add_u32 v5, v6, 3, v5
    v_add_u32 v0, 65536, v5
    v_lshrrev_b32 v5, 8, v1
    v_and_b32 v6, 1, v5
    v_lshrrev_b32 v7, 1, v5
    v_and_b32 v2, 0xf0, v1
    v_mul_u32_u24 v6, 44032, v6
    v_lshl_add_u32 v2, v7, 8, v2
    v_add_u32 v2, v6, v2
    v_bfe_u32 v6, v1, 6, 2
    v_lshrrev_b32 v7, 1, v6
    v_xor_b32 v6, v6, v7
    v_and_b32 v6, 1, v6
    v_lshl_or_b32 v6, v6, 1, v7
    v_xor_b32 v6, v6, v5
    s_add_u32 m0, s63, 1920
    s_nop 0
    buffer_load_dwordx4 v143, s[8:11], 0 offen offset:128 lds
    s_add_u32 m0, s63, 2880
    s_nop 0
    buffer_load_dwordx4 v143, s[8:11], 0 offen offset:192 lds
    s_add_u32 m0, s63, 3840
    s_nop 0
    buffer_load_dwordx4 v143, s[8:11], 0 offen offset:256 lds
    s_add_u32 m0, s63, 4800
    s_nop 0
    buffer_load_dwordx4 v143, s[8:11], 0 offen offset:320 lds
    s_waitcnt vmcnt(14)
    v_lshlrev_b32 v244, 16, v246
    v_and_b32 v245, s41, v246
    v_lshlrev_b32 v246, 16, v247
    v_and_b32 v247, s41, v247
    s_waitcnt vmcnt(13)
    v_lshlrev_b32 v248, 16, v250
    v_and_b32 v249, s41, v250
    v_lshlrev_b32 v250, 16, v251
    v_and_b32 v251, s41, v251
    s_waitcnt vmcnt(12)
    v_lshlrev_b32 v252, 16, v254
    v_and_b32 v253, s41, v254
    v_lshlrev_b32 v254, 16, v255
    v_and_b32 v255, s41, v255
    v_perm_b32 v16, v226, v224, s84
    v_perm_b32 v17, v230, v228, s84
    v_perm_b32 v18, v226, v224, s85
    v_perm_b32 v19, v230, v228, s85
    v_perm_b32 v20, v227, v225, s84
    v_perm_b32 v21, v231, v229, s84
    v_perm_b32 v22, v227, v225, s85
    v_perm_b32 v23, v231, v229, s85
    v_cndmask_b32 v104, 0, v16, s[64:65]
    v_cndmask_b32 v105, 0, v17, s[64:65]
    v_cndmask_b32 v106, 0, v16, s[66:67]
    v_cndmask_b32 v107, 0, v17, s[66:67]
    v_accvgpr_write_b32 a0, v104
    v_accvgpr_write_b32 a1, v105
    v_accvgpr_write_b32 a2, v106
    v_accvgpr_write_b32 a3, v107
    v_cndmask_b32 v104, 0, v16, s[68:69]
    v_cndmask_b32 v105, 0, v17, s[68:69]
    v_cndmask_b32 v106, 0, v16, s[70:71]
    v_cndmask_b32 v107, 0, v17, s[70:71]
    v_accvgpr_write_b32 a4, v104
    v_accvgpr_write_b32 a5, v105
    v_accvgpr_write_b32 a6, v106
    v_accvgpr_write_b32 a7, v107
    v_cndmask_b32 v104, 0, v18, s[64:65]
    v_cndmask_b32 v105, 0, v19, s[64:65]
    v_cndmask_b32 v106, 0, v18, s[66:67]
    v_cndmask_b32 v107, 0, v19, s[66:67]
    v_accvgpr_write_b32 a8, v104
    v_accvgpr_write_b32 a9, v105
    v_accvgpr_write_b32 a10, v106
    v_accvgpr_write_b32 a11, v107
    v_cndmask_b32 v104, 0, v18, s[68:69]
    v_cndmask_b32 v105, 0, v19, s[68:69]
    v_cndmask_b32 v106, 0, v18, s[70:71]
    v_cndmask_b32 v107, 0, v19, s[70:71]
    v_accvgpr_write_b32 a12, v104
    v_accvgpr_write_b32 a13, v105
    v_accvgpr_write_b32 a14, v106
    v_accvgpr_write_b32 a15, v107
    v_cndmask_b32 v104, 0, v20, s[64:65]
    v_cndmask_b32 v105, 0, v21, s[64:65]
    v_cndmask_b32 v106, 0, v20, s[66:67]
    v_cndmask_b32 v107, 0, v21, s[66:67]
    v_accvgpr_write_b32 a16, v104
    v_accvgpr_write_b32 a17, v105
    v_accvgpr_write_b32 a18, v106
    v_accvgpr_write_b32 a19, v107
    v_cndmask_b32 v104, 0, v20, s[68:69]
    v_cndmask_b32 v105, 0, v21, s[68:69]
    v_cndmask_b32 v106, 0, v20, s[70:71]
    v_cndmask_b32 v107, 0, v21, s[70:71]
    v_accvgpr_write_b32 a20, v104
    v_accvgpr_write_b32 a21, v105
    v_accvgpr_write_b32 a22, v106
    v_accvgpr_write_b32 a23, v107
    v_cndmask_b32 v104, 0, v22, s[64:65]
    v_cndmask_b32 v105, 0, v23, s[64:65]
    v_cndmask_b32 v106, 0, v22, s[66:67]
    v_cndmask_b32 v107, 0, v23, s[66:67]
    v_accvgpr_write_b32 a24, v104
    v_accvgpr_write_b32 a25, v105
    v_accvgpr_write_b32 a26, v106
    v_accvgpr_write_b32 a27, v107
    v_cndmask_b32 v104, 0, v22, s[68:69]
    v_cndmask_b32 v105, 0, v23, s[68:69]
    v_cndmask_b32 v106, 0, v22, s[70:71]
    v_cndmask_b32 v107, 0, v23, s[70:71]
    v_accvgpr_write_b32 a28, v104
    v_accvgpr_write_b32 a29, v105
    v_accvgpr_write_b32 a30, v106
    v_accvgpr_write_b32 a31, v107
    s_mov_b32 exec_lo, 0x00010001
    s_mov_b32 exec_hi, 0x00010001
    ds_write_b128 v223, v[244:247] offset:384
    ds_write_b128 v223, v[248:251] offset:448
    ds_write_b128 v223, v[252:255] offset:512
    s_waitcnt vmcnt(11)
    ds_write_b128 v223, v[240:243] offset:576
    s_mov_b64 exec, -1
    s_add_u32 m0, s63, 5760
    s_nop 0
    buffer_load_dwordx4 v143, s[8:11], 0 offen offset:384 lds
    s_add_u32 m0, s63, 6720
    s_nop 0
    buffer_load_dwordx4 v143, s[8:11], 0 offen offset:448 lds
    buffer_load_dword v213, v216, s[76:79], 0 offen offset:384
    s_waitcnt lgkmcnt(0)
    s_lshr_b32 s45, s45, 4
    s_mul_i32 s45, s45, 1664525
    s_add_u32 s45, s45, 1013904223
    s_lshl_b32 s45, s45, 4
    s_waitcnt vmcnt(10)
    ds_read_b64_tr_b16 v[192:193], v209 offset:0
    ds_read_b64_tr_b16 v[194:195], v209 offset:512
    ds_read_b64_tr_b16 v[196:197], v210 offset:0
    ds_read_b64_tr_b16 v[198:199], v210 offset:512
    ds_read_b64_tr_b16 v[200:201], v209 offset:64
    ds_read_b64_tr_b16 v[202:203], v209 offset:576
    ds_read_b64_tr_b16 v[204:205], v210 offset:64
    ds_read_b64_tr_b16 v[206:207], v210 offset:576
    s_add_u32 m0, s63, 7680
    s_nop 0
    buffer_load_dwordx4 v143, s[8:11], 0 offen offset:512 lds
    v_lshlrev_b32 v6, 4, v6
    v_and_b32 v7, 0xf0, v1
    v_lshl_add_u32 v97, v7, 2, v6
    s_lshr_b32 s34, s2, 3
    s_lshl_b32 s90, s28, 5
    s_add_u32 m0, s63, 8640
    s_nop 0
    buffer_load_dwordx4 v143, s[8:11], 0 offen offset:576 lds
    s_add_u32 s90, s90, s34
    s_lshl_b32 s90, s90, 7
    s_lshl_b32 s34, s32, 13
    s_add_u32 s34, s34, 4096
    s_cmp_eq_u32 s28, 0
    s_cselect_b32 s34, s34, 1879048192
    s_add_u32 m0, s63, 9600
    s_nop 0
    buffer_load_dwordx4 v143, s[8:11], 0 offen offset:640 lds
    v_lshl_add_u32 v7, v1, 3, s34
    s_lshl_b32 s19, s31, 15
    s_add_u32 s19, s19, 33071104
    s_lshl_b32 s16, s30, 10
    s_add_u32 m0, s63, 10560
    s_nop 0
    buffer_load_dwordx4 v143, s[8:11], 0 offen offset:704 lds
    s_add_u32 s16, s16, s19
    s_lshl_b32 s20, s30, 5
    s_add_u32 s19, s19, s20
    s_lshl_b32 s21, s31, 10
    s_add_u32 s21, s21, 35299328
    s_waitcnt lgkmcnt(6)
    buffer_store_dwordx4 v[192:195], v211, s[4:7], 0 offen sc1
    s_add_u32 s20, s20, s21
    s_and_b32 s17, s32, 7
    s_lshl_b32 s17, s17, 15
    s_add_u32 s21, s21, s17
    s_lshl_b32 s17, s31, 11
    s_add_u32 m0, s63, 11520
    s_nop 0
    buffer_load_dwordx4 v143, s[8:11], 0 offen offset:768 lds
    s_add_u32 s17, s17, 35168256
    s_lshl_b32 s18, s32, 8
    s_add_u32 s18, s18, s17
    s_and_b32 s22, s30, 3
    s_lshl_b32 s22, s22, 4
    s_add_u32 m0, s63, 12480
    s_nop 0
    buffer_load_dwordx4 v143, s[8:11], 0 offen offset:832 lds
    s_add_u32 s18, s18, s22
    s_lshl_b32 s22, s31, 9
    s_add_u32 s22, s22, s86
    s_add_u32 s22, s22, 21798912
    s_add_u32 s23, s22, 88064
    s_add_u32 m0, s63, 13440
    s_nop 0
    buffer_load_dwordx4 v143, s[8:11], 0 offen offset:896 lds
    v_add_u32 v220, 65536, v0
    v_bfe_u32 v5, v1, 6, 2
    v_mul_u32_u24 v5, 44032, v5
    v_bfe_u32 v6, v1, 4, 2
    v_lshl_add_u32 v5, v6, 7, v5
    s_add_u32 m0, s63, 14400
    s_nop 0
    buffer_load_dwordx4 v143, s[8:11], 0 offen offset:960 lds
    s_lshl_b32 s34, s31, 9
    s_add_u32 s34, s34, s86
    s_add_u32 s34, s34, 21798912
    s_lshl_b32 s35, s29, 11
    s_add_u32 s35, s35, s63
    s_add_u32 m0, s47, 65536
    s_mov_b32 s38, 1024
    buffer_load_dwordx4 v142, s[76:79], s38 offen lds
    s_add_u32 s35, s35, s44
    s_add_u32 s35, s35, 3446784
    s_lshl_b32 s36, s30, 13
    s_lshl_b32 s37, s31, 8
    s_add_u32 s36, s36, s37
    s_add_u32 m0, s47, 69632
    s_mov_b32 s38, 99328
    buffer_load_dwordx4 v142, s[76:79], s38 offen lds
    s_add_u32 s36, s36, 9736192
    v_mov_b32 v233, 1879048192
    s_mov_b64 exec, 0xffff
    v_add_u32 v233, s34, v5
    s_mov_b32 exec_lo, 0xffff0000
    v_lshl_add_u32 v233, v1, 3, s35
    s_mov_b32 exec_lo, 0
    s_mov_b32 exec_hi, 3
    v_lshl_add_u32 v233, v1, 3, s36
    s_mov_b64 exec, -1
    s_add_u32 m0, s47, 73728
    s_mov_b32 s38, 2048
    buffer_load_dwordx4 v142, s[76:79], s38 offen lds
    v_mov_b32 v24, s40
    s_add_u32 m0, s47, 77824
    s_mov_b32 s38, 100352
    buffer_load_dwordx4 v142, s[76:79], s38 offen lds
    v_mov_b32 v25, s40
    v_mov_b32 v26, s40
    v_mov_b32 v27, s40
    s_waitcnt lgkmcnt(0)
    s_barrier
    v_add_u32 v124, s63, v97
    s_waitcnt vmcnt(14)
    ds_read_b128 v[60:63], v124 offset:0
    ds_read_b128 v[64:67], v124 offset:1024
    ds_read_b128 v[68:71], v124 offset:2048
    ds_read_b128 v[72:75], v124 offset:3072
    s_waitcnt lgkmcnt(3)
    v_mfma_f32_16x16x32_bf16 v[104:107], v[60:63], v[60:63], 0
    ds_read_b128 v[76:79], v124 offset:4096
    v_add_u32 v211, s87, v211
    v_bfe_u32 v5, v1, 4, 2
    v_cmp_eq_u32 s[24:25], 1, v5
    v_cmp_eq_u32 s[36:37], 2, v5
    s_waitcnt lgkmcnt(3)
    v_mfma_f32_16x16x32_bf16 v[104:107], v[64:67], v[64:67], v[104:107]
    buffer_store_dwordx4 v[196:199], v211, s[4:7], 0 offen sc1
    v_mfma_f32_16x16x32_bf16 v[108:111], v[24:27], v[60:63], 0
    ds_read_b128 v[88:91], v124 offset:5120
    s_add_u32 m0, s47, 81920
    s_mov_b32 s38, 197632
    v_cmp_eq_u32 s[26:27], 3, v5
    v_bfe_u32 v114, v1, 4, 4
    v_mfma_f32_16x16x32_bf16 v[108:111], v[24:27], v[64:67], v[108:111]
    s_waitcnt lgkmcnt(2)
    buffer_load_dwordx4 v142, s[76:79], s38 offen lds
    v_lshrrev_b32 v115, 8, s47
    v_mfma_f32_16x16x32_bf16 v[104:107], v[68:71], v[68:71], v[104:107]
    ds_read_b128 v[60:63], v124 offset:6144
    s_add_u32 m0, s47, 86016
    s_mov_b32 s38, 295936
    v_lshl_add_u32 v113, v114, 4, v115
    v_lshlrev_b32 v115, 4, v115
    v_mfma_f32_16x16x32_bf16 v[104:107], v[72:75], v[72:75], v[104:107]
    v_lshl_add_u32 v114, v114, 2, v115
    v_add_u32 v113, 147456, v113
    v_add_u32 v114, 147968, v114
    v_mfma_f32_16x16x32_bf16 v[108:111], v[24:27], v[68:71], v[108:111]
    ds_read_b128 v[64:67], v124 offset:7168
    buffer_load_dwordx4 v142, s[76:79], s38 offen lds
    v_mfma_f32_16x16x32_bf16 v[108:111], v[24:27], v[72:75], v[108:111]
    s_waitcnt lgkmcnt(2)
    s_add_u32 m0, s47, 90112
    s_mov_b32 s38, 198656
    v_mfma_f32_16x16x32_bf16 v[104:107], v[76:79], v[76:79], v[104:107]
    s_waitcnt vmcnt(7)
    ds_read_b128 v[68:71], v124 offset:8192
    v_mfma_f32_16x16x32_bf16 v[104:107], v[88:91], v[88:91], v[104:107]
    buffer_load_dwordx4 v142, s[76:79], s38 offen lds
    v_mfma_f32_16x16x32_bf16 v[108:111], v[24:27], v[76:79], v[108:111]
    ds_read_b128 v[72:75], v124 offset:9216
    s_add_u32 m0, s47, 94208
    s_mov_b32 s38, 296960
    v_mfma_f32_16x16x32_bf16 v[108:111], v[24:27], v[88:91], v[108:111]
    s_waitcnt lgkmcnt(2)
    v_mfma_f32_16x16x32_bf16 v[104:107], v[60:63], v[60:63], v[104:107]
    ds_read_b128 v[76:79], v124 offset:10240
    buffer_load_dwordx4 v142, s[76:79], s38 offen lds
    v_mfma_f32_16x16x32_bf16 v[104:107], v[64:67], v[64:67], v[104:107]
    v_add_u32 v211, s87, v211
    v_mfma_f32_16x16x32_bf16 v[108:111], v[24:27], v[60:63], v[108:111]
    ds_read_b128 v[88:91], v124 offset:11264
    v_mfma_f32_16x16x32_bf16 v[108:111], v[24:27], v[64:67], v[108:111]
    s_waitcnt lgkmcnt(2)
    v_mfma_f32_16x16x32_bf16 v[104:107], v[68:71], v[68:71], v[104:107]
    ds_read_b128 v[60:63], v124 offset:12288
    v_mfma_f32_16x16x32_bf16 v[104:107], v[72:75], v[72:75], v[104:107]
    buffer_store_dwordx4 v[200:203], v211, s[4:7], 0 offen sc1
    v_mfma_f32_16x16x32_bf16 v[108:111], v[24:27], v[68:71], v[108:111]
    ds_read_b128 v[64:67], v124 offset:13312
    s_add_u32 m0, s47, 131072
    s_mov_b32 s38, 394240
    v_mfma_f32_16x16x32_bf16 v[108:111], v[24:27], v[72:75], v[108:111]
    s_waitcnt lgkmcnt(2)
    buffer_load_dwordx4 v142, s[76:79], s38 offen lds
    s_add_u32 m0, s47, 135168
    v_mfma_f32_16x16x32_bf16 v[104:107], v[76:79], v[76:79], v[104:107]
    ds_read_b128 v[68:71], v124 offset:14336
    s_mov_b32 s38, 492544
    v_mfma_f32_16x16x32_bf16 v[104:107], v[88:91], v[88:91], v[104:107]
    buffer_load_dwordx4 v142, s[76:79], s38 offen lds
    v_mfma_f32_16x16x32_bf16 v[108:111], v[24:27], v[76:79], v[108:111]
    ds_read_b128 v[72:75], v124 offset:15360
    s_add_u32 m0, s47, 139264
    s_mov_b32 s38, 395264
    v_mfma_f32_16x16x32_bf16 v[108:111], v[24:27], v[88:91], v[108:111]
    s_waitcnt lgkmcnt(2)
    v_mfma_f32_16x16x32_bf16 v[104:107], v[60:63], v[60:63], v[104:107]
    buffer_load_dwordx4 v142, s[76:79], s38 offen lds
    v_mfma_f32_16x16x32_bf16 v[104:107], v[64:67], v[64:67], v[104:107]
    s_add_u32 m0, s47, 143360
    s_mov_b32 s38, 493568
    v_mfma_f32_16x16x32_bf16 v[108:111], v[24:27], v[60:63], v[108:111]
    v_mfma_f32_16x16x32_bf16 v[108:111], v[24:27], v[64:67], v[108:111]
    s_waitcnt lgkmcnt(0)
    buffer_load_dwordx4 v142, s[76:79], s38 offen lds
    v_mfma_f32_16x16x32_bf16 v[104:107], v[68:71], v[68:71], v[104:107]
    v_add_u32 v211, s87, v211
    v_mfma_f32_16x16x32_bf16 v[104:107], v[72:75], v[72:75], v[104:107]
    v_mfma_f32_16x16x32_bf16 v[108:111], v[24:27], v[68:71], v[108:111]
    buffer_store_dwordx4 v[204:207], v211, s[4:7], 0 offen sc1
    v_mfma_f32_16x16x32_bf16 v[108:111], v[24:27], v[72:75], v[108:111]
    s_add_u32 m0, s47, 98304
    s_mov_b32 s38, 590848
    buffer_load_dwordx4 v142, s[76:79], s38 offen lds
    v_and_b32 v98, 0xf0, v1
    v_add_u32 v98, 147456, v98
    v_lshrrev_b32 v100, 8, v1
    v_lshl_add_u32 v99, v100, 2, v98
    v_lshlrev_b32 v100, 4, v100
    s_add_u32 m0, s47, 102400
    s_mov_b32 s38, 689152
    buffer_load_dwordx4 v142, s[76:79], s38 offen lds
    v_add_u32 v100, 147968, v100
    v_cndmask_b32 v104, v104, v105, s[24:25]
    v_cndmask_b32 v104, v104, v106, s[36:37]
    v_cndmask_b32 v104, v104, v107, s[26:27]
    s_add_u32 m0, s47, 106496
    s_mov_b32 s38, 591872
    buffer_load_dwordx4 v142, s[76:79], s38 offen lds
    v_mul_f32 v108, 0xbb000000, v108
    v_mul_f32 v104, 0x3b000000, v104
    v_fma_f32 v104, -v108, v108, v104
    v_max_f32 v104, 0, v104
    v_add_f32 v112, 0x3727c5ac, v104
    s_add_u32 m0, s47, 110592
    s_mov_b32 s38, 690176
    buffer_load_dwordx4 v142, s[76:79], s38 offen lds
    v_rsq_f32 v112, v112
    v_bfe_u32 v137, v1, 5, 2
    v_lshlrev_b32 v137, 4, v137
    s_mov_b32 exec_lo, 0x00f0000f
    s_mov_b32 exec_hi, 0xf0000f00
    ds_write_b32 v113, v108
    ds_write_b32 v113, v112 offset:256
    ds_write_b32 v114, v108
    ds_write_b32 v114, v112 offset:256
    s_mov_b64 exec, -1
    v_lshl_add_u32 v136, v1, 2, v137
    v_lshrrev_b32 v140, 6, v1
    v_bfe_u32 v137, v1, 7, 2
    v_bfe_u32 v138, v1, 5, 1
    v_xor_b32 v137, v137, v138
    v_lshlrev_b32 v137, 4, v137
    v_lshl_add_u32 v140, v140, 6, v137
    v_bfe_u32 v138, v1, 4, 1
    v_lshl_add_u32 v140, v138, 3, v140
    v_mov_b32 v141, 131072
    v_lshl_add_u32 v141, s47, 2, v141
    v_add_u32 v136, v141, v136
    v_add_u32 v140, v141, v140
    v_xor_b32 v137, 16, v136
    v_xor_b32 v138, 32, v136
    v_xor_b32 v139, 48, v136
    v_xor_b32 v141, 32, v140
    s_waitcnt vmcnt(15) lgkmcnt(0)
    s_barrier
    ds_read_b64_tr_b16 a[176:177], v0 offset:0
    ds_read_b64_tr_b16 a[178:179], v0 offset:512
    ds_read_b64_tr_b16 a[180:181], v0 offset:4096
    ds_read_b64_tr_b16 a[182:183], v0 offset:4608
    ds_read_b64_tr_b16 v[144:145], v0 offset:8192
    ds_read_b64_tr_b16 v[146:147], v0 offset:8704
    ds_read_b64_tr_b16 v[148:149], v0 offset:12288
    ds_read_b64_tr_b16 v[150:151], v0 offset:12800
    ds_read_b128 v[60:63], v97 offset:0
    ds_read_b128 v[64:67], v97 offset:1024
    ds_read_b128 v[68:71], v97 offset:16384
    ds_read_b128 v[72:75], v97 offset:17408
    ds_read_b128 v[92:95], v98
    ds_read_b32 v96, v99 offset:256
    ds_read_b128 v[120:123], v100 offset:0
    ds_read_b128 v[104:107], v100 offset:256
    ds_read_b128 v[124:127], v100 offset:64
    s_waitcnt lgkmcnt(8)
    v_mfma_f32_16x16x32_bf16 v[28:31], a[176:179], v[60:63], 0
    ds_read_b128 v[76:79], v97 offset:32768
    s_waitcnt lgkmcnt(8)
    v_mfma_f32_16x16x32_bf16 v[28:31], a[180:183], v[64:67], v[28:31]
    buffer_store_dwordx4 v[234:237], v239, s[4:7], 0 offen sc1
    v_mfma_f32_16x16x32_bf16 v[44:47], v[60:63], v[144:147], 0
    ds_read_b128 v[88:91], v97 offset:33792
    s_add_u32 m0, s47, 114688
    s_mov_b32 s38, 787456
    v_mfma_f32_16x16x32_bf16 v[44:47], v[64:67], v[148:151], v[44:47]
    s_waitcnt lgkmcnt(7)
    v_mfma_f32_16x16x32_bf16 v[32:35], a[176:179], v[68:71], 0
    ds_read_b128 v[60:63], v97 offset:49152
    v_mfma_f32_16x16x32_bf16 v[32:35], a[180:183], v[72:75], v[32:35]
    buffer_load_dwordx4 v142, s[76:79], s38 offen lds
    v_mfma_f32_16x16x32_bf16 v[48:51], v[68:71], v[144:147], 0
    ds_read_b128 v[64:67], v97 offset:50176
    s_add_u32 m0, s47, 118784
    s_mov_b32 s38, 885760
    v_mfma_f32_16x16x32_bf16 v[48:51], v[72:75], v[148:151], v[48:51]
    s_waitcnt lgkmcnt(2)
    v_mfma_f32_16x16x32_bf16 v[36:39], a[176:179], v[76:79], 0
    s_waitcnt vmcnt(12)
    s_barrier
    ds_read_b64_tr_b16 a[184:185], v0 offset:16384
    ds_read_b128 v[68:71], v97 offset:2048
    v_mfma_f32_16x16x32_bf16 v[36:39], a[180:183], v[88:91], v[36:39]
    ds_read_b64_tr_b16 a[186:187], v0 offset:16896
    buffer_load_dwordx4 v142, s[76:79], s38 offen lds
    v_mfma_f32_16x16x32_bf16 v[52:55], v[76:79], v[144:147], 0
    ds_read_b128 v[72:75], v97 offset:3072
    ds_read_b64_tr_b16 a[188:189], v0 offset:20480
    s_add_u32 m0, s47, 122880
    v_mfma_f32_16x16x32_bf16 v[52:55], v[88:91], v[148:151], v[52:55]
    s_waitcnt lgkmcnt(5)
    ds_read_b64_tr_b16 a[190:191], v0 offset:20992
    s_mov_b32 s38, 788480
    v_mfma_f32_16x16x32_bf16 v[40:43], a[176:179], v[60:63], 0
    ds_read_b128 v[76:79], v97 offset:18432
    ds_read_b64_tr_b16 v[152:153], v0 offset:24576
    v_mfma_f32_16x16x32_bf16 v[40:43], a[180:183], v[64:67], v[40:43]
    ds_read_b64_tr_b16 v[154:155], v0 offset:25088
    buffer_load_dwordx4 v142, s[76:79], s38 offen lds
    v_mfma_f32_16x16x32_bf16 v[56:59], v[60:63], v[144:147], 0
    ds_read_b64_tr_b16 v[156:157], v0 offset:28672
    s_add_u32 m0, s47, 126976
    s_mov_b32 s38, 886784
    v_mfma_f32_16x16x32_bf16 v[56:59], v[64:67], v[148:151], v[56:59]
    ds_read_b64_tr_b16 v[158:159], v0 offset:29184
    v_mfma_f32_16x16x32_bf16 v[80:83], a[176:179], v[24:27], 0
    ds_read_b128 v[88:91], v97 offset:19456
    buffer_load_dwordx4 v142, s[76:79], s38 offen lds
    v_mfma_f32_16x16x32_bf16 v[80:83], a[180:183], v[24:27], v[80:83]
    buffer_store_dwordx4 v[234:237], v238, s[4:7], 0 offen sc1
    v_mfma_f32_16x16x32_bf16 v[84:87], v[24:27], v[144:147], 0
    s_add_u32 m0, s47, 65536
    s_mov_b32 s38, 984064
    v_mfma_f32_16x16x32_bf16 v[84:87], v[24:27], v[148:151], v[84:87]
    s_waitcnt lgkmcnt(8)
    v_mfma_f32_16x16x32_bf16 v[28:31], a[184:187], v[68:71], v[28:31]
    ds_read_b128 v[60:63], v97 offset:34816
    buffer_load_dwordx4 v142, s[76:79], s38 offen lds
    s_waitcnt lgkmcnt(7)
    v_mfma_f32_16x16x32_bf16 v[28:31], a[188:191], v[72:75], v[28:31]
    s_add_u32 m0, s47, 69632
    s_mov_b32 s38, 1082368
    s_waitcnt lgkmcnt(4)
    v_mfma_f32_16x16x32_bf16 v[44:47], v[68:71], v[152:155], v[44:47]
    ds_read_b128 v[64:67], v97 offset:35840
    buffer_load_dwordx4 v142, s[76:79], s38 offen lds
    s_waitcnt lgkmcnt(3)
    v_mfma_f32_16x16x32_bf16 v[44:47], v[72:75], v[156:159], v[44:47]
    s_waitcnt lgkmcnt(2)
    s_add_u32 m0, s47, 73728
    s_mov_b32 s38, 985088
    v_mfma_f32_16x16x32_bf16 v[32:35], a[184:187], v[76:79], v[32:35]
    ds_read_b128 v[68:71], v97 offset:51200
    v_mfma_f32_16x16x32_bf16 v[32:35], a[188:191], v[88:91], v[32:35]
    buffer_load_dwordx4 v142, s[76:79], s38 offen lds
    v_mfma_f32_16x16x32_bf16 v[48:51], v[76:79], v[152:155], v[48:51]
    ds_read_b128 v[72:75], v97 offset:52224
    s_add_u32 m0, s47, 77824
    s_mov_b32 s38, 1083392
    v_mfma_f32_16x16x32_bf16 v[48:51], v[88:91], v[156:159], v[48:51]
    s_waitcnt lgkmcnt(2)
    v_mfma_f32_16x16x32_bf16 v[36:39], a[184:187], v[60:63], v[36:39]
    s_waitcnt vmcnt(14)
    s_barrier
    ds_read_b64_tr_b16 a[192:193], v220 offset:0
    ds_read_b128 v[76:79], v97 offset:4096
    v_mfma_f32_16x16x32_bf16 v[36:39], a[188:191], v[64:67], v[36:39]
    ds_read_b64_tr_b16 a[194:195], v220 offset:512
    buffer_load_dwordx4 v142, s[76:79], s38 offen lds
    v_mfma_f32_16x16x32_bf16 v[52:55], v[60:63], v[152:155], v[52:55]
    ds_read_b128 v[88:91], v97 offset:5120
    ds_read_b64_tr_b16 a[196:197], v220 offset:4096
    s_add_u32 m0, s47, 81920
    v_mfma_f32_16x16x32_bf16 v[52:55], v[64:67], v[156:159], v[52:55]
    s_waitcnt lgkmcnt(5)
    ds_read_b64_tr_b16 a[198:199], v220 offset:4608
    s_mov_b32 s38, 1180672
    v_mfma_f32_16x16x32_bf16 v[40:43], a[184:187], v[68:71], v[40:43]
    ds_read_b128 v[60:63], v97 offset:20480
    ds_read_b64_tr_b16 v[160:161], v220 offset:8192
    v_mfma_f32_16x16x32_bf16 v[40:43], a[188:191], v[72:75], v[40:43]
    ds_read_b64_tr_b16 v[162:163], v220 offset:8704
    buffer_load_dwordx4 v142, s[76:79], s38 offen lds
    v_mfma_f32_16x16x32_bf16 v[56:59], v[68:71], v[152:155], v[56:59]
    ds_read_b64_tr_b16 v[164:165], v220 offset:12288
    s_add_u32 m0, s47, 86016
    s_mov_b32 s38, 1278976
    v_mfma_f32_16x16x32_bf16 v[56:59], v[72:75], v[156:159], v[56:59]
    ds_read_b64_tr_b16 v[166:167], v220 offset:12800
    v_mfma_f32_16x16x32_bf16 v[80:83], a[184:187], v[24:27], v[80:83]
    ds_read_b128 v[64:67], v97 offset:21504
    buffer_load_dwordx4 v142, s[76:79], s38 offen lds
    v_mfma_f32_16x16x32_bf16 v[80:83], a[188:191], v[24:27], v[80:83]
    s_add_u32 m0, s47, 90112
    s_mov_b32 s38, 1181696
    v_mfma_f32_16x16x32_bf16 v[84:87], v[24:27], v[152:155], v[84:87]
    buffer_load_dwordx4 v142, s[76:79], s38 offen lds
    v_mfma_f32_16x16x32_bf16 v[84:87], v[24:27], v[156:159], v[84:87]
    s_waitcnt lgkmcnt(8)
    s_add_u32 m0, s47, 94208
    s_mov_b32 s38, 1280000
    v_mfma_f32_16x16x32_bf16 v[28:31], a[192:195], v[76:79], v[28:31]
    ds_read_b128 v[68:71], v97 offset:36864
    s_waitcnt lgkmcnt(7)
    v_mfma_f32_16x16x32_bf16 v[28:31], a[196:199], v[88:91], v[28:31]
    buffer_load_dwordx4 v142, s[76:79], s38 offen lds
    s_waitcnt lgkmcnt(4)
    v_mfma_f32_16x16x32_bf16 v[44:47], v[76:79], v[160:163], v[44:47]
    ds_read_b128 v[72:75], v97 offset:37888
    s_waitcnt lgkmcnt(3)
    v_mfma_f32_16x16x32_bf16 v[44:47], v[88:91], v[164:167], v[44:47]
    s_waitcnt lgkmcnt(2)
    v_mfma_f32_16x16x32_bf16 v[32:35], a[192:195], v[60:63], v[32:35]
    ds_read_b128 v[76:79], v97 offset:53248
    v_mfma_f32_16x16x32_bf16 v[32:35], a[196:199], v[64:67], v[32:35]
    v_mfma_f32_16x16x32_bf16 v[48:51], v[60:63], v[160:163], v[48:51]
    ds_read_b128 v[88:91], v97 offset:54272
    v_mfma_f32_16x16x32_bf16 v[48:51], v[64:67], v[164:167], v[48:51]
    s_waitcnt lgkmcnt(2)
    v_mfma_f32_16x16x32_bf16 v[36:39], a[192:195], v[68:71], v[36:39]
    s_waitcnt vmcnt(8)
    s_barrier
    s_cmp_lg_u32 s28, 0
    s_cbranch_scc1 L1
    s_lshl_b32 s34, s30, 8
    s_lshr_b32 s35, s29, 2
    s_mul_i32 s35, s35, 112
    s_add_u32 s34, s34, s35
    s_lshl_b32 s35, s29, 2
    s_add_u32 s34, s34, s35
    s_add_u32 s34, s34, 4096
    s_or_b32 s35, s45, s3
    v_mov_b32 v6, s35
    v_lshlrev_b32 v215, 9, v1
    s_mov_b64 exec, 0xff
    buffer_store_dword v6, v215, s[4:7], s34 offen sc1
    s_mov_b64 exec, -1
L1:
    ds_read_b64_tr_b16 a[200:201], v0 offset:32768
    ds_read_b128 v[60:63], v97 offset:6144
    v_mfma_f32_16x16x32_bf16 v[36:39], a[196:199], v[72:75], v[36:39]
    ds_read_b64_tr_b16 a[202:203], v0 offset:33280
    v_mfma_f32_16x16x32_bf16 v[52:55], v[68:71], v[160:163], v[52:55]
    ds_read_b128 v[64:67], v97 offset:7168
    ds_read_b64_tr_b16 a[204:205], v0 offset:36864
    s_add_u32 m0, s47, 131072
    v_mfma_f32_16x16x32_bf16 v[52:55], v[72:75], v[164:167], v[52:55]
    s_waitcnt lgkmcnt(5)
    ds_read_b64_tr_b16 a[206:207], v0 offset:37376
    s_mov_b32 s38, 1377280
    v_mfma_f32_16x16x32_bf16 v[40:43], a[192:195], v[76:79], v[40:43]
    ds_read_b128 v[68:71], v97 offset:22528
    ds_read_b64_tr_b16 v[168:169], v0 offset:40960
    v_mfma_f32_16x16x32_bf16 v[40:43], a[196:199], v[88:91], v[40:43]
    ds_read_b64_tr_b16 v[170:171], v0 offset:41472
    buffer_load_dwordx4 v142, s[76:79], s38 offen lds
    v_mfma_f32_16x16x32_bf16 v[56:59], v[76:79], v[160:163], v[56:59]
    ds_read_b64_tr_b16 v[172:173], v0 offset:45056
    s_add_u32 m0, s47, 135168
    s_mov_b32 s38, 1475584
    v_mfma_f32_16x16x32_bf16 v[56:59], v[88:91], v[164:167], v[56:59]
    ds_read_b64_tr_b16 v[174:175], v0 offset:45568
    v_mfma_f32_16x16x32_bf16 v[80:83], a[192:195], v[24:27], v[80:83]
    ds_read_b128 v[72:75], v97 offset:23552
    buffer_load_dwordx4 v142, s[76:79], s38 offen lds
    v_mfma_f32_16x16x32_bf16 v[80:83], a[196:199], v[24:27], v[80:83]
    s_add_u32 m0, s47, 139264
    s_mov_b32 s38, 1378304
    v_mfma_f32_16x16x32_bf16 v[84:87], v[24:27], v[160:163], v[84:87]
    buffer_load_dwordx4 v142, s[76:79], s38 offen lds
    v_mfma_f32_16x16x32_bf16 v[84:87], v[24:27], v[164:167], v[84:87]
    s_waitcnt lgkmcnt(8)
    s_add_u32 m0, s47, 143360
    s_mov_b32 s38, 1476608
    v_mfma_f32_16x16x32_bf16 v[28:31], a[200:203], v[60:63], v[28:31]
    ds_read_b128 v[76:79], v97 offset:38912
    s_waitcnt lgkmcnt(7)
    v_mfma_f32_16x16x32_bf16 v[28:31], a[204:207], v[64:67], v[28:31]
    buffer_load_dwordx4 v142, s[76:79], s38 offen lds
    s_waitcnt lgkmcnt(4)
    v_mfma_f32_16x16x32_bf16 v[44:47], v[60:63], v[168:171], v[44:47]
    ds_read_b128 v[88:91], v97 offset:39936
    s_waitcnt lgkmcnt(3)
    v_mfma_f32_16x16x32_bf16 v[44:47], v[64:67], v[172:175], v[44:47]
    s_waitcnt lgkmcnt(2)
    v_mfma_f32_16x16x32_bf16 v[32:35], a[200:203], v[68:71], v[32:35]
    ds_read_b128 v[60:63], v97 offset:55296
    v_mfma_f32_16x16x32_bf16 v[32:35], a[204:207], v[72:75], v[32:35]
    v_mfma_f32_16x16x32_bf16 v[48:51], v[68:71], v[168:171], v[48:51]
    ds_read_b128 v[64:67], v97 offset:56320
    v_mfma_f32_16x16x32_bf16 v[48:51], v[72:75], v[172:175], v[48:51]
    s_waitcnt lgkmcnt(2)
    v_mfma_f32_16x16x32_bf16 v[36:39], a[200:203], v[76:79], v[36:39]
    s_barrier
    ds_read_b64_tr_b16 a[208:209], v0 offset:49152
    ds_read_b128 v[68:71], v97 offset:8192
    v_mfma_f32_16x16x32_bf16 v[36:39], a[204:207], v[88:91], v[36:39]
    ds_read_b64_tr_b16 a[210:211], v0 offset:49664
    v_mfma_f32_16x16x32_bf16 v[52:55], v[76:79], v[168:171], v[52:55]
    ds_read_b128 v[72:75], v97 offset:9216
    ds_read_b64_tr_b16 a[212:213], v0 offset:53248
    s_add_u32 m0, s47, 98304
    v_mfma_f32_16x16x32_bf16 v[52:55], v[88:91], v[172:175], v[52:55]
    s_waitcnt lgkmcnt(5)
    ds_read_b64_tr_b16 a[214:215], v0 offset:53760
    s_mov_b32 s38, 786432
    v_mfma_f32_16x16x32_bf16 v[40:43], a[200:203], v[60:63], v[40:43]
    ds_read_b128 v[76:79], v97 offset:24576
    ds_read_b64_tr_b16 v[176:177], v0 offset:57344
    v_mfma_f32_16x16x32_bf16 v[40:43], a[204:207], v[64:67], v[40:43]
    ds_read_b64_tr_b16 v[178:179], v0 offset:57856
    buffer_load_dwordx4 v142, s[76:79], s38 offen lds
    v_mfma_f32_16x16x32_bf16 v[56:59], v[60:63], v[168:171], v[56:59]
    ds_read_b64_tr_b16 v[180:181], v0 offset:61440
    s_add_u32 m0, s47, 102400
    s_mov_b32 s38, 884736
    v_mfma_f32_16x16x32_bf16 v[56:59], v[64:67], v[172:175], v[56:59]
    ds_read_b64_tr_b16 v[182:183], v0 offset:61952
    v_mfma_f32_16x16x32_bf16 v[80:83], a[200:203], v[24:27], v[80:83]
    ds_read_b128 v[88:91], v97 offset:25600
    buffer_load_dwordx4 v142, s[76:79], s38 offen lds
    v_mfma_f32_16x16x32_bf16 v[80:83], a[204:207], v[24:27], v[80:83]
    s_add_u32 m0, s47, 106496
    s_mov_b32 s38, 983040
    v_mfma_f32_16x16x32_bf16 v[84:87], v[24:27], v[168:171], v[84:87]
    buffer_load_dwordx4 v142, s[76:79], s38 offen lds
    v_mfma_f32_16x16x32_bf16 v[84:87], v[24:27], v[172:175], v[84:87]
    s_waitcnt lgkmcnt(8)
    s_add_u32 m0, s47, 110592
    s_mov_b32 s38, 1081344
    v_mfma_f32_16x16x32_bf16 v[28:31], a[208:211], v[68:71], v[28:31]
    ds_read_b128 v[60:63], v97 offset:40960
    s_waitcnt lgkmcnt(7)
    v_mfma_f32_16x16x32_bf16 v[28:31], a[212:215], v[72:75], v[28:31]
    buffer_load_dwordx4 v142, s[76:79], s38 offen lds
    s_waitcnt lgkmcnt(4)
    v_mfma_f32_16x16x32_bf16 v[44:47], v[68:71], v[176:179], v[44:47]
    ds_read_b128 v[64:67], v97 offset:41984
    s_waitcnt lgkmcnt(3)
    v_mfma_f32_16x16x32_bf16 v[44:47], v[72:75], v[180:183], v[44:47]
    s_waitcnt lgkmcnt(2)
    v_mfma_f32_16x16x32_bf16 v[32:35], a[208:211], v[76:79], v[32:35]
    ds_read_b128 v[68:71], v97 offset:57344
    v_mfma_f32_16x16x32_bf16 v[32:35], a[212:215], v[88:91], v[32:35]
    v_mfma_f32_16x16x32_bf16 v[48:51], v[76:79], v[176:179], v[48:51]
    ds_read_b128 v[72:75], v97 offset:58368
    v_mfma_f32_16x16x32_bf16 v[48:51], v[88:91], v[180:183], v[48:51]
    s_waitcnt lgkmcnt(2)
    v_mfma_f32_16x16x32_bf16 v[36:39], a[208:211], v[60:63], v[36:39]
    s_waitcnt vmcnt(12)
    s_barrier
    ds_read_b64_tr_b16 a[216:217], v0 offset:0
    ds_read_b128 v[76:79], v97 offset:10240
    v_mfma_f32_16x16x32_bf16 v[36:39], a[212:215], v[64:67], v[36:39]
    ds_read_b64_tr_b16 a[218:219], v0 offset:512
    v_mfma_f32_16x16x32_bf16 v[52:55], v[60:63], v[176:179], v[52:55]
    ds_read_b128 v[88:91], v97 offset:11264
    ds_read_b64_tr_b16 a[220:221], v0 offset:4096
    s_add_u32 m0, s47, 114688
    v_mfma_f32_16x16x32_bf16 v[52:55], v[64:67], v[180:183], v[52:55]
    s_waitcnt lgkmcnt(5)
    ds_read_b64_tr_b16 a[222:223], v0 offset:4608
    s_mov_b32 s38, 1179648
    v_mfma_f32_16x16x32_bf16 v[40:43], a[208:211], v[68:71], v[40:43]
    ds_read_b128 v[60:63], v97 offset:26624
    ds_read_b64_tr_b16 v[184:185], v0 offset:8192
    v_mfma_f32_16x16x32_bf16 v[40:43], a[212:215], v[72:75], v[40:43]
    ds_read_b64_tr_b16 v[186:187], v0 offset:8704
    buffer_load_dwordx4 v142, s[76:79], s38 offen lds
    v_mfma_f32_16x16x32_bf16 v[56:59], v[68:71], v[176:179], v[56:59]
    ds_read_b64_tr_b16 v[188:189], v0 offset:12288
    s_add_u32 m0, s47, 118784
    s_mov_b32 s38, 1277952
    v_mfma_f32_16x16x32_bf16 v[56:59], v[72:75], v[180:183], v[56:59]
    ds_read_b64_tr_b16 v[190:191], v0 offset:12800
    v_mfma_f32_16x16x32_bf16 v[80:83], a[208:211], v[24:27], v[80:83]
    ds_read_b128 v[64:67], v97 offset:27648
    buffer_load_dwordx4 v142, s[76:79], s38 offen lds
    v_mfma_f32_16x16x32_bf16 v[80:83], a[212:215], v[24:27], v[80:83]
    s_add_u32 m0, s47, 122880
    s_mov_b32 s38, 1376256
    v_mfma_f32_16x16x32_bf16 v[84:87], v[24:27], v[176:179], v[84:87]
    buffer_load_dwordx4 v142, s[76:79], s38 offen lds
    v_mfma_f32_16x16x32_bf16 v[84:87], v[24:27], v[180:183], v[84:87]
    s_waitcnt lgkmcnt(8)
    s_add_u32 m0, s47, 126976
    s_mov_b32 s38, 1474560
    v_mfma_f32_16x16x32_bf16 v[28:31], a[216:219], v[76:79], v[28:31]
    ds_read_b128 v[68:71], v97 offset:43008
    s_waitcnt lgkmcnt(7)
    v_mfma_f32_16x16x32_bf16 v[28:31], a[220:223], v[88:91], v[28:31]
    buffer_load_dwordx4 v142, s[76:79], s38 offen lds
    s_waitcnt lgkmcnt(4)
    v_mfma_f32_16x16x32_bf16 v[44:47], v[76:79], v[184:187], v[44:47]
    ds_read_b128 v[72:75], v97 offset:44032
    s_waitcnt lgkmcnt(3)
    v_mfma_f32_16x16x32_bf16 v[44:47], v[88:91], v[188:191], v[44:47]
    s_waitcnt lgkmcnt(2)
    v_mfma_f32_16x16x32_bf16 v[32:35], a[216:219], v[60:63], v[32:35]
    ds_read_b128 v[76:79], v97 offset:59392
    v_mfma_f32_16x16x32_bf16 v[32:35], a[220:223], v[64:67], v[32:35]
    v_mfma_f32_16x16x32_bf16 v[48:51], v[60:63], v[184:187], v[48:51]
    ds_read_b128 v[88:91], v97 offset:60416
    v_mfma_f32_16x16x32_bf16 v[48:51], v[64:67], v[188:191], v[48:51]
    s_waitcnt lgkmcnt(2)
    v_mfma_f32_16x16x32_bf16 v[36:39], a[216:219], v[68:71], v[36:39]
    s_waitcnt vmcnt(12)
    s_barrier
    ds_read_b64_tr_b16 a[224:225], v0 offset:16384
    ds_read_b128 v[60:63], v97 offset:12288
    v_mfma_f32_16x16x32_bf16 v[36:39], a[220:223], v[72:75], v[36:39]
    ds_read_b64_tr_b16 a[226:227], v0 offset:16896
    v_mfma_f32_16x16x32_bf16 v[52:55], v[68:71], v[184:187], v[52:55]
    ds_read_b128 v[64:67], v97 offset:13312
    ds_read_b64_tr_b16 a[228:229], v0 offset:20480
    s_add_u32 m0, s47, 65536
    v_mfma_f32_16x16x32_bf16 v[52:55], v[72:75], v[188:191], v[52:55]
    s_waitcnt lgkmcnt(5)
    ds_read_b64_tr_b16 a[230:231], v0 offset:20992
    s_mov_b32 s38, 0
    v_mfma_f32_16x16x32_bf16 v[40:43], a[216:219], v[76:79], v[40:43]
    ds_read_b128 v[68:71], v97 offset:28672
    ds_read_b64_tr_b16 a[240:241], v0 offset:24576
    v_mfma_f32_16x16x32_bf16 v[40:43], a[220:223], v[88:91], v[40:43]
    ds_read_b64_tr_b16 a[242:243], v0 offset:25088
    buffer_load_dwordx4 v142, s[76:79], s38 offen lds
    v_mfma_f32_16x16x32_bf16 v[56:59], v[76:79], v[184:187], v[56:59]
    ds_read_b64_tr_b16 a[244:245], v0 offset:28672
    s_add_u32 m0, s47, 69632
    s_mov_b32 s38, 98304
    v_mfma_f32_16x16x32_bf16 v[56:59], v[88:91], v[188:191], v[56:59]
    ds_read_b64_tr_b16 a[246:247], v0 offset:29184
    v_mfma_f32_16x16x32_bf16 v[80:83], a[216:219], v[24:27], v[80:83]
    ds_read_b128 v[72:75], v97 offset:29696
    buffer_load_dwordx4 v142, s[76:79], s38 offen lds
    v_mfma_f32_16x16x32_bf16 v[80:83], a[220:223], v[24:27], v[80:83]
    s_add_u32 m0, s47, 73728
    s_mov_b32 s38, 196608
    v_mfma_f32_16x16x32_bf16 v[84:87], v[24:27], v[184:187], v[84:87]
    buffer_load_dwordx4 v142, s[76:79], s38 offen lds
    v_mfma_f32_16x16x32_bf16 v[84:87], v[24:27], v[188:191], v[84:87]
    s_waitcnt lgkmcnt(8)
    s_add_u32 m0, s47, 77824
    s_mov_b32 s38, 294912
    v_mfma_f32_16x16x32_bf16 v[28:31], a[224:227], v[60:63], v[28:31]
    ds_read_b128 v[76:79], v97 offset:45056
    s_waitcnt lgkmcnt(7)
    v_mfma_f32_16x16x32_bf16 v[28:31], a[228:231], v[64:67], v[28:31]
    buffer_load_dwordx4 v142, s[76:79], s38 offen lds
    s_waitcnt lgkmcnt(4)
    v_mfma_f32_16x16x32_bf16 v[44:47], v[60:63], a[240:243], v[44:47]
    ds_read_b128 v[88:91], v97 offset:46080
    s_waitcnt lgkmcnt(3)
    v_mfma_f32_16x16x32_bf16 v[44:47], v[64:67], a[244:247], v[44:47]
    s_waitcnt lgkmcnt(2)
    v_mfma_f32_16x16x32_bf16 v[32:35], a[224:227], v[68:71], v[32:35]
    ds_read_b128 v[60:63], v97 offset:61440
    v_mfma_f32_16x16x32_bf16 v[32:35], a[228:231], v[72:75], v[32:35]
    v_mfma_f32_16x16x32_bf16 v[48:51], v[68:71], a[240:243], v[48:51]
    ds_read_b128 v[64:67], v97 offset:62464
    v_mfma_f32_16x16x32_bf16 v[48:51], v[72:75], a[244:247], v[48:51]
    s_waitcnt lgkmcnt(2)
    v_mfma_f32_16x16x32_bf16 v[36:39], a[224:227], v[76:79], v[36:39]
    s_waitcnt vmcnt(12)
    s_barrier
    ds_read_b64_tr_b16 a[232:233], v220 offset:0
    ds_read_b128 v[68:71], v97 offset:14336
    v_mfma_f32_16x16x32_bf16 v[36:39], a[228:231], v[88:91], v[36:39]
    ds_read_b64_tr_b16 a[234:235], v220 offset:512
    v_mfma_f32_16x16x32_bf16 v[52:55], v[76:79], a[240:243], v[52:55]
    ds_read_b128 v[72:75], v97 offset:15360
    ds_read_b64_tr_b16 a[236:237], v220 offset:4096
    s_add_u32 m0, s47, 81920
    v_mfma_f32_16x16x32_bf16 v[52:55], v[88:91], a[244:247], v[52:55]
    s_waitcnt lgkmcnt(5)
    ds_read_b64_tr_b16 a[238:239], v220 offset:4608
    s_mov_b32 s38, 393216
    v_mfma_f32_16x16x32_bf16 v[40:43], a[224:227], v[60:63], v[40:43]
    ds_read_b128 v[76:79], v97 offset:30720
    ds_read_b64_tr_b16 a[248:249], v220 offset:8192
    v_mfma_f32_16x16x32_bf16 v[40:43], a[228:231], v[64:67], v[40:43]
    ds_read_b64_tr_b16 a[250:251], v220 offset:8704
    buffer_load_dwordx4 v142, s[76:79], s38 offen lds
    v_mfma_f32_16x16x32_bf16 v[56:59], v[60:63], a[240:243], v[56:59]
    ds_read_b64_tr_b16 a[252:253], v220 offset:12288
    s_add_u32 m0, s47, 86016
    s_mov_b32 s38, 491520
    v_mfma_f32_16x16x32_bf16 v[56:59], v[64:67], a[244:247], v[56:59]
    ds_read_b64_tr_b16 a[254:255], v220 offset:12800
    v_mfma_f32_16x16x32_bf16 v[80:83], a[224:227], v[24:27], v[80:83]
    ds_read_b128 v[88:91], v97 offset:31744
    buffer_load_dwordx4 v142, s[76:79], s38 offen lds
    v_mfma_f32_16x16x32_bf16 v[80:83], a[228:231], v[24:27], v[80:83]
    s_add_u32 m0, s47, 90112
    s_mov_b32 s38, 589824
    v_mfma_f32_16x16x32_bf16 v[84:87], v[24:27], a[240:243], v[84:87]
    buffer_load_dwordx4 v142, s[76:79], s38 offen lds
    v_mfma_f32_16x16x32_bf16 v[84:87], v[24:27], a[244:247], v[84:87]
    s_waitcnt lgkmcnt(8)
    s_add_u32 m0, s47, 94208
    s_mov_b32 s38, 688128
    v_mfma_f32_16x16x32_bf16 v[28:31], a[232:235], v[68:71], v[28:31]
    ds_read_b128 v[60:63], v97 offset:47104
    s_waitcnt lgkmcnt(7)
    v_mfma_f32_16x16x32_bf16 v[28:31], a[236:239], v[72:75], v[28:31]
    buffer_load_dwordx4 v142, s[76:79], s38 offen lds
    s_waitcnt lgkmcnt(4)
    v_mfma_f32_16x16x32_bf16 v[44:47], v[68:71], a[248:251], v[44:47]
    ds_read_b128 v[64:67], v97 offset:48128
    buffer_load_dword v233, v233, s[4:7], 0 offen sc1
    s_waitcnt lgkmcnt(3)
    v_mfma_f32_16x16x32_bf16 v[44:47], v[72:75], a[252:255], v[44:47]
    s_waitcnt lgkmcnt(2)
    v_mfma_f32_16x16x32_bf16 v[32:35], a[232:235], v[76:79], v[32:35]
    ds_read_b128 v[68:71], v97 offset:63488
    v_mfma_f32_16x16x32_bf16 v[32:35], a[236:239], v[88:91], v[32:35]
    s_barrier
    v_mfma_f32_16x16x32_bf16 v[48:51], v[76:79], a[248:251], v[48:51]
    ds_read_b128 v[72:75], v97 offset:64512
    v_mfma_f32_16x16x32_bf16 v[48:51], v[88:91], a[252:255], v[48:51]
    s_waitcnt lgkmcnt(2)
    v_mfma_f32_16x16x32_bf16 v[36:39], a[232:235], v[60:63], v[36:39]
    ds_read_b128 v[108:111], v100 offset:320
    ds_read_b128 v[128:131], v100 offset:128
    ds_read_b128 v[112:115], v100 offset:384
    v_mfma_f32_16x16x32_bf16 v[36:39], a[236:239], v[64:67], v[36:39]
    ds_read_b128 v[132:135], v100 offset:192
    ds_read_b128 v[116:119], v100 offset:448
    v_mfma_f32_16x16x32_bf16 v[52:55], v[60:63], a[248:251], v[52:55]
    v_mfma_f32_16x16x32_bf16 v[52:55], v[64:67], a[252:255], v[52:55]
    s_waitcnt lgkmcnt(5)
    v_mfma_f32_16x16x32_bf16 v[40:43], a[232:235], v[68:71], v[40:43]
    v_mfma_f32_16x16x32_bf16 v[40:43], a[236:239], v[72:75], v[40:43]
    v_mfma_f32_16x16x32_bf16 v[56:59], v[68:71], a[248:251], v[56:59]
    v_mfma_f32_16x16x32_bf16 v[56:59], v[72:75], a[252:255], v[56:59]
    v_mfma_f32_16x16x32_bf16 v[80:83], a[232:235], v[24:27], v[80:83]
    v_mfma_f32_16x16x32_bf16 v[80:83], a[236:239], v[24:27], v[80:83]
    v_mfma_f32_16x16x32_bf16 v[84:87], v[24:27], a[248:251], v[84:87]
    v_mfma_f32_16x16x32_bf16 v[84:87], v[24:27], a[252:255], v[84:87]
    v_mul_f32 v96, 0x3fb8aa3b, v96
    s_nop 4
    v_pk_fma_f32 v[28:29], v[80:81], v[92:93], v[28:29] op_sel:[0,0,0] op_sel_hi:[1,0,1]
    v_pk_fma_f32 v[30:31], v[82:83], v[92:93], v[30:31] op_sel:[0,0,0] op_sel_hi:[1,0,1]
    v_pk_fma_f32 v[32:33], v[80:81], v[92:93], v[32:33] op_sel:[0,1,0] op_sel_hi:[1,1,1]
    v_pk_fma_f32 v[34:35], v[82:83], v[92:93], v[34:35] op_sel:[0,1,0] op_sel_hi:[1,1,1]
    v_pk_fma_f32 v[36:37], v[80:81], v[94:95], v[36:37] op_sel:[0,0,0] op_sel_hi:[1,0,1]
    v_pk_fma_f32 v[38:39], v[82:83], v[94:95], v[38:39] op_sel:[0,0,0] op_sel_hi:[1,0,1]
    v_pk_fma_f32 v[40:41], v[80:81], v[94:95], v[40:41] op_sel:[0,1,0] op_sel_hi:[1,1,1]
    v_pk_fma_f32 v[42:43], v[82:83], v[94:95], v[42:43] op_sel:[0,1,0] op_sel_hi:[1,1,1]
    v_pk_fma_f32 v[44:45], v[120:121], v[84:85], v[44:45] op_sel_hi:[1,0,1]
    v_pk_fma_f32 v[46:47], v[122:123], v[84:85], v[46:47] op_sel_hi:[1,0,1]
    v_pk_fma_f32 v[48:49], v[124:125], v[84:85], v[48:49] op_sel_hi:[1,0,1]
    v_pk_fma_f32 v[50:51], v[126:127], v[84:85], v[50:51] op_sel_hi:[1,0,1]
    s_waitcnt lgkmcnt(3)
    v_pk_fma_f32 v[52:53], v[128:129], v[84:85], v[52:53] op_sel_hi:[1,0,1]
    v_pk_fma_f32 v[54:55], v[130:131], v[84:85], v[54:55] op_sel_hi:[1,0,1]
    s_waitcnt lgkmcnt(1)
    v_pk_fma_f32 v[56:57], v[132:133], v[84:85], v[56:57] op_sel_hi:[1,0,1]
    v_pk_fma_f32 v[58:59], v[134:135], v[84:85], v[58:59] op_sel_hi:[1,0,1]
    v_cvt_pk_bf16_f32 v28, v28, v29
    v_cvt_pk_bf16_f32 v29, v30, v31
    v_cvt_pk_bf16_f32 v30, v32, v33
    v_cvt_pk_bf16_f32 v31, v34, v35
    v_cvt_pk_bf16_f32 v36, v36, v37
    v_cvt_pk_bf16_f32 v37, v38, v39
    v_cvt_pk_bf16_f32 v38, v40, v41
    v_cvt_pk_bf16_f32 v39, v42, v43
    v_pk_mul_f32 v[44:45], v[44:45], v[104:105]
    v_pk_mul_f32 v[46:47], v[46:47], v[106:107]
    v_pk_mul_f32 v[48:49], v[48:49], v[108:109]
    v_pk_mul_f32 v[50:51], v[50:51], v[110:111]
    v_pk_mul_f32 v[52:53], v[52:53], v[112:113]
    v_pk_mul_f32 v[54:55], v[54:55], v[114:115]
    s_waitcnt lgkmcnt(0)
    v_pk_mul_f32 v[56:57], v[56:57], v[116:117]
    v_pk_mul_f32 v[58:59], v[58:59], v[118:119]
    v_mfma_f32_16x16x32_bf16 v[104:107], a[0:3], v[28:31], 0
    s_lshl_b32 s8, s29, 11
    v_cvt_pk_bf16_f32 v44, v44, v45
    v_cvt_pk_bf16_f32 v45, v46, v47
    v_mfma_f32_16x16x32_bf16 v[108:111], a[8:11], v[28:31], 0
    s_add_u32 s9, s8, 2048
    v_cvt_pk_bf16_f32 v46, v48, v49
    v_cvt_pk_bf16_f32 v47, v50, v51
    v_mfma_f32_16x16x32_bf16 v[112:115], a[16:19], v[28:31], 0
    s_and_b32 s9, s9, 0x3fff
    v_cvt_pk_bf16_f32 v52, v52, v53
    v_cvt_pk_bf16_f32 v53, v54, v55
    v_mfma_f32_16x16x32_bf16 v[116:119], a[24:27], v[28:31], 0
    s_add_u32 s10, s9, 2048
    v_cvt_pk_bf16_f32 v54, v56, v57
    v_cvt_pk_bf16_f32 v55, v58, v59
    v_mfma_f32_16x16x32_bf16 v[104:107], a[4:7], v[36:39], v[104:107]
    s_and_b32 s10, s10, 0x3fff
    v_lshlrev_b32 v143, 11, s29
    v_add3_u32 v143, v143, v97, s63
    v_mfma_f32_16x16x32_bf16 v[108:111], a[12:15], v[36:39], v[108:111]
    ds_read_b128 v[8:11], v143 offset:0
    ds_read_b128 v[12:15], v143 offset:1024
    s_add_u32 s11, s10, 2048
    v_mfma_f32_16x16x32_bf16 v[112:115], a[20:23], v[36:39], v[112:115]
    s_and_b32 s11, s11, 0x3fff
    s_add_u32 s33, s11, 2048
    v_mfma_f32_16x16x32_bf16 v[116:119], a[28:31], v[36:39], v[116:119]
    v_max3_f32 v98, v104, v105, v106
    v_min3_f32 v99, v104, v105, v106
    v_max3_f32 v98, v98, v107, v108
    v_min3_f32 v99, v99, v107, v108
    v_max3_f32 v98, v98, v109, v110
    v_min3_f32 v99, v99, v109, v110
    v_max3_f32 v98, v98, v111, v112
    v_min3_f32 v99, v99, v111, v112
    v_max3_f32 v98, v98, v113, v114
    v_min3_f32 v99, v99, v113, v114
    v_max3_f32 v98, v98, v115, v116
    v_min3_f32 v99, v99, v115, v116
    v_max3_f32 v98, v98, v117, v118
    v_min3_f32 v99, v99, v117, v118
    v_max_f32 v98, v98, v119
    v_min_f32 v99, v99, v119
    v_pk_mul_f32 v[98:99], v[98:99], v[96:97] op_sel_hi:[1,0]
    v_pk_fma_f32 v[120:121], v[104:105], v[96:97], v[98:99] op_sel_hi:[1,0,0] neg_lo:[0,0,1] neg_hi:[0,0,1]
    v_pk_fma_f32 v[122:123], v[106:107], v[96:97], v[98:99] op_sel_hi:[1,0,0] neg_lo:[0,0,1] neg_hi:[0,0,1]
    v_pk_fma_f32 v[124:125], v[108:109], v[96:97], v[98:99] op_sel_hi:[1,0,0] neg_lo:[0,0,1] neg_hi:[0,0,1]
    v_pk_fma_f32 v[126:127], v[110:111], v[96:97], v[98:99] op_sel_hi:[1,0,0] neg_lo:[0,0,1] neg_hi:[0,0,1]
    v_pk_fma_f32 v[128:129], v[112:113], v[96:97], v[98:99] op_sel_hi:[1,0,0] neg_lo:[0,0,1] neg_hi:[0,0,1]
    v_pk_fma_f32 v[130:131], v[114:115], v[96:97], v[98:99] op_sel_hi:[1,0,0] neg_lo:[0,0,1] neg_hi:[0,0,1]
    v_pk_fma_f32 v[132:133], v[116:117], v[96:97], v[98:99] op_sel_hi:[1,0,0] neg_lo:[0,0,1] neg_hi:[0,0,1]
    v_pk_fma_f32 v[134:135], v[118:119], v[96:97], v[98:99] op_sel_hi:[1,0,0] neg_lo:[0,0,1] neg_hi:[0,0,1]
    v_pk_fma_f32 v[104:105], v[104:105], v[96:97], v[98:99] op_sel:[0,0,1] op_sel_hi:[1,0,1] neg_lo:[1,0,0] neg_hi:[1,0,0]
    v_pk_fma_f32 v[106:107], v[106:107], v[96:97], v[98:99] op_sel:[0,0,1] op_sel_hi:[1,0,1] neg_lo:[1,0,0] neg_hi:[1,0,0]
    v_pk_fma_f32 v[108:109], v[108:109], v[96:97], v[98:99] op_sel:[0,0,1] op_sel_hi:[1,0,1] neg_lo:[1,0,0] neg_hi:[1,0,0]
    v_pk_fma_f32 v[110:111], v[110:111], v[96:97], v[98:99] op_sel:[0,0,1] op_sel_hi:[1,0,1] neg_lo:[1,0,0] neg_hi:[1,0,0]
    v_pk_fma_f32 v[112:113], v[112:113], v[96:97], v[98:99] op_sel:[0,0,1] op_sel_hi:[1,0,1] neg_lo:[1,0,0] neg_hi:[1,0,0]
    v_pk_fma_f32 v[114:115], v[114:115], v[96:97], v[98:99] op_sel:[0,0,1] op_sel_hi:[1,0,1] neg_lo:[1,0,0] neg_hi:[1,0,0]
    v_pk_fma_f32 v[116:117], v[116:117], v[96:97], v[98:99] op_sel:[0,0,1] op_sel_hi:[1,0,1] neg_lo:[1,0,0] neg_hi:[1,0,0]
    v_pk_fma_f32 v[118:119], v[118:119], v[96:97], v[98:99] op_sel:[0,0,1] op_sel_hi:[1,0,1] neg_lo:[1,0,0] neg_hi:[1,0,0]
    v_exp_f32 v120, v120
    v_exp_f32 v121, v121
    v_exp_f32 v122, v122
    v_exp_f32 v123, v123
    v_exp_f32 v124, v124
    v_exp_f32 v125, v125
    v_exp_f32 v126, v126
    v_exp_f32 v127, v127
    v_exp_f32 v128, v128
    v_exp_f32 v129, v129
    v_exp_f32 v130, v130
    v_exp_f32 v131, v131
    v_exp_f32 v132, v132
    v_exp_f32 v133, v133
    v_exp_f32 v134, v134
    v_exp_f32 v135, v135
    v_exp_f32 v104, v104
    v_exp_f32 v105, v105
    v_exp_f32 v106, v106
    v_exp_f32 v107, v107
    v_exp_f32 v108, v108
    v_exp_f32 v109, v109
    v_exp_f32 v110, v110
    v_exp_f32 v111, v111
    v_exp_f32 v112, v112
    v_exp_f32 v113, v113
    v_exp_f32 v114, v114
    v_exp_f32 v115, v115
    v_exp_f32 v116, v116
    v_exp_f32 v117, v117
    v_exp_f32 v118, v118
    v_exp_f32 v119, v119
    v_pk_add_f32 v[100:101], v[120:121], v[122:123]
    v_pk_add_f32 v[102:103], v[104:105], v[106:107]
    v_pk_add_f32 v[100:101], v[100:101], v[124:125]
    v_pk_add_f32 v[102:103], v[102:103], v[108:109]
    v_pk_add_f32 v[100:101], v[100:101], v[126:127]
    v_pk_add_f32 v[102:103], v[102:103], v[110:111]
    v_pk_add_f32 v[100:101], v[100:101], v[128:129]
    v_pk_add_f32 v[102:103], v[102:103], v[112:113]
    v_pk_add_f32 v[100:101], v[100:101], v[130:131]
    v_pk_add_f32 v[102:103], v[102:103], v[114:115]
    v_pk_add_f32 v[100:101], v[100:101], v[132:133]
    v_pk_add_f32 v[102:103], v[102:103], v[116:117]
    v_pk_add_f32 v[100:101], v[100:101], v[134:135]
    v_pk_add_f32 v[102:103], v[102:103], v[118:119]
    v_add_f32 v100, v100, v101
    v_add_f32 v102, v102, v103
    v_rcp_f32 v100, v100
    v_rcp_f32 v102, v102
    v_pk_mul_f32 v[120:121], v[120:121], v[100:101] op_sel_hi:[1,0]
    v_pk_mul_f32 v[122:123], v[122:123], v[100:101] op_sel_hi:[1,0]
    v_pk_mul_f32 v[124:125], v[124:125], v[100:101] op_sel_hi:[1,0]
    v_pk_mul_f32 v[126:127], v[126:127], v[100:101] op_sel_hi:[1,0]
    v_pk_mul_f32 v[128:129], v[128:129], v[100:101] op_sel_hi:[1,0]
    v_pk_mul_f32 v[130:131], v[130:131], v[100:101] op_sel_hi:[1,0]
    v_pk_mul_f32 v[132:133], v[132:133], v[100:101] op_sel_hi:[1,0]
    v_pk_mul_f32 v[134:135], v[134:135], v[100:101] op_sel_hi:[1,0]
    v_cvt_pk_bf16_f32 v60, v120, v121
    v_cvt_pk_bf16_f32 v61, v122, v123
    v_cvt_pk_bf16_f32 v62, v124, v125
    v_cvt_pk_bf16_f32 v63, v126, v127
    v_cvt_pk_bf16_f32 v64, v128, v129
    v_cvt_pk_bf16_f32 v65, v130, v131
    v_cvt_pk_bf16_f32 v66, v132, v133
    v_cvt_pk_bf16_f32 v67, v134, v135
    ds_write_b128 v136, v[60:63]
    ds_write_b128 v137, v[64:67]
    buffer_load_dwordx4 v[240:243], v7, s[4:7], 0 offen sc1
    ds_read_b64_tr_b16 v[120:121], v140 offset:0
    ds_read_b64_tr_b16 v[122:123], v140 offset:1024
    ds_read_b64_tr_b16 v[124:125], v140 offset:2048
    ds_read_b64_tr_b16 v[126:127], v140 offset:3072
    v_pk_mul_f32 v[104:105], v[104:105], v[102:103] op_sel_hi:[1,0]
    v_pk_mul_f32 v[106:107], v[106:107], v[102:103] op_sel_hi:[1,0]
    v_pk_mul_f32 v[108:109], v[108:109], v[102:103] op_sel_hi:[1,0]
    v_pk_mul_f32 v[110:111], v[110:111], v[102:103] op_sel_hi:[1,0]
    v_pk_mul_f32 v[112:113], v[112:113], v[102:103] op_sel_hi:[1,0]
    v_pk_mul_f32 v[114:115], v[114:115], v[102:103] op_sel_hi:[1,0]
    v_pk_mul_f32 v[116:117], v[116:117], v[102:103] op_sel_hi:[1,0]
    v_pk_mul_f32 v[118:119], v[118:119], v[102:103] op_sel_hi:[1,0]
    v_cvt_pk_bf16_f32 v68, v104, v105
    v_cvt_pk_bf16_f32 v69, v106, v107
    v_cvt_pk_bf16_f32 v70, v108, v109
    v_cvt_pk_bf16_f32 v71, v110, v111
    v_cvt_pk_bf16_f32 v72, v112, v113
    v_cvt_pk_bf16_f32 v73, v114, v115
    v_cvt_pk_bf16_f32 v74, v116, v117
    v_cvt_pk_bf16_f32 v75, v118, v119
    ds_write_b128 v138, v[68:71]
    ds_write_b128 v139, v[72:75]
    ds_read_b64_tr_b16 v[128:129], v141 offset:0
    ds_read_b64_tr_b16 v[130:131], v141 offset:1024
    ds_read_b64_tr_b16 v[132:133], v141 offset:2048
    ds_read_b64_tr_b16 v[134:135], v141 offset:3072
    s_waitcnt lgkmcnt(8)
    v_mfma_f32_16x16x32_bf16 v[104:107], v[120:123], v[44:47], 0
    s_and_b32 s33, s33, 0x3fff
    v_lshrrev_b32 v98, 2, v1
    v_lshrrev_b32 v85, 5, v1
    s_waitcnt lgkmcnt(6)
    v_mfma_f32_16x16x32_bf16 v[104:107], v[124:127], v[52:55], v[104:107]
    s_add_u32 s40, s33, 2048
    v_and_b32 v87, 16, v1
    v_lshl_add_u32 v85, v85, 10, v87
    v_mfma_f32_16x16x32_bf16 v[112:115], v[120:123], v[24:27], 0
    s_and_b32 s40, s40, 0x3fff
    v_lshrrev_b32 v5, 8, v1
    v_lshl_add_u32 v87, v5, 3, v87
    v_mfma_f32_16x16x32_bf16 v[112:115], v[124:127], v[24:27], v[112:115]
    s_add_u32 s84, s40, 2048
    v_bfe_u32 v6, v1, 5, 3
    v_lshl_add_u32 v87, v6, 15, v87
    s_waitcnt lgkmcnt(2)
    v_mfma_f32_16x16x32_bf16 v[108:111], v[128:131], v[44:47], 0
    s_and_b32 s84, s84, 0x3fff
    v_bfe_u32 v5, v1, 4, 1
    v_lshlrev_b32 v5, 4, v5
    s_waitcnt lgkmcnt(0)
    v_mfma_f32_16x16x32_bf16 v[108:111], v[132:135], v[52:55], v[108:111]
    s_add_u32 s38, s84, 2048
    v_mov_b32 v86, 0x3f80
    v_lshlrev_b32 v5, v5, v86
    v_mfma_f32_16x16x32_bf16 v[116:119], v[128:131], v[24:27], 0
    s_and_b32 s38, s38, 0x3fff
    v_mfma_f32_16x16x32_bf16 v[116:119], v[132:135], v[24:27], v[116:119]
    v_cvt_pk_bf16_f32 v60, v104, v105
    v_cvt_pk_bf16_f32 v61, v106, v107
    v_cvt_pk_bf16_f32 v62, v108, v109
    v_cvt_pk_bf16_f32 v63, v110, v111
    v_min_u32 v60, -2, v60
    v_min_u32 v61, -2, v61
    v_min_u32 v62, -2, v62
    v_min_u32 v63, -2, v63
    buffer_store_dwordx4 v[60:63], v1, s[4:7], s16 offen sc1
    v_cvt_pk_bf16_f32 v112, v112, v113
    v_cvt_pk_bf16_f32 v113, v114, v115
    v_cvt_pk_bf16_f32 v114, v116, v117
    v_cvt_pk_bf16_f32 v115, v118, v119
    v_min_u32 v112, -2, v112
    v_min_u32 v113, -2, v113
    v_min_u32 v114, -2, v114
    v_min_u32 v115, -2, v115
    s_mov_b32 s91, 0
    s_cmp_eq_u32 s28, 0
    s_cselect_b32 s82, s45, 0
    s_waitcnt vmcnt(1)
L5c:
    v_xor_b32 v240, s82, v240
    v_xor_b32 v241, s82, v241
    v_xor_b32 v242, s82, v242
    v_xor_b32 v243, s82, v243
    v_or3_b32 v244, v240, v241, v242
    v_or_b32 v244, v244, v243
    v_cmp_lt_u32 vcc, 7, v244
    v_xor_b32 v240, s3, v240
    v_xor_b32 v241, s3, v241
    v_xor_b32 v242, s3, v242
    v_xor_b32 v243, s3, v243
    s_cbranch_vccnz L5s
L5:
    v_or3_b32 v244, v240, v241, v242
    v_or_b32 v130, v244, v243
    s_barrier
    s_mov_b32 exec_lo, 0x00010001
    s_mov_b32 exec_hi, 0x00010001
    buffer_store_dwordx4 v[112:115], v98, s[4:7], s18 offen sc1
    s_mov_b64 exec, -1
    ds_read_b64_tr_b16 v[104:105], v0 offset:0
    ds_read_b64_tr_b16 v[106:107], v0 offset:512
    ds_read_b64_tr_b16 v[108:109], v0 offset:4096
    ds_read_b64_tr_b16 v[110:111], v0 offset:4608
    ds_read_b128 v[44:47], v97 offset:0
    ds_read_b128 v[48:51], v97 offset:1024
    ds_read_b128 v[52:55], v97 offset:16384
    ds_read_b128 v[56:59], v97 offset:17408
    ds_read_b128 v[60:63], v97 offset:32768
    ds_read_b128 v[64:67], v97 offset:33792
    s_waitcnt lgkmcnt(5)
    v_mfma_f32_16x16x32_bf16 v[28:31], v[104:107], v[44:47], 0
    ds_read_b64_tr_b16 v[112:113], v0 offset:8192
    ds_read_b128 v[68:71], v97 offset:49152
    v_add_u32 v7, s95, v1
    s_waitcnt lgkmcnt(6)
    v_mfma_f32_16x16x32_bf16 v[28:31], v[108:111], v[48:51], v[28:31]
    ds_read_b64_tr_b16 v[114:115], v0 offset:8704
    buffer_load_dwordx4 v[192:195], v7, s[4:7], s8 offen
    v_mfma_f32_16x16x32_bf16 v[88:91], v[104:107], v[24:27], 0
    ds_read_b64_tr_b16 v[116:117], v0 offset:12288
    ds_read_b128 v[72:75], v97 offset:50176
    v_cmp_eq_u32 s[24:25], 0, v6
    v_mfma_f32_16x16x32_bf16 v[88:91], v[108:111], v[24:27], v[88:91]
    ds_read_b64_tr_b16 v[118:119], v0 offset:12800
    s_waitcnt lgkmcnt(8)
    v_cmp_eq_u32 s[26:27], 1, v6
    v_mfma_f32_16x16x32_bf16 v[32:35], v[104:107], v[52:55], 0
    ds_read_b128 v[44:47], v97 offset:2048
    v_cndmask_b32 v136, 0, v5, s[24:25]
    v_cndmask_b32 v137, 0, v5, s[26:27]
    v_mfma_f32_16x16x32_bf16 v[32:35], v[108:111], v[56:59], v[32:35]
    ds_read_b128 v[48:51], v97 offset:3072
    s_waitcnt lgkmcnt(8)
    v_cmp_eq_u32 s[24:25], 2, v6
    v_mfma_f32_16x16x32_bf16 v[36:39], v[104:107], v[60:63], 0
    ds_read_b128 v[52:55], v97 offset:18432
    buffer_load_dwordx4 v[196:199], v7, s[4:7], s8 offen offset:1024
    v_mfma_f32_16x16x32_bf16 v[36:39], v[108:111], v[64:67], v[36:39]
    ds_read_b128 v[56:59], v97 offset:19456
    s_waitcnt lgkmcnt(5)
    v_cmp_eq_u32 s[26:27], 3, v6
    v_mfma_f32_16x16x32_bf16 v[40:43], v[104:107], v[68:71], 0
    ds_read_b128 v[60:63], v97 offset:34816
    v_cndmask_b32 v138, 0, v5, s[24:25]
    v_cndmask_b32 v139, 0, v5, s[26:27]
    v_mfma_f32_16x16x32_bf16 v[40:43], v[108:111], v[72:75], v[40:43]
    ds_read_b128 v[64:67], v97 offset:35840
    s_waitcnt lgkmcnt(4)
    v_lshrrev_b32 v86, 8, v1
    v_mfma_f32_16x16x32_bf16 v[28:31], v[112:115], v[44:47], v[28:31]
    ds_read_b64_tr_b16 v[104:105], v0 offset:16384
    ds_read_b128 v[68:71], v97 offset:51200
    v_lshl_add_u32 v86, v86, 14, s90
    v_mfma_f32_16x16x32_bf16 v[28:31], v[116:119], v[48:51], v[28:31]
    ds_read_b64_tr_b16 v[106:107], v0 offset:16896
    buffer_load_dwordx4 v[200:203], v7, s[4:7], s9 offen
    v_mfma_f32_16x16x32_bf16 v[88:91], v[112:115], v[24:27], v[88:91]
    ds_read_b64_tr_b16 v[108:109], v0 offset:20480
    ds_read_b128 v[72:75], v97 offset:52224
    v_min_u32 v86, M_done-interleave_layers__linear_kernel_hedgehog__mixer_channel_mlp__prompt_kernel-128, v86
    v_mfma_f32_16x16x32_bf16 v[88:91], v[116:119], v[24:27], v[88:91]
    ds_read_b64_tr_b16 v[110:111], v0 offset:20992
    s_waitcnt lgkmcnt(8)
    v_mfma_f32_16x16x32_bf16 v[32:35], v[112:115], v[52:55], v[32:35]
    ds_read_b128 v[44:47], v97 offset:4096
    global_load_dword v86, v86, s[88:89]
    v_mfma_f32_16x16x32_bf16 v[32:35], v[116:119], v[56:59], v[32:35]
    ds_read_b128 v[48:51], v97 offset:5120
    s_waitcnt lgkmcnt(8)
    v_mov_b32 v124, -1
    v_mfma_f32_16x16x32_bf16 v[36:39], v[112:115], v[60:63], v[36:39]
    ds_read_b128 v[52:55], v97 offset:20480
    buffer_load_dwordx4 v[204:207], v7, s[4:7], s9 offen offset:1024
    v_mfma_f32_16x16x32_bf16 v[36:39], v[116:119], v[64:67], v[36:39]
    ds_read_b128 v[56:59], v97 offset:21504
    s_waitcnt lgkmcnt(5)
    v_mov_b32 v125, -1
    v_mfma_f32_16x16x32_bf16 v[40:43], v[112:115], v[68:71], v[40:43]
    ds_read_b128 v[60:63], v97 offset:36864
    v_mov_b32 v126, -1
    v_mov_b32 v127, -1
    v_mfma_f32_16x16x32_bf16 v[40:43], v[116:119], v[72:75], v[40:43]
    ds_read_b128 v[64:67], v97 offset:37888
    s_waitcnt lgkmcnt(4)
    s_lshl_b32 s34, s31, 5
    v_mfma_f32_16x16x32_bf16 v[28:31], v[104:107], v[44:47], v[28:31]
    ds_read_b64_tr_b16 v[112:113], v0 offset:24576
    ds_read_b128 v[68:71], v97 offset:53248
    s_add_u32 s34, s34, s30
    v_mfma_f32_16x16x32_bf16 v[28:31], v[108:111], v[48:51], v[28:31]
    ds_read_b64_tr_b16 v[114:115], v0 offset:25088
    s_lshl_b32 s34, s34, 10
    s_add_u32 s34, s34, 34119680
    v_mfma_f32_16x16x32_bf16 v[88:91], v[104:107], v[24:27], v[88:91]
    ds_read_b64_tr_b16 v[116:117], v0 offset:28672
    ds_read_b128 v[72:75], v97 offset:54272
    v_add_u32 v129, s34, v1
    v_mfma_f32_16x16x32_bf16 v[88:91], v[108:111], v[24:27], v[88:91]
    ds_read_b64_tr_b16 v[118:119], v0 offset:29184
    s_waitcnt lgkmcnt(8)
    v_mfma_f32_16x16x32_bf16 v[32:35], v[104:107], v[52:55], v[32:35]
    ds_read_b128 v[44:47], v97 offset:6144
    buffer_load_dwordx4 v[208:211], v7, s[4:7], s10 offen
    v_mfma_f32_16x16x32_bf16 v[32:35], v[108:111], v[56:59], v[32:35]
    ds_read_b128 v[48:51], v97 offset:7168
    s_waitcnt lgkmcnt(8)
    v_mfma_f32_16x16x32_bf16 v[36:39], v[104:107], v[60:63], v[36:39]
    ds_read_b128 v[52:55], v97 offset:22528
    buffer_store_dwordx4 v[124:127], v129, s[4:7], 0 offen sc1
    v_mfma_f32_16x16x32_bf16 v[36:39], v[108:111], v[64:67], v[36:39]
    ds_read_b128 v[56:59], v97 offset:23552
    s_waitcnt lgkmcnt(5)
    v_mfma_f32_16x16x32_bf16 v[40:43], v[104:107], v[68:71], v[40:43]
    ds_read_b128 v[60:63], v97 offset:38912
    buffer_load_dwordx4 v[212:215], v7, s[4:7], s10 offen offset:1024
    v_mfma_f32_16x16x32_bf16 v[40:43], v[108:111], v[72:75], v[40:43]
    ds_read_b128 v[64:67], v97 offset:39936
    s_waitcnt lgkmcnt(4)
    v_mfma_f32_16x16x32_bf16 v[28:31], v[112:115], v[44:47], v[28:31]
    ds_read_b64_tr_b16 v[104:105], v0 offset:32768
    ds_read_b128 v[68:71], v97 offset:55296
    v_mfma_f32_16x16x32_bf16 v[28:31], v[116:119], v[48:51], v[28:31]
    ds_read_b64_tr_b16 v[106:107], v0 offset:33280
    v_mfma_f32_16x16x32_bf16 v[88:91], v[112:115], v[24:27], v[88:91]
    ds_read_b64_tr_b16 v[108:109], v0 offset:36864
    ds_read_b128 v[72:75], v97 offset:56320
    v_mfma_f32_16x16x32_bf16 v[88:91], v[116:119], v[24:27], v[88:91]
    ds_read_b64_tr_b16 v[110:111], v0 offset:37376
    s_waitcnt lgkmcnt(8)
    v_mfma_f32_16x16x32_bf16 v[32:35], v[112:115], v[52:55], v[32:35]
    ds_read_b128 v[44:47], v97 offset:8192
    buffer_load_dwordx4 v[216:219], v7, s[4:7], s11 offen
    v_mfma_f32_16x16x32_bf16 v[32:35], v[116:119], v[56:59], v[32:35]
    ds_read_b128 v[48:51], v97 offset:9216
    s_waitcnt lgkmcnt(8)
    v_mfma_f32_16x16x32_bf16 v[36:39], v[112:115], v[60:63], v[36:39]
    ds_read_b128 v[52:55], v97 offset:24576
    v_mfma_f32_16x16x32_bf16 v[36:39], v[116:119], v[64:67], v[36:39]
    ds_read_b128 v[56:59], v97 offset:25600
    s_waitcnt lgkmcnt(5)
    v_mfma_f32_16x16x32_bf16 v[40:43], v[112:115], v[68:71], v[40:43]
    ds_read_b128 v[60:63], v97 offset:40960
    buffer_load_dwordx4 v[220:223], v7, s[4:7], s11 offen offset:1024
    v_mfma_f32_16x16x32_bf16 v[40:43], v[116:119], v[72:75], v[40:43]
    ds_read_b128 v[64:67], v97 offset:41984
    s_waitcnt lgkmcnt(4)
    v_mfma_f32_16x16x32_bf16 v[28:31], v[104:107], v[44:47], v[28:31]
    ds_read_b64_tr_b16 v[112:113], v0 offset:40960
    ds_read_b128 v[68:71], v97 offset:57344
    v_mfma_f32_16x16x32_bf16 v[28:31], v[108:111], v[48:51], v[28:31]
    ds_read_b64_tr_b16 v[114:115], v0 offset:41472
    v_mfma_f32_16x16x32_bf16 v[88:91], v[104:107], v[24:27], v[88:91]
    ds_read_b64_tr_b16 v[116:117], v0 offset:45056
    ds_read_b128 v[72:75], v97 offset:58368
    v_mfma_f32_16x16x32_bf16 v[88:91], v[108:111], v[24:27], v[88:91]
    ds_read_b64_tr_b16 v[118:119], v0 offset:45568
    s_waitcnt lgkmcnt(8)
    v_mfma_f32_16x16x32_bf16 v[32:35], v[104:107], v[52:55], v[32:35]
    ds_read_b128 v[44:47], v97 offset:10240
    s_barrier
    v_mfma_f32_16x16x32_bf16 v[32:35], v[108:111], v[56:59], v[32:35]
    ds_read_b128 v[48:51], v97 offset:11264
    s_waitcnt lgkmcnt(8)
    s_add_u32 m0, s63, 0
    v_mfma_f32_16x16x32_bf16 v[36:39], v[104:107], v[60:63], v[36:39]
    ds_read_b128 v[52:55], v97 offset:26624
    v_add_u32 v7, s98, v1
    v_mfma_f32_16x16x32_bf16 v[36:39], v[108:111], v[64:67], v[36:39]
    ds_read_b128 v[56:59], v97 offset:27648
    s_waitcnt lgkmcnt(5)
    v_mfma_f32_16x16x32_bf16 v[40:43], v[104:107], v[68:71], v[40:43]
    ds_read_b128 v[60:63], v97 offset:43008
    buffer_load_dwordx4 v7, s[4:7], 0 offen lds
    v_mfma_f32_16x16x32_bf16 v[40:43], v[108:111], v[72:75], v[40:43]
    ds_read_b128 v[64:67], v97 offset:44032
    s_waitcnt lgkmcnt(4)
    v_mfma_f32_16x16x32_bf16 v[28:31], v[112:115], v[44:47], v[28:31]
    ds_read_b64_tr_b16 v[104:105], v0 offset:49152
    ds_read_b128 v[68:71], v97 offset:59392
    buffer_load_dwordx4 v[140:143], v85, s[4:7], s19 offen sc1
    v_mfma_f32_16x16x32_bf16 v[28:31], v[116:119], v[48:51], v[28:31]
    ds_read_b64_tr_b16 v[106:107], v0 offset:49664
    buffer_load_dwordx4 v7, s[4:7], 0 offen offset:1024 lds
    v_mfma_f32_16x16x32_bf16 v[88:91], v[112:115], v[24:27], v[88:91]
    ds_read_b64_tr_b16 v[108:109], v0 offset:53248
    ds_read_b128 v[72:75], v97 offset:60416
    v_mfma_f32_16x16x32_bf16 v[88:91], v[116:119], v[24:27], v[88:91]
    ds_read_b64_tr_b16 v[110:111], v0 offset:53760
    s_waitcnt lgkmcnt(8)
    v_mfma_f32_16x16x32_bf16 v[32:35], v[112:115], v[52:55], v[32:35]
    ds_read_b128 v[44:47], v97 offset:12288
    buffer_load_dwordx4 v7, s[4:7], 0 offen offset:2048 lds
    v_mfma_f32_16x16x32_bf16 v[32:35], v[116:119], v[56:59], v[32:35]
    ds_read_b128 v[48:51], v97 offset:13312
    s_waitcnt lgkmcnt(8)
    v_mfma_f32_16x16x32_bf16 v[36:39], v[112:115], v[60:63], v[36:39]
    ds_read_b128 v[52:55], v97 offset:28672
    v_mfma_f32_16x16x32_bf16 v[36:39], v[116:119], v[64:67], v[36:39]
    ds_read_b128 v[56:59], v97 offset:29696
    s_waitcnt lgkmcnt(5)
    v_mfma_f32_16x16x32_bf16 v[40:43], v[112:115], v[68:71], v[40:43]
    ds_read_b128 v[60:63], v97 offset:45056
    buffer_load_dwordx4 v7, s[4:7], 0 offen offset:3072 lds
    v_mfma_f32_16x16x32_bf16 v[40:43], v[116:119], v[72:75], v[40:43]
    ds_read_b128 v[64:67], v97 offset:46080
    s_waitcnt lgkmcnt(4)
    s_add_u32 m0, s63, 4096
    v_mfma_f32_16x16x32_bf16 v[28:31], v[104:107], v[44:47], v[28:31]
    ds_read_b64_tr_b16 v[112:113], v0 offset:57344
    ds_read_b128 v[68:71], v97 offset:61440
    s_cmp_lg_u32 s28, 0
    s_cbranch_scc1 L5e
    v_cmp_ne_u32 vcc, 0, v130
    s_lshl_b32 s91, s30, 1
    v_mov_b32 v131, 152576
    s_nop 3
    s_lshr_b64 s[82:83], vcc, s91
    s_and_b32 s82, s82, 3
    s_cselect_b32 s46, 0, 1
    v_mov_b32 v130, s46
    ds_write_b32 v131, v130
    s_or_b32 s91, s30, s29
    s_cbranch_scc1 L5e
    v_mov_b32_e64 v130, s45
    s_mov_b64 exec, 1
    buffer_store_dword v130, v1, s[4:7], 0 offen sc1
    s_mov_b64 exec, -1
L5e:
    v_mfma_f32_16x16x32_bf16 v[28:31], v[108:111], v[48:51], v[28:31]
    ds_read_b64_tr_b16 v[114:115], v0 offset:57856
    v_mfma_f32_16x16x32_bf16 v[88:91], v[104:107], v[24:27], v[88:91]
    ds_read_b64_tr_b16 v[116:117], v0 offset:61440
    ds_read_b128 v[72:75], v97 offset:62464
    v_mfma_f32_16x16x32_bf16 v[88:91], v[108:111], v[24:27], v[88:91]
    ds_read_b64_tr_b16 v[118:119], v0 offset:61952
    s_waitcnt lgkmcnt(8)
    v_mfma_f32_16x16x32_bf16 v[32:35], v[104:107], v[52:55], v[32:35]
    ds_read_b128 v[44:47], v97 offset:14336
    buffer_load_dwordx4 v7, s[4:7], s48 offen lds
    v_mfma_f32_16x16x32_bf16 v[32:35], v[108:111], v[56:59], v[32:35]
    ds_read_b128 v[48:51], v97 offset:15360
    s_waitcnt lgkmcnt(8)
    v_mfma_f32_16x16x32_bf16 v[36:39], v[104:107], v[60:63], v[36:39]
    ds_read_b128 v[52:55], v97 offset:30720
    buffer_load_dwordx4 v7, s[4:7], s48 offen offset:1024 lds
    v_mfma_f32_16x16x32_bf16 v[36:39], v[108:111], v[64:67], v[36:39]
    ds_read_b128 v[56:59], v97 offset:31744
    s_waitcnt lgkmcnt(5)
    v_mfma_f32_16x16x32_bf16 v[40:43], v[104:107], v[68:71], v[40:43]
    ds_read_b128 v[60:63], v97 offset:47104
    v_mfma_f32_16x16x32_bf16 v[40:43], v[108:111], v[72:75], v[40:43]
    ds_read_b128 v[64:67], v97 offset:48128
    s_waitcnt lgkmcnt(4)
    v_mfma_f32_16x16x32_bf16 v[28:31], v[112:115], v[44:47], v[28:31]
    ds_read_b128 v[68:71], v97 offset:63488
    v_mfma_f32_16x16x32_bf16 v[28:31], v[116:119], v[48:51], v[28:31]
    buffer_load_dwordx4 v7, s[4:7], s48 offen offset:2048 lds
    v_mfma_f32_16x16x32_bf16 v[88:91], v[112:115], v[24:27], v[88:91]
    ds_read_b128 v[72:75], v97 offset:64512
    v_mfma_f32_16x16x32_bf16 v[88:91], v[116:119], v[24:27], v[88:91]
    s_waitcnt lgkmcnt(4)
    v_mfma_f32_16x16x32_bf16 v[32:35], v[112:115], v[52:55], v[32:35]
    buffer_load_dwordx4 v7, s[4:7], s48 offen offset:3072 lds
    v_mfma_f32_16x16x32_bf16 v[32:35], v[116:119], v[56:59], v[32:35]
    s_waitcnt lgkmcnt(2)
    v_mfma_f32_16x16x32_bf16 v[36:39], v[112:115], v[60:63], v[36:39]
    v_mfma_f32_16x16x32_bf16 v[36:39], v[116:119], v[64:67], v[36:39]
    s_waitcnt lgkmcnt(0)
    v_mfma_f32_16x16x32_bf16 v[40:43], v[112:115], v[68:71], v[40:43]
    v_mfma_f32_16x16x32_bf16 v[40:43], v[116:119], v[72:75], v[40:43]
    s_barrier
    v_pk_fma_f32 v[28:29], v[88:89], v[92:93], v[28:29] op_sel:[0,0,0] op_sel_hi:[1,0,1]
    v_pk_fma_f32 v[30:31], v[90:91], v[92:93], v[30:31] op_sel:[0,0,0] op_sel_hi:[1,0,1]
    v_pk_fma_f32 v[32:33], v[88:89], v[92:93], v[32:33] op_sel:[0,1,0] op_sel_hi:[1,1,1]
    v_pk_fma_f32 v[34:35], v[90:91], v[92:93], v[34:35] op_sel:[0,1,0] op_sel_hi:[1,1,1]
    v_pk_fma_f32 v[36:37], v[88:89], v[94:95], v[36:37] op_sel:[0,0,0] op_sel_hi:[1,0,1]
    v_pk_fma_f32 v[38:39], v[90:91], v[94:95], v[38:39] op_sel:[0,0,0] op_sel_hi:[1,0,1]
    s_nop 0
    v_pk_fma_f32 v[40:41], v[88:89], v[94:95], v[40:41] op_sel:[0,1,0] op_sel_hi:[1,1,1]
    v_pk_fma_f32 v[42:43], v[90:91], v[94:95], v[42:43] op_sel:[0,1,0] op_sel_hi:[1,1,1]
    v_cvt_pk_bf16_f32 v28, v28, v29
    v_cvt_pk_bf16_f32 v29, v30, v31
    v_cvt_pk_bf16_f32 v30, v32, v33
    v_cvt_pk_bf16_f32 v31, v34, v35
    v_cvt_pk_bf16_f32 v36, v36, v37
    v_cvt_pk_bf16_f32 v37, v38, v39
    v_cvt_pk_bf16_f32 v38, v40, v41
    v_cvt_pk_bf16_f32 v39, v42, v43
    v_mfma_f32_16x16x32_bf16 v[104:107], a[0:3], v[28:31], 0
    s_add_u32 m0, s63, 8192
    v_add_u32 v7, s98, v1
    v_mfma_f32_16x16x32_bf16 v[108:111], a[8:11], v[28:31], 0
    buffer_load_dwordx4 v7, s[4:7], s55 offen lds
    v_mfma_f32_16x16x32_bf16 v[112:115], a[16:19], v[28:31], 0
    v_mfma_f32_16x16x32_bf16 v[116:119], a[24:27], v[28:31], 0
    v_mfma_f32_16x16x32_bf16 v[104:107], a[4:7], v[36:39], v[104:107]
    buffer_load_dwordx4 v7, s[4:7], s55 offen offset:1024 lds
    v_mfma_f32_16x16x32_bf16 v[108:111], a[12:15], v[36:39], v[108:111]
    v_mfma_f32_16x16x32_bf16 v[112:115], a[20:23], v[36:39], v[112:115]
    v_mfma_f32_16x16x32_bf16 v[116:119], a[28:31], v[36:39], v[116:119]
    s_mov_b32 s91, 0
    s_waitcnt vmcnt(9)
L6c:
    v_mfma_f32_16x16x32_bf16 v[60:63], v[136:139], v[140:143], 0
    v_max3_u32 v5, v140, v141, v142
    v_max_u32 v5, v5, v143
    v_cmp_eq_u32 vcc, -1, v5
    s_nop 3
    s_cbranch_vccnz L6s
L6:
    buffer_load_dwordx4 v[28:31], v1, s[4:7], s17 offen sc1
    buffer_load_dwordx4 v[32:35], v1, s[4:7], s17 offen offset:1024 sc1
    v_add_f32_dpp v60, v60, v60 row_ror:8 row_mask:0xf bank_mask:0xf
    v_add_f32_dpp v61, v61, v61 row_ror:8 row_mask:0xf bank_mask:0xf
    v_add_f32_dpp v62, v62, v62 row_ror:8 row_mask:0xf bank_mask:0xf
    v_add_f32_dpp v63, v63, v63 row_ror:8 row_mask:0xf bank_mask:0xf
    v_add_f32_dpp v60, v60, v60 row_ror:4 row_mask:0xf bank_mask:0xf
    v_add_f32_dpp v61, v61, v61 row_ror:4 row_mask:0xf bank_mask:0xf
    v_add_f32_dpp v62, v62, v62 row_ror:4 row_mask:0xf bank_mask:0xf
    v_add_f32_dpp v63, v63, v63 row_ror:4 row_mask:0xf bank_mask:0xf
    v_add_f32_dpp v60, v60, v60 row_ror:2 row_mask:0xf bank_mask:0xf
    v_add_f32_dpp v61, v61, v61 row_ror:2 row_mask:0xf bank_mask:0xf
    v_add_f32_dpp v62, v62, v62 row_ror:2 row_mask:0xf bank_mask:0xf
    v_add_f32_dpp v63, v63, v63 row_ror:2 row_mask:0xf bank_mask:0xf
    v_cvt_pk_bf16_f32 v60, v60, v61
    v_cvt_pk_bf16_f32 v61, v62, v63
    v_min_u32 v60, -2, v60
    v_min_u32 v61, -2, v61
    v_mov_b32 v62, v60
    v_mov_b32 v63, v61
    s_nop 0
    v_permlane16_swap_b32 v60, v62
    v_permlane16_swap_b32 v61, v63
    s_mov_b64 exec, 65535
    buffer_store_dwordx4 v[60:63], v87, s[4:7], s20 offen sc1
    s_mov_b64 exec, -1
    buffer_load_dwordx4 v7, s[4:7], s55 offen offset:2048 lds
    v_max3_f32 v98, v104, v105, v106
    v_min3_f32 v99, v104, v105, v106
    v_max3_f32 v98, v98, v107, v108
    v_min3_f32 v99, v99, v107, v108
    v_max3_f32 v98, v98, v109, v110
    v_min3_f32 v99, v99, v109, v110
    v_max3_f32 v98, v98, v111, v112
    v_min3_f32 v99, v99, v111, v112
    v_max3_f32 v98, v98, v113, v114
    v_min3_f32 v99, v99, v113, v114
    v_max3_f32 v98, v98, v115, v116
    v_min3_f32 v99, v99, v115, v116
    v_max3_f32 v98, v98, v117, v118
    buffer_load_dwordx4 v7, s[4:7], s55 offen offset:3072 lds
    v_min3_f32 v99, v99, v117, v118
    v_max_f32 v98, v98, v119
    v_min_f32 v99, v99, v119
    v_pk_mul_f32 v[98:99], v[98:99], v[96:97] op_sel_hi:[1,0]
    v_pk_fma_f32 v[120:121], v[104:105], v[96:97], v[98:99] op_sel_hi:[1,0,0] neg_lo:[0,0,1] neg_hi:[0,0,1]
    v_pk_fma_f32 v[122:123], v[106:107], v[96:97], v[98:99] op_sel_hi:[1,0,0] neg_lo:[0,0,1] neg_hi:[0,0,1]
    v_pk_fma_f32 v[124:125], v[108:109], v[96:97], v[98:99] op_sel_hi:[1,0,0] neg_lo:[0,0,1] neg_hi:[0,0,1]
    v_pk_fma_f32 v[126:127], v[110:111], v[96:97], v[98:99] op_sel_hi:[1,0,0] neg_lo:[0,0,1] neg_hi:[0,0,1]
    v_pk_fma_f32 v[128:129], v[112:113], v[96:97], v[98:99] op_sel_hi:[1,0,0] neg_lo:[0,0,1] neg_hi:[0,0,1]
    v_pk_fma_f32 v[130:131], v[114:115], v[96:97], v[98:99] op_sel_hi:[1,0,0] neg_lo:[0,0,1] neg_hi:[0,0,1]
    v_pk_fma_f32 v[132:133], v[116:117], v[96:97], v[98:99] op_sel_hi:[1,0,0] neg_lo:[0,0,1] neg_hi:[0,0,1]
    v_pk_fma_f32 v[134:135], v[118:119], v[96:97], v[98:99] op_sel_hi:[1,0,0] neg_lo:[0,0,1] neg_hi:[0,0,1]
    s_add_u32 m0, s63, 12288
    s_nop 0
    buffer_load_dwordx4 v7, s[4:7], s56 offen lds
    v_pk_fma_f32 v[104:105], v[104:105], v[96:97], v[98:99] op_sel:[0,0,1] op_sel_hi:[1,0,1] neg_lo:[1,0,0] neg_hi:[1,0,0]
    v_pk_fma_f32 v[106:107], v[106:107], v[96:97], v[98:99] op_sel:[0,0,1] op_sel_hi:[1,0,1] neg_lo:[1,0,0] neg_hi:[1,0,0]
    v_pk_fma_f32 v[108:109], v[108:109], v[96:97], v[98:99] op_sel:[0,0,1] op_sel_hi:[1,0,1] neg_lo:[1,0,0] neg_hi:[1,0,0]
    v_pk_fma_f32 v[110:111], v[110:111], v[96:97], v[98:99] op_sel:[0,0,1] op_sel_hi:[1,0,1] neg_lo:[1,0,0] neg_hi:[1,0,0]
    v_pk_fma_f32 v[112:113], v[112:113], v[96:97], v[98:99] op_sel:[0,0,1] op_sel_hi:[1,0,1] neg_lo:[1,0,0] neg_hi:[1,0,0]
    v_pk_fma_f32 v[114:115], v[114:115], v[96:97], v[98:99] op_sel:[0,0,1] op_sel_hi:[1,0,1] neg_lo:[1,0,0] neg_hi:[1,0,0]
    v_pk_fma_f32 v[116:117], v[116:117], v[96:97], v[98:99] op_sel:[0,0,1] op_sel_hi:[1,0,1] neg_lo:[1,0,0] neg_hi:[1,0,0]
    v_pk_fma_f32 v[118:119], v[118:119], v[96:97], v[98:99] op_sel:[0,0,1] op_sel_hi:[1,0,1] neg_lo:[1,0,0] neg_hi:[1,0,0]
    v_exp_f32 v120, v120
    v_exp_f32 v121, v121
    v_exp_f32 v122, v122
    buffer_load_dwordx4 v7, s[4:7], s56 offen offset:1024 lds
    v_exp_f32 v123, v123
    v_exp_f32 v124, v124
    v_exp_f32 v125, v125
    v_exp_f32 v126, v126
    v_exp_f32 v127, v127
    v_exp_f32 v128, v128
    buffer_load_dwordx4 v7, s[4:7], s56 offen offset:2048 lds
    v_exp_f32 v129, v129
    v_exp_f32 v130, v130
    v_exp_f32 v131, v131
    v_exp_f32 v132, v132
    v_exp_f32 v133, v133
    v_exp_f32 v134, v134
    buffer_load_dwordx4 v7, s[4:7], s56 offen offset:3072 lds
    v_exp_f32 v135, v135
    v_exp_f32 v104, v104
    v_exp_f32 v105, v105
    v_exp_f32 v106, v106
    v_exp_f32 v107, v107
    v_exp_f32 v108, v108
    v_add_u32 v7, s95, v1
    buffer_load_dwordx4 v[224:227], v7, s[4:7], s33 offen
    v_exp_f32 v109, v109
    v_exp_f32 v110, v110
    v_exp_f32 v111, v111
    v_exp_f32 v112, v112
    v_exp_f32 v113, v113
    v_exp_f32 v114, v114
    buffer_load_dwordx4 v[228:231], v7, s[4:7], s33 offen offset:1024
    v_exp_f32 v115, v115
    v_exp_f32 v116, v116
    v_exp_f32 v117, v117
    v_exp_f32 v118, v118
    v_exp_f32 v119, v119
    v_pk_add_f32 v[100:101], v[120:121], v[122:123]
    v_pk_add_f32 v[102:103], v[104:105], v[106:107]
    v_pk_add_f32 v[100:101], v[100:101], v[124:125]
    buffer_load_dwordx4 v[232:235], v7, s[4:7], s40 offen
    v_pk_add_f32 v[102:103], v[102:103], v[108:109]
    v_pk_add_f32 v[100:101], v[100:101], v[126:127]
    v_pk_add_f32 v[102:103], v[102:103], v[110:111]
    v_pk_add_f32 v[100:101], v[100:101], v[128:129]
    v_pk_add_f32 v[102:103], v[102:103], v[112:113]
    v_pk_add_f32 v[100:101], v[100:101], v[130:131]
    v_pk_add_f32 v[102:103], v[102:103], v[114:115]
    v_pk_add_f32 v[100:101], v[100:101], v[132:133]
    v_pk_add_f32 v[102:103], v[102:103], v[116:117]
    v_pk_add_f32 v[100:101], v[100:101], v[134:135]
    v_pk_add_f32 v[102:103], v[102:103], v[118:119]
    v_add_f32 v100, v100, v101
    buffer_load_dwordx4 v[236:239], v7, s[4:7], s40 offen offset:1024
    v_add_f32 v102, v102, v103
    v_rcp_f32 v100, v100
    v_rcp_f32 v102, v102
    v_pk_mul_f32 v[120:121], v[120:121], v[100:101] op_sel_hi:[1,0]
    v_pk_mul_f32 v[122:123], v[122:123], v[100:101] op_sel_hi:[1,0]
    v_pk_mul_f32 v[124:125], v[124:125], v[100:101] op_sel_hi:[1,0]
    v_pk_mul_f32 v[126:127], v[126:127], v[100:101] op_sel_hi:[1,0]
    v_pk_mul_f32 v[128:129], v[128:129], v[100:101] op_sel_hi:[1,0]
    v_pk_mul_f32 v[130:131], v[130:131], v[100:101] op_sel_hi:[1,0]
    v_pk_mul_f32 v[132:133], v[132:133], v[100:101] op_sel_hi:[1,0]
    v_pk_mul_f32 v[134:135], v[134:135], v[100:101] op_sel_hi:[1,0]
    buffer_load_dwordx4 v[240:243], v7, s[4:7], s84 offen
    v_cvt_pk_bf16_f32 v44, v120, v121
    v_cvt_pk_bf16_f32 v45, v122, v123
    v_cvt_pk_bf16_f32 v48, v124, v125
    v_cvt_pk_bf16_f32 v49, v126, v127
    v_cvt_pk_bf16_f32 v52, v128, v129
    v_cvt_pk_bf16_f32 v53, v130, v131
    v_cvt_pk_bf16_f32 v56, v132, v133
    v_cvt_pk_bf16_f32 v57, v134, v135
    v_pk_mul_f32 v[104:105], v[104:105], v[102:103] op_sel_hi:[1,0]
    v_pk_mul_f32 v[106:107], v[106:107], v[102:103] op_sel_hi:[1,0]
    v_pk_mul_f32 v[108:109], v[108:109], v[102:103] op_sel_hi:[1,0]
    v_pk_mul_f32 v[110:111], v[110:111], v[102:103] op_sel_hi:[1,0]
    buffer_load_dwordx4 v[244:247], v7, s[4:7], s84 offen offset:1024
    v_pk_mul_f32 v[112:113], v[112:113], v[102:103] op_sel_hi:[1,0]
    v_pk_mul_f32 v[114:115], v[114:115], v[102:103] op_sel_hi:[1,0]
    v_pk_mul_f32 v[116:117], v[116:117], v[102:103] op_sel_hi:[1,0]
    v_pk_mul_f32 v[118:119], v[118:119], v[102:103] op_sel_hi:[1,0]
    v_cvt_pk_bf16_f32 v46, v104, v105
    v_cvt_pk_bf16_f32 v47, v106, v107
    v_cvt_pk_bf16_f32 v50, v108, v109
    v_cvt_pk_bf16_f32 v51, v110, v111
    v_cvt_pk_bf16_f32 v54, v112, v113
    v_cvt_pk_bf16_f32 v55, v114, v115
    v_cvt_pk_bf16_f32 v58, v116, v117
    v_cvt_pk_bf16_f32 v59, v118, v119
    s_mov_b32 s91, 0
    s_waitcnt vmcnt(13)
L7c:
    v_max3_u32 v5, v28, v29, v30
    v_max3_u32 v5, v5, v31, v32
    v_max3_u32 v5, v5, v33, v34
    v_max_u32 v5, v5, v35
    v_cmp_eq_u32 vcc, -1, v5
    s_nop 3
    s_cbranch_vccnz L7s
L7:
    buffer_load_dwordx4 v[248:251], v7, s[4:7], s38 offen
    v_mfma_f32_16x16x32_bf16 v[64:67], v[28:31], v[136:139], 0
    v_mfma_f32_16x16x32_bf16 v[64:67], v[32:35], v[136:139], v[64:67]
    v_permlane32_swap_b32 v44, v52
    v_permlane32_swap_b32 v48, v56
    v_permlane32_swap_b32 v45, v53
    v_permlane32_swap_b32 v49, v57
    v_permlane32_swap_b32 v46, v54
    buffer_load_dwordx4 v[252:255], v7, s[4:7], s38 offen offset:1024
    v_permlane32_swap_b32 v50, v58
    v_permlane32_swap_b32 v47, v55
    v_permlane32_swap_b32 v51, v59
    v_add_f32 v64, v64, v65
    v_add_f32 v66, v66, v67
    v_add_f32 v64, v64, v66
    v_permlane16_swap_b32 v44, v48
    v_permlane16_swap_b32 v52, v56
    v_mov_b32_dpp v65, v64 quad_perm:[1,0,3,2] row_mask:0xf bank_mask:0xf
    v_cvt_pk_bf16_f32 v64, v64, v65
    v_add_u32 v7, s93, v1
    buffer_load_dwordx4 a[48:51], v7, s[4:7], s8 offen
    v_permlane16_swap_b32 v45, v49
    v_permlane16_swap_b32 v53, v57
    v_mov_b32_dpp v72, v64 row_newbcast:0 row_mask:0xf bank_mask:0xf
    v_mov_b32_dpp v73, v64 row_newbcast:2 row_mask:0xf bank_mask:0xf
    v_mov_b32_dpp v74, v64 row_newbcast:4 row_mask:0xf bank_mask:0xf
    v_mov_b32_dpp v75, v64 row_newbcast:6 row_mask:0xf bank_mask:0xf
    v_permlane16_swap_b32 v46, v50
    v_permlane16_swap_b32 v54, v58
    v_permlane16_swap_b32 v47, v51
    v_permlane16_swap_b32 v55, v59
    v_mov_b32 v6, 152576
    ds_read_b32 v6, v6
    v_mfma_f32_16x16x32_bf16 v[96:99], v[72:75], v[44:47], 0
    v_mfma_f32_16x16x32_bf16 v[100:103], v[72:75], v[48:51], 0
    v_mfma_f32_16x16x32_bf16 v[104:107], v[72:75], v[52:55], 0
    v_mfma_f32_16x16x32_bf16 v[108:111], v[72:75], v[56:59], 0
    buffer_load_dwordx4 v[76:79], v1, s[4:7], s21 offen sc1
    s_nop 3
    v_add_f32 v96, 0x358637bd, v96
    v_add_f32 v100, 0x358637bd, v100
    v_add_f32 v104, 0x358637bd, v104
    v_add_f32 v108, 0x358637bd, v108
    v_rcp_f32 v96, v96
    v_rcp_f32 v100, v100
    v_rcp_f32 v104, v104
    v_rcp_f32 v108, v108
    s_waitcnt lgkmcnt(0)
    v_readfirstlane_b32 s46, v6
    s_nop 3
    s_xor_b32 s1, s46, 1
    s_lshl_b32 s1, s1, 31
    s_xor_b32 s1, s1, s45
    s_mov_b32 s91, 0
    s_waitcnt vmcnt(0)
L8c:
    v_mfma_f32_16x16x32_bf16 v[120:123], v[76:79], v[44:47], 0
    v_max3_u32 v5, v76, v77, v78
    v_max_u32 v5, v5, v79
    v_cmp_eq_u32 vcc, -1, v5
    v_mfma_f32_16x16x32_bf16 v[124:127], v[76:79], v[48:51], 0
    v_mfma_f32_16x16x32_bf16 v[128:131], v[76:79], v[52:55], 0
    v_mfma_f32_16x16x32_bf16 v[132:135], v[76:79], v[56:59], 0
    s_nop 0
    s_cbranch_vccnz L8s
L8:
    v_mul_f32 v120, v120, v96
    v_mul_f32 v121, v121, v96
    v_mul_f32 v122, v122, v96
    v_mul_f32_e64 v123, v123, v96
    v_pk_mul_f32 v[124:125], v[124:125], v[100:101] op_sel_hi:[1,0]
    v_pk_mul_f32 v[126:127], v[126:127], v[100:101] op_sel_hi:[1,0]
    v_cvt_pk_bf16_f32 v112, v120, v121
    v_cvt_pk_bf16_f32 v113, v122, v123
    v_cvt_pk_bf16_f32 v114, v124, v125
    v_cvt_pk_bf16_f32 v115, v126, v127
    s_nop 0
    v_permlane16_swap_b32 v112, v114
    v_permlane16_swap_b32 v113, v115
    buffer_store_dwordx4 v[112:115], v2, s[4:7], s22 offen
    v_pk_mul_f32 v[128:129], v[128:129], v[104:105] op_sel_hi:[1,0]
    v_pk_mul_f32 v[130:131], v[130:131], v[104:105] op_sel_hi:[1,0]
    v_pk_mul_f32 v[132:133], v[132:133], v[108:109] op_sel_hi:[1,0]
    v_pk_mul_f32 v[134:135], v[134:135], v[108:109] op_sel_hi:[1,0]
    v_cvt_pk_bf16_f32 v116, v128, v129
    v_cvt_pk_bf16_f32 v117, v130, v131
    v_cvt_pk_bf16_f32 v118, v132, v133
    v_cvt_pk_bf16_f32 v119, v134, v135
    s_nop 0
    v_permlane16_swap_b32 v116, v118
    v_permlane16_swap_b32 v117, v119
    buffer_store_dwordx4 v[116:119], v2, s[4:7], s23 offen
    buffer_load_dwordx4 a[56:59], v7, s[4:7], s8 offen offset:1024
    v_add_u32 v7, s94, v1
    buffer_load_dwordx4 a[52:55], v7, s[4:7], s8 offen
    buffer_load_dwordx4 a[60:63], v7, s[4:7], s8 offen offset:1024
    buffer_load_dwordx4 a[68:71], v7, s[4:7], s9 offen
    buffer_load_dwordx4 a[76:79], v7, s[4:7], s9 offen offset:1024
    v_bfe_u32 v142, v1, 8, 1
    v_lshrrev_b32 v143, 9, v1
    v_lshlrev_b32 v142, 11, v142
    v_lshl_add_u32 v142, v143, 8, v142
    v_and_b32 v143, 0xf0, v1
    s_lshl_b32 s34, s28, 9
    s_add_u32 s34, s34, 131072
    v_add3_u32 v142, v142, v143, s34
    ds_write_b128 v142, v[112:115] offset:0
    ds_write_b128 v142, v[116:119] offset:4096
    s_lshl_b32 s34, s28, 11
    s_add_u32 s34, s34, 131072
    v_add_u32 v143, s34, v1
    v_lshlrev_b32 v28, 16, v8
    v_and_b32 v29, s41, v8
    v_lshlrev_b32 v30, 16, v9
    v_and_b32 v31, s41, v9
    v_lshlrev_b32 v32, 16, v10
    v_and_b32 v33, s41, v10
    v_lshlrev_b32 v34, 16, v11
    v_and_b32 v35, s41, v11
    v_lshlrev_b32 v36, 16, v12
    v_and_b32 v37, s41, v12
    v_lshlrev_b32 v38, 16, v13
    v_and_b32 v39, s41, v13
    v_lshlrev_b32 v40, 16, v14
    v_and_b32 v41, s41, v14
    v_lshlrev_b32 v42, 16, v15
    v_and_b32 v43, s41, v15
    s_mul_i32 s34, s28, 44032
    s_add_u32 s34, s34, s86
    s_add_u32 s34, s34, 21798912
    v_add_u32 v140, s34, v1
    s_lshl_b32 s35, s29, 11
    s_add_u32 s99, s63, s35
    s_add_u32 s99, s99, s44
    s_add_u32 s99, s99, 3448832
    s_lshl_b32 s34, s30, 13
    s_lshl_b32 s35, s29, 10
    s_add_u32 s34, s34, s35
    s_lshl_b32 s35, s28, 8
    s_add_u32 s34, s34, s35
    s_add_u32 s34, s34, 9740288
    v_bfe_u32 v141, v1, 4, 4
    v_lshl_add_u32 v141, v141, 4, s34
    v_mov_b32 v5, 1879048192
    s_mov_b32 vcc_lo, 0x00f0000f
    s_mov_b32 vcc_hi, 0xf0000f00
    v_cndmask_b32 v141, v5, v141, vcc
    s_mov_b32 s76, 0x22222222
    s_mov_b32 s77, 0x22222222
    s_mov_b32 s78, 0x44444444
    s_mov_b32 s79, 0x44444444
    s_mov_b32 s80, 0x88888888
    s_mov_b32 s81, 0x88888888
    s_lshr_b32 s34, s28, 1
    s_and_b32 s35, s28, 1
    s_lshl_b32 s87, s28, 13
    s_lshl_b32 s0, s35, 4
    s_add_u32 s0, s0, s34
    s_lshl_b32 s0, s0, 10
    v_add_u32 v6, s45, 0
    s_cmp_eq_u32 s46, 0
    s_mov_b64 exec, s[72:73]
    s_waitcnt vmcnt(5)
    s_cbranch_scc1 L9s
    buffer_store_dword v6, v3, s[4:7], 0 offen
L9:
    s_mov_b64 exec, -1
    v_lshrrev_b32 v0, 8, v1
    v_lshlrev_b32 v0, 4, v0
    s_add_u32 s34, s47, 148480
    v_add_u32 v0, s34, v0
    s_mov_b32 exec_lo, 0x00010001
    s_mov_b32 exec_hi, 0x00010001
    ds_write_b128 v0, v[80:83] offset:0
    ds_write_b128 v0, v[88:91] offset:64
    s_mov_b64 exec, -1
    v_lshrrev_b32 v5, 2, v1
    v_add_u32 v5, s34, v5
    s_mov_b64 exec, 0xffff
    ds_write_b32 v5, v84 offset:320
    s_mov_b64 exec, -1
    s_waitcnt lgkmcnt(3)
    s_barrier
    buffer_load_dwordx4 a[84:87], v7, s[4:7], s10 offen
    buffer_load_dwordx4 a[92:95], v7, s[4:7], s10 offen offset:1024
    buffer_load_dwordx4 a[100:103], v7, s[4:7], s11 offen
    ds_read_b128 v[108:111], v143 offset:0
    ds_read_b128 v[112:115], v143 offset:1024
    ds_read_b128 v[44:47], v1 offset:0
    ds_read_b128 v[48:51], v1 offset:4096
    ds_read_b128 v[52:55], v1 offset:1024
    ds_read_b128 v[56:59], v1 offset:5120
    ds_read_b128 v[60:63], v1 offset:2048
    ds_read_b128 v[64:67], v1 offset:6144
    ds_read_b128 v[68:71], v1 offset:3072
    ds_read_b128 v[72:75], v1 offset:7168
    ds_read_b128 v[76:79], v1 offset:16384
    ds_read_b128 v[80:83], v1 offset:20480
    ds_read_b128 v[84:87], v1 offset:17408
    ds_read_b128 v[88:91], v1 offset:21504
    ds_read_b128 v[92:95], v1 offset:18432
    ds_read_b128 v[96:99], v1 offset:22528
    ds_read_b128 v[100:103], v1 offset:19456
    s_cmp_lg_u32 s28, 0
    s_cbranch_scc1 L10
    s_cmp_eq_u32 s46, 0
    s_cbranch_scc1 L10s
    s_mov_b32 s91, 524288
    s_add_u32 s82, s45, 0
L10q:
    buffer_load_dword v5, v3, s[4:7], 0 offen sc1
    s_sub_u32 s91, s91, 1
    s_cbranch_scc1 L10
    s_waitcnt vmcnt(0)
    v_subrev_u32 v5, s82, v5
    v_cmp_lt_u32 vcc, 15, v5
    s_nop 3
    s_cbranch_vccnz L10q
L10:
    s_barrier
    buffer_load_dwordx4 v[116:119], v140, s[4:7], s9 offen sc1
    s_waitcnt lgkmcnt(14)
    v_mfma_f32_16x16x32_bf16 v[28:31], v[44:47], v[108:111], v[28:31]
    ds_read_b128 v[104:107], v1 offset:23552
    s_waitcnt lgkmcnt(14)
    v_mfma_f32_16x16x32_bf16 v[28:31], v[48:51], v[112:115], v[28:31]
    buffer_load_dwordx4 v[120:123], v140, s[4:7], s9 offen offset:1024 sc1
    ds_read_b128 v[44:47], v1 offset:32768
    s_waitcnt lgkmcnt(13)
    v_mfma_f32_16x16x32_bf16 v[32:35], v[52:55], v[108:111], v[32:35]
    buffer_load_dwordx4 v[124:127], v140, s[4:7], s10 offen sc1
    ds_read_b128 v[48:51], v1 offset:36864
    v_mfma_f32_16x16x32_bf16 v[32:35], v[56:59], v[112:115], v[32:35]
    ds_read_b128 v[52:55], v1 offset:33792
    s_waitcnt lgkmcnt(11)
    buffer_load_dwordx4 v[128:131], v140, s[4:7], s10 offen offset:1024 sc1
    v_mfma_f32_16x16x32_bf16 v[36:39], v[60:63], v[108:111], v[36:39]
    ds_read_b128 v[56:59], v1 offset:37888
    v_mfma_f32_16x16x32_bf16 v[36:39], v[64:67], v[112:115], v[36:39]
    buffer_load_dwordx4 v[132:135], v140, s[4:7], s11 offen sc1
    ds_read_b128 v[60:63], v1 offset:34816
    v_mfma_f32_16x16x32_bf16 v[40:43], v[68:71], v[108:111], v[40:43]
    buffer_load_dwordx4 v[136:139], v140, s[4:7], s11 offen offset:1024 sc1
    ds_read_b128 v[64:67], v1 offset:38912
    v_mfma_f32_16x16x32_bf16 v[40:43], v[72:75], v[112:115], v[40:43]
    ds_read_b128 v[68:71], v1 offset:35840
    s_waitcnt vmcnt(5) lgkmcnt(11)
    v_mfma_f32_16x16x32_bf16 v[28:31], v[76:79], v[116:119], v[28:31]
    buffer_load_dwordx4 v[108:111], v140, s[4:7], s33 offen sc1
    s_waitcnt vmcnt(5)
    v_mfma_f32_16x16x32_bf16 v[28:31], v[80:83], v[120:123], v[28:31]
    ds_read_b128 v[72:75], v1 offset:39936
    v_mfma_f32_16x16x32_bf16 v[32:35], v[84:87], v[116:119], v[32:35]
    ds_read_b128 v[76:79], v1 offset:49152
    v_mfma_f32_16x16x32_bf16 v[32:35], v[88:91], v[120:123], v[32:35]
    ds_read_b128 v[80:83], v1 offset:53248
    s_waitcnt lgkmcnt(10)
    v_mfma_f32_16x16x32_bf16 v[36:39], v[92:95], v[116:119], v[36:39]
    buffer_load_dwordx4 v[112:115], v140, s[4:7], s33 offen offset:1024 sc1
    v_mfma_f32_16x16x32_bf16 v[36:39], v[96:99], v[120:123], v[36:39]
    ds_read_b128 v[84:87], v1 offset:50176
    v_mfma_f32_16x16x32_bf16 v[40:43], v[100:103], v[116:119], v[40:43]
    ds_read_b128 v[88:91], v1 offset:54272
    v_mfma_f32_16x16x32_bf16 v[40:43], v[104:107], v[120:123], v[40:43]
    ds_read_b128 v[92:95], v1 offset:51200
    s_waitcnt vmcnt(5) lgkmcnt(9)
    v_mfma_f32_16x16x32_bf16 v[28:31], v[44:47], v[124:127], v[28:31]
    buffer_load_dwordx4 v[116:119], v140, s[4:7], s40 offen sc1
    s_waitcnt vmcnt(5)
    v_mfma_f32_16x16x32_bf16 v[28:31], v[48:51], v[128:131], v[28:31]
    ds_read_b128 v[96:99], v1 offset:55296
    v_mfma_f32_16x16x32_bf16 v[32:35], v[52:55], v[124:127], v[32:35]
    ds_read_b128 v[100:103], v1 offset:52224
    v_mfma_f32_16x16x32_bf16 v[32:35], v[56:59], v[128:131], v[32:35]
    ds_read_b128 v[104:107], v1 offset:56320
    s_waitcnt lgkmcnt(8)
    v_mfma_f32_16x16x32_bf16 v[36:39], v[60:63], v[124:127], v[36:39]
    buffer_load_dwordx4 v[120:123], v140, s[4:7], s40 offen offset:1024 sc1
    v_mfma_f32_16x16x32_bf16 v[36:39], v[64:67], v[128:131], v[36:39]
    ds_read_b128 v[44:47], v1 offset:8192
    v_mfma_f32_16x16x32_bf16 v[40:43], v[68:71], v[124:127], v[40:43]
    ds_read_b128 v[48:51], v1 offset:12288
    v_mfma_f32_16x16x32_bf16 v[40:43], v[72:75], v[128:131], v[40:43]
    ds_read_b128 v[52:55], v1 offset:9216
    s_waitcnt vmcnt(5) lgkmcnt(7)
    v_mfma_f32_16x16x32_bf16 v[28:31], v[76:79], v[132:135], v[28:31]
    buffer_load_dwordx4 v[124:127], v140, s[4:7], s84 offen sc1
    s_waitcnt vmcnt(5)
    v_mfma_f32_16x16x32_bf16 v[28:31], v[80:83], v[136:139], v[28:31]
    ds_read_b128 v[56:59], v1 offset:13312
    v_mfma_f32_16x16x32_bf16 v[32:35], v[84:87], v[132:135], v[32:35]
    ds_read_b128 v[60:63], v1 offset:10240
    v_mfma_f32_16x16x32_bf16 v[32:35], v[88:91], v[136:139], v[32:35]
    ds_read_b128 v[64:67], v1 offset:14336
    s_waitcnt lgkmcnt(6)
    v_mfma_f32_16x16x32_bf16 v[36:39], v[92:95], v[132:135], v[36:39]
    buffer_load_dwordx4 v[128:131], v140, s[4:7], s84 offen offset:1024 sc1
    v_mfma_f32_16x16x32_bf16 v[36:39], v[96:99], v[136:139], v[36:39]
    ds_read_b128 v[68:71], v1 offset:11264
    v_mfma_f32_16x16x32_bf16 v[40:43], v[100:103], v[132:135], v[40:43]
    ds_read_b128 v[72:75], v1 offset:15360
    v_mfma_f32_16x16x32_bf16 v[40:43], v[104:107], v[136:139], v[40:43]
    ds_read_b128 v[76:79], v1 offset:24576
    s_waitcnt vmcnt(5) lgkmcnt(7)
    v_mfma_f32_16x16x32_bf16 v[28:31], v[44:47], v[108:111], v[28:31]
    buffer_load_dwordx4 v[132:135], v140, s[4:7], s38 offen sc1
    s_waitcnt vmcnt(5)
    v_mfma_f32_16x16x32_bf16 v[28:31], v[48:51], v[112:115], v[28:31]
    ds_read_b128 v[80:83], v1 offset:28672
    s_waitcnt lgkmcnt(6)
    v_mfma_f32_16x16x32_bf16 v[32:35], v[52:55], v[108:111], v[32:35]
    ds_read_b128 v[84:87], v1 offset:25600
    v_mfma_f32_16x16x32_bf16 v[32:35], v[56:59], v[112:115], v[32:35]
    ds_read_b128 v[88:91], v1 offset:29696
    s_waitcnt lgkmcnt(6)
    v_mfma_f32_16x16x32_bf16 v[36:39], v[60:63], v[108:111], v[36:39]
    buffer_load_dwordx4 v[136:139], v140, s[4:7], s38 offen offset:1024 sc1
    v_mfma_f32_16x16x32_bf16 v[36:39], v[64:67], v[112:115], v[36:39]
    ds_read_b128 v[92:95], v1 offset:26624
    s_waitcnt lgkmcnt(5)
    v_mfma_f32_16x16x32_bf16 v[40:43], v[68:71], v[108:111], v[40:43]
    ds_read_b128 v[96:99], v1 offset:30720
    v_mfma_f32_16x16x32_bf16 v[40:43], v[72:75], v[112:115], v[40:43]
    ds_read_b128 v[100:103], v1 offset:27648
    s_waitcnt vmcnt(5) lgkmcnt(5)
    v_mfma_f32_16x16x32_bf16 v[28:31], v[76:79], v[116:119], v[28:31]
    ds_read_b128 v[104:107], v1 offset:31744
    s_waitcnt vmcnt(4)
    v_mfma_f32_16x16x32_bf16 v[28:31], v[80:83], v[120:123], v[28:31]
    ds_read_b128 v[44:47], v1 offset:40960
    s_waitcnt lgkmcnt(5)
    v_mfma_f32_16x16x32_bf16 v[32:35], v[84:87], v[116:119], v[32:35]
    ds_read_b128 v[48:51], v1 offset:45056
    v_mfma_f32_16x16x32_bf16 v[32:35], v[88:91], v[120:123], v[32:35]
    ds_read_b128 v[52:55], v1 offset:41984
    s_waitcnt lgkmcnt(5)
    v_mfma_f32_16x16x32_bf16 v[36:39], v[92:95], v[116:119], v[36:39]
    ds_read_b128 v[56:59], v1 offset:46080
    v_mfma_f32_16x16x32_bf16 v[36:39], v[96:99], v[120:123], v[36:39]
    ds_read_b128 v[60:63], v1 offset:43008
    s_waitcnt lgkmcnt(5)
    v_mfma_f32_16x16x32_bf16 v[40:43], v[100:103], v[116:119], v[40:43]
    ds_read_b128 v[64:67], v1 offset:47104
    v_mfma_f32_16x16x32_bf16 v[40:43], v[104:107], v[120:123], v[40:43]
    ds_read_b128 v[68:71], v1 offset:44032
    s_waitcnt vmcnt(3) lgkmcnt(5)
    v_mfma_f32_16x16x32_bf16 v[28:31], v[44:47], v[124:127], v[28:31]
    ds_read_b128 v[72:75], v1 offset:48128
    s_waitcnt vmcnt(2)
    v_mfma_f32_16x16x32_bf16 v[28:31], v[48:51], v[128:131], v[28:31]
    ds_read_b128 v[76:79], v1 offset:57344
    s_waitcnt lgkmcnt(5)
    v_mfma_f32_16x16x32_bf16 v[32:35], v[52:55], v[124:127], v[32:35]
    ds_read_b128 v[80:83], v1 offset:61440
    v_mfma_f32_16x16x32_bf16 v[32:35], v[56:59], v[128:131], v[32:35]
    ds_read_b128 v[84:87], v1 offset:58368
    s_waitcnt lgkmcnt(5)
    v_mfma_f32_16x16x32_bf16 v[36:39], v[60:63], v[124:127], v[36:39]
    ds_read_b128 v[88:91], v1 offset:62464
    v_mfma_f32_16x16x32_bf16 v[36:39], v[64:67], v[128:131], v[36:39]
    ds_read_b128 v[92:95], v1 offset:59392
    s_waitcnt lgkmcnt(5)
    v_mfma_f32_16x16x32_bf16 v[40:43], v[68:71], v[124:127], v[40:43]
    ds_read_b128 v[96:99], v1 offset:63488
    v_mfma_f32_16x16x32_bf16 v[40:43], v[72:75], v[128:131], v[40:43]
    ds_read_b128 v[100:103], v1 offset:60416
    s_waitcnt vmcnt(1) lgkmcnt(5)
    v_mfma_f32_16x16x32_bf16 v[28:31], v[76:79], v[132:135], v[28:31]
    ds_read_b128 v[104:107], v1 offset:64512
    s_waitcnt vmcnt(0)
    v_mfma_f32_16x16x32_bf16 v[28:31], v[80:83], v[136:139], v[28:31]
    s_waitcnt lgkmcnt(4)
    v_mfma_f32_16x16x32_bf16 v[32:35], v[84:87], v[132:135], v[32:35]
    v_mfma_f32_16x16x32_bf16 v[32:35], v[88:91], v[136:139], v[32:35]
    s_waitcnt lgkmcnt(2)
    v_mfma_f32_16x16x32_bf16 v[36:39], v[92:95], v[132:135], v[36:39]
    v_mfma_f32_16x16x32_bf16 v[36:39], v[96:99], v[136:139], v[36:39]
    s_waitcnt lgkmcnt(0)
    v_mfma_f32_16x16x32_bf16 v[40:43], v[100:103], v[132:135], v[40:43]
    v_mfma_f32_16x16x32_bf16 v[40:43], v[104:107], v[136:139], v[40:43]
    v_cvt_pk_bf16_f32 v8, v28, v29
    v_cvt_pk_bf16_f32 v9, v30, v31
    v_cvt_pk_bf16_f32 v10, v32, v33
    v_cvt_pk_bf16_f32 v11, v34, v35
    s_nop 0
    v_cvt_pk_bf16_f32 v12, v36, v37
    v_cvt_pk_bf16_f32 v13, v38, v39
    s_nop 0
    v_cvt_pk_bf16_f32 v14, v40, v41
    v_cvt_pk_bf16_f32 v15, v42, v43
    v_mfma_f32_16x16x32_bf16 v[44:47], v[8:11], v[8:11], 0
    buffer_store_dwordx4 v[8:11], v1, s[4:7], s99 offen
    v_mfma_f32_16x16x32_bf16 v[44:47], v[12:15], v[12:15], v[44:47]
    v_mfma_f32_16x16x32_bf16 v[48:51], v[24:27], v[8:11], 0
    v_mfma_f32_16x16x32_bf16 v[48:51], v[24:27], v[12:15], v[48:51]
    buffer_store_dwordx4 v[12:15], v1, s[4:7], s99 offen offset:1024
    s_nop 4
    v_cndmask_b32 v44, v44, v45, s[76:77]
    v_cndmask_b32 v44, v44, v46, s[78:79]
    v_cndmask_b32 v49, v44, v47, s[80:81]
    v_mov_b32 v50, 0
    v_mov_b32 v51, 0
    buffer_store_dwordx4 v[48:51], v141, s[4:7], 0 offen
    buffer_load_dwordx4 a[108:111], v7, s[4:7], s11 offen offset:1024
    buffer_load_dwordx4 a[116:119], v7, s[4:7], s33 offen
    buffer_load_dwordx4 a[124:127], v7, s[4:7], s33 offen offset:1024
    buffer_load_dwordx4 a[132:135], v7, s[4:7], s40 offen
    buffer_load_dwordx4 a[140:143], v7, s[4:7], s40 offen offset:1024
    v_add_u32 v142, 139264, v1
    v_lshl_add_u32 v143, s47, 1, v142
    ds_write_b128 v143, v[8:11] offset:0
    ds_write_b128 v143, v[12:15] offset:1024
    s_lshl_b32 s85, s30, 13
    s_add_u32 s85, s85, 9740288
    v_bfe_u32 v126, v1, 4, 4
    v_lshrrev_b32 v127, 8, v1
    v_lshrrev_b32 v128, 8, s47
    v_lshlrev_b32 v134, 11, v127
    v_lshl_add_u32 v134, v126, 4, v134
    v_lshl_add_u32 v134, v128, 6, v134
    v_lshl_add_u32 v135, v126, 4, v128
    v_lshlrev_b32 v128, 4, v128
    v_lshl_add_u32 v126, v126, 2, v128
    s_mov_b32 vcc_lo, -1
    s_mov_b32 vcc_hi, 0
    v_cndmask_b32 v135, v126, v135, vcc
    v_lshl_add_u32 v135, v127, 8, v135
    v_add_u32 v135, 147456, v135
    s_add_u32 s34, s44, 3448832
    v_add_u32 v136, s34, v1
    s_add_u32 s34, s8, s47
    s_add_u32 s24, s34, 4096
    s_and_b32 s24, s24, 0x3fff
    s_add_u32 s25, s34, 8192
    s_and_b32 s25, s25, 0x3fff
    s_add_u32 s26, s34, 12288
    s_and_b32 s26, s26, 0x3fff
    s_lshr_b32 s34, s28, 1
    s_lshl_b32 s34, s34, 4
    s_and_b32 s35, s28, 1
    s_add_u32 s34, s34, s35
    s_lshl_b32 s3, s34, 10
    buffer_load_dwordx4 a[148:151], v7, s[4:7], s84 offen
    s_add_u32 s27, s3, s9
    s_lshl_b32 s35, s31, 9
    s_add_u32 s34, s86, s35
    s_add_u32 s34, s34, 21798912
    v_add_u32 v137, s34, v2
    s_lshl_b32 s35, s92, 9
    s_add_u32 s35, s35, s86
    s_add_u32 s35, s35, 21798912
    s_cmp_lt_u32 s92, 22
    s_cselect_b32 s35, s35, 1879048192
    v_add_u32 v138, s35, v2
    v_mov_b32 v139, s74
    buffer_load_dwordx4 a[156:159], v7, s[4:7], s84 offen offset:1024
    v_and_b32 v140, 0xf0, v1
    v_add_u32 v140, 147456, v140
    s_lshr_b32 s34, s28, 1
    s_and_b32 s35, s28, 1
    s_lshl_b32 s36, s29, 1
    s_add_u32 s35, s35, s36
    s_lshl_b32 s36, s34, 4
    s_add_u32 s36, s36, s35
    s_lshl_b32 s100, s36, 10
    v_add_u32 v143, s47, v142
    s_mul_i32 s34, s34, 44032
    s_mul_i32 s35, s28, 0
    s_add_u32 s35, s35, s86
    v_add_u32 v6, s45, 1
    s_cmp_eq_u32 s46, 0
    s_mov_b64 exec, s[72:73]
    s_waitcnt vmcnt(7)
    s_cbranch_scc1 L11s
    buffer_store_dword v6, v3, s[4:7], 0 offen
L11:
    s_mov_b64 exec, -1
    buffer_load_dwordx4 a[164:167], v7, s[4:7], s38 offen
    s_add_u32 s35, s35, 21798912
    s_add_u32 s99, s35, s34
    s_sub_u32 s101, s35, s34
    s_add_u32 s101, s101, 44032
    v_lshrrev_b32 v0, 8, v1
    v_lshlrev_b32 v0, 4, v0
    s_add_u32 s34, s47, 148480
    v_add_u32 v0, s34, v0
    ds_read_b128 v[108:111], v0 offset:384
    ds_read_b128 v[112:115], v0 offset:448
    ds_read_b128 v[116:119], v0 offset:512
    v_mfma_f32_16x16x32_bf16 v[104:107], v[192:195], v[24:27], 0
    buffer_load_dwordx4 a[172:175], v7, s[4:7], s38 offen offset:1024
    v_mfma_f32_16x16x32_bf16 v[104:107], v[196:199], v[24:27], v[104:107]
    v_mfma_f32_16x16x32_bf16 v[104:107], v[200:203], v[24:27], v[104:107]
    v_mfma_f32_16x16x32_bf16 v[104:107], v[204:207], v[24:27], v[104:107]
    v_add_u32 v7, s93, v1
    buffer_load_dwordx4 a[168:171], v7, s[4:7], s38 offen offset:1024
    v_mfma_f32_16x16x32_bf16 v[104:107], v[208:211], v[24:27], v[104:107]
    v_mfma_f32_16x16x32_bf16 v[104:107], v[212:215], v[24:27], v[104:107]
    v_mfma_f32_16x16x32_bf16 v[104:107], v[216:219], v[24:27], v[104:107]
    buffer_load_dwordx4 a[160:163], v7, s[4:7], s38 offen
    v_mfma_f32_16x16x32_bf16 v[104:107], v[220:223], v[24:27], v[104:107]
    v_mfma_f32_16x16x32_bf16 v[104:107], v[224:227], v[24:27], v[104:107]
    v_mfma_f32_16x16x32_bf16 v[104:107], v[228:231], v[24:27], v[104:107]
    buffer_load_dwordx4 a[152:155], v7, s[4:7], s84 offen offset:1024
    v_mfma_f32_16x16x32_bf16 v[104:107], v[232:235], v[24:27], v[104:107]
    v_mfma_f32_16x16x32_bf16 v[104:107], v[236:239], v[24:27], v[104:107]
    v_mfma_f32_16x16x32_bf16 v[104:107], v[240:243], v[24:27], v[104:107]
    buffer_load_dwordx4 a[144:147], v7, s[4:7], s84 offen
    v_mfma_f32_16x16x32_bf16 v[104:107], v[244:247], v[24:27], v[104:107]
    v_mfma_f32_16x16x32_bf16 v[104:107], v[248:251], v[24:27], v[104:107]
    v_mfma_f32_16x16x32_bf16 v[104:107], v[252:255], v[24:27], v[104:107]
    s_waitcnt lgkmcnt(3)
    s_barrier
    buffer_load_dwordx4 a[136:139], v7, s[4:7], s40 offen offset:1024
    buffer_load_dwordx4 a[128:131], v7, s[4:7], s40 offen
    buffer_load_dwordx4 a[120:123], v7, s[4:7], s33 offen offset:1024
    buffer_load_dwordx4 a[112:115], v7, s[4:7], s33 offen
    ds_read_b128 v[76:79], v142 offset:0
    ds_read_b128 v[80:83], v142 offset:1024
    ds_read_b128 v[84:87], v142 offset:2048
    ds_read_b128 v[88:91], v142 offset:3072
    s_waitcnt lgkmcnt(3)
    v_mfma_f32_16x16x32_bf16 v[28:31], a[48:51], v[76:79], 0
    ds_read_b128 v[92:95], v142 offset:4096
    s_waitcnt lgkmcnt(3)
    v_mfma_f32_16x16x32_bf16 v[28:31], a[56:59], v[80:83], v[28:31]
    buffer_load_dwordx4 a[104:107], v7, s[4:7], s11 offen offset:1024
    v_mfma_f32_16x16x32_bf16 v[44:47], a[52:55], v[76:79], 0
    v_mfma_f32_16x16x32_bf16 v[44:47], a[60:63], v[80:83], v[44:47]
    ds_read_b128 v[12:15], v142 offset:5120
    v_mfma_f32_16x16x32_bf16 v[60:63], v[192:195], v[76:79], 0
    buffer_load_dwordx4 a[96:99], v7, s[4:7], s11 offen
    v_mfma_f32_16x16x32_bf16 v[60:63], v[196:199], v[80:83], v[60:63]
    s_waitcnt lgkmcnt(2)
    v_mfma_f32_16x16x32_bf16 v[32:35], a[48:51], v[84:87], 0
    ds_read_b128 v[76:79], v142 offset:6144
    v_mfma_f32_16x16x32_bf16 v[32:35], a[56:59], v[88:91], v[32:35]
    v_mfma_f32_16x16x32_bf16 v[48:51], a[52:55], v[84:87], 0
    buffer_load_dwordx4 a[88:91], v7, s[4:7], s10 offen offset:1024
    v_mfma_f32_16x16x32_bf16 v[48:51], a[60:63], v[88:91], v[48:51]
    ds_read_b128 v[80:83], v142 offset:7168
    v_mfma_f32_16x16x32_bf16 v[64:67], v[192:195], v[84:87], 0
    v_mfma_f32_16x16x32_bf16 v[64:67], v[196:199], v[88:91], v[64:67]
    s_waitcnt lgkmcnt(2)
    v_mfma_f32_16x16x32_bf16 v[36:39], a[48:51], v[92:95], 0
    buffer_load_dwordx4 a[80:83], v7, s[4:7], s10 offen
    v_mfma_f32_16x16x32_bf16 v[36:39], a[56:59], v[12:15], v[36:39]
    v_mfma_f32_16x16x32_bf16 v[52:55], a[52:55], v[92:95], 0
    v_mfma_f32_16x16x32_bf16 v[52:55], a[60:63], v[12:15], v[52:55]
    v_mfma_f32_16x16x32_bf16 v[68:71], v[192:195], v[92:95], 0
    buffer_load_dwordx4 a[72:75], v7, s[4:7], s9 offen offset:1024
    v_mfma_f32_16x16x32_bf16 v[68:71], v[196:199], v[12:15], v[68:71]
    s_waitcnt lgkmcnt(0)
    v_mfma_f32_16x16x32_bf16 v[40:43], a[48:51], v[76:79], 0
    v_mfma_f32_16x16x32_bf16 v[40:43], a[56:59], v[80:83], v[40:43]
    v_mfma_f32_16x16x32_bf16 v[56:59], a[52:55], v[76:79], 0
    buffer_load_dwordx4 a[64:67], v7, s[4:7], s9 offen
    v_mfma_f32_16x16x32_bf16 v[56:59], a[60:63], v[80:83], v[56:59]
    v_mfma_f32_16x16x32_bf16 v[72:75], v[192:195], v[76:79], 0
    v_mfma_f32_16x16x32_bf16 v[72:75], v[196:199], v[80:83], v[72:75]
    v_mfma_f32_16x16x32_bf16 v[100:103], a[52:55], v[24:27], 0
    v_mfma_f32_16x16x32_bf16 v[100:103], a[60:63], v[24:27], v[100:103]
    v_mfma_f32_16x16x32_bf16 v[100:103], a[68:71], v[24:27], v[100:103]
    v_mfma_f32_16x16x32_bf16 v[100:103], a[76:79], v[24:27], v[100:103]
    v_mfma_f32_16x16x32_bf16 v[100:103], a[84:87], v[24:27], v[100:103]
    v_mfma_f32_16x16x32_bf16 v[100:103], a[92:95], v[24:27], v[100:103]
    v_mfma_f32_16x16x32_bf16 v[100:103], a[100:103], v[24:27], v[100:103]
    s_waitcnt vmcnt(23)
    v_mfma_f32_16x16x32_bf16 v[100:103], a[108:111], v[24:27], v[100:103]
    s_waitcnt vmcnt(22)
    v_mfma_f32_16x16x32_bf16 v[100:103], a[116:119], v[24:27], v[100:103]
    s_waitcnt vmcnt(21)
    v_mfma_f32_16x16x32_bf16 v[100:103], a[124:127], v[24:27], v[100:103]
    s_waitcnt vmcnt(20)
    v_mfma_f32_16x16x32_bf16 v[100:103], a[132:135], v[24:27], v[100:103]
    s_waitcnt vmcnt(19)
    v_mfma_f32_16x16x32_bf16 v[100:103], a[140:143], v[24:27], v[100:103]
    s_waitcnt vmcnt(18)
    v_mfma_f32_16x16x32_bf16 v[100:103], a[148:151], v[24:27], v[100:103]
    s_waitcnt vmcnt(17)
    v_mfma_f32_16x16x32_bf16 v[100:103], a[156:159], v[24:27], v[100:103]
    s_waitcnt vmcnt(15)
    v_mfma_f32_16x16x32_bf16 v[100:103], a[164:167], v[24:27], v[100:103]
    s_waitcnt vmcnt(14)
    v_mfma_f32_16x16x32_bf16 v[100:103], a[172:175], v[24:27], v[100:103]
    s_mul_i32 s34, s28, 5
    s_add_u32 s34, s34, 2
    s_cmp_lt_u32 s34, 9
    s_cselect_b32 s35, 0, 8
    s_subb_u32 s59, s34, 0
    s_add_u32 s59, s59, s29
    s_and_b32 s59, s59, 7
    s_add_u32 s59, s59, s35
    s_cmp_lt_u32 s34, 16
    s_cselect_b32 s59, s59, s34
    s_lshl_b32 s59, s59, 11
    s_mul_i32 s34, s28, 5
    s_add_u32 s34, s34, 3
    s_cmp_lt_u32 s34, 9
    s_cselect_b32 s35, 0, 8
    s_subb_u32 s60, s34, 0
    s_add_u32 s60, s60, s29
    s_and_b32 s60, s60, 7
    s_add_u32 s60, s60, s35
    s_cmp_lt_u32 s34, 16
    s_cselect_b32 s60, s60, s34
    s_lshl_b32 s60, s60, 11
    s_mul_i32 s34, s28, 5
    s_add_u32 s34, s34, 4
    s_cmp_lt_u32 s34, 9
    s_cselect_b32 s35, 0, 8
    s_subb_u32 s61, s34, 0
    s_add_u32 s61, s61, s29
    s_and_b32 s61, s61, 7
    s_add_u32 s61, s61, s35
    s_cmp_lt_u32 s34, 16
    s_cselect_b32 s61, s61, s34
    s_lshl_b32 s61, s61, 11
    s_mul_i32 s34, s28, 5
    s_add_u32 s34, s34, 5
    s_cmp_lt_u32 s34, 9
    s_cselect_b32 s35, 0, 8
    s_subb_u32 s62, s34, 0
    s_add_u32 s62, s62, s29
    s_and_b32 s62, s62, 7
    s_add_u32 s62, s62, s35
    s_cmp_lt_u32 s34, 16
    s_cselect_b32 s62, s62, s34
    s_lshl_b32 s62, s62, 11
    s_mul_i32 s34, s28, 5
    s_add_u32 s34, s34, 6
    s_cmp_lt_u32 s34, 9
    s_cselect_b32 s35, 0, 8
    s_subb_u32 s2, s34, 0
    s_add_u32 s2, s2, s29
    s_and_b32 s2, s2, 7
    s_add_u32 s2, s2, s35
    s_cmp_lt_u32 s34, 16
    s_cselect_b32 s2, s2, s34
    s_lshl_b32 s2, s2, 11
    s_cmp_lt_u32 s28, 3
    s_cselect_b32 s39, 1024, 0
    s_add_u32 s39, s39, s2
    s_cmp_lg_u32 s28, 0
    s_cbranch_scc1 L12
    s_cmp_eq_u32 s46, 0
    s_cbranch_scc1 L12s
    s_mov_b32 s91, 524288
    s_add_u32 s82, s45, 1
L12q:
    buffer_load_dword v5, v3, s[4:7], 0 offen sc1
    s_sub_u32 s91, s91, 1
    s_cbranch_scc1 L12
    s_waitcnt vmcnt(0)
    v_subrev_u32 v5, s82, v5
    v_cmp_lt_u32 vcc, 14, v5
    s_nop 3
    s_cbranch_vccnz L12q
L12:
    s_barrier
    s_add_u32 m0, s47, 4096
    s_nop 0
    buffer_load_dwordx4 v136, s[4:7], s24 offen sc1 lds
    s_add_u32 m0, s47, 8192
    s_nop 0
    buffer_load_dwordx4 v136, s[4:7], s25 offen sc1 lds
    buffer_load_dwordx4 v[126:129], v134, s[4:7], s85 offen sc1
    v_mfma_f32_16x16x32_bf16 v[96:99], a[48:51], v[24:27], 0
    v_mfma_f32_16x16x32_bf16 v[96:99], a[56:59], v[24:27], v[96:99]
    s_waitcnt vmcnt(3)
    v_mfma_f32_16x16x32_bf16 v[96:99], a[64:67], v[24:27], v[96:99]
    v_mfma_f32_16x16x32_bf16 v[96:99], a[72:75], v[24:27], v[96:99]
    buffer_load_dwordx4 v[130:133], v134, s[4:7], s85 offen offset:1024 sc1
    v_mfma_f32_16x16x32_bf16 v[96:99], a[80:83], v[24:27], v[96:99]
    v_mfma_f32_16x16x32_bf16 v[96:99], a[88:91], v[24:27], v[96:99]
    v_mfma_f32_16x16x32_bf16 v[96:99], a[96:99], v[24:27], v[96:99]
    v_mfma_f32_16x16x32_bf16 v[96:99], a[104:107], v[24:27], v[96:99]
    s_add_u32 m0, s47, 12288
    s_nop 0
    buffer_load_dwordx4 v136, s[4:7], s26 offen sc1 lds
    v_mfma_f32_16x16x32_bf16 v[96:99], a[112:115], v[24:27], v[96:99]
    v_mfma_f32_16x16x32_bf16 v[96:99], a[120:123], v[24:27], v[96:99]
    v_mfma_f32_16x16x32_bf16 v[96:99], a[128:131], v[24:27], v[96:99]
    v_mfma_f32_16x16x32_bf16 v[96:99], a[136:139], v[24:27], v[96:99]
    s_add_u32 m0, s3, 2048
    s_nop 0
    buffer_load_dwordx4 v136, s[4:7], s27 offen sc1 lds
    v_mfma_f32_16x16x32_bf16 v[96:99], a[144:147], v[24:27], v[96:99]
    v_mfma_f32_16x16x32_bf16 v[96:99], a[152:155], v[24:27], v[96:99]
    v_mfma_f32_16x16x32_bf16 v[96:99], a[160:163], v[24:27], v[96:99]
    v_mfma_f32_16x16x32_bf16 v[96:99], a[168:171], v[24:27], v[96:99]
    s_waitcnt vmcnt(5)
    s_barrier
    ds_read_b128 v[76:79], v1 offset:4096
    ds_read_b128 v[80:83], v1 offset:5120
    ds_read_b128 v[84:87], v1 offset:6144
    ds_read_b128 v[88:91], v1 offset:7168
    s_waitcnt lgkmcnt(3)
    v_mfma_f32_16x16x32_bf16 v[28:31], a[80:83], v[76:79], v[28:31]
    s_waitcnt vmcnt(4)
    s_barrier
    ds_read_b128 v[92:95], v1 offset:8192
    s_add_u32 m0, s47, 20480
    v_add_u32 v136, 16384, v136
    s_waitcnt lgkmcnt(3)
    v_mfma_f32_16x16x32_bf16 v[28:31], a[88:91], v[80:83], v[28:31]
    buffer_load_dwordx4 v136, s[4:7], s24 offen sc1 lds
    v_mfma_f32_16x16x32_bf16 v[44:47], a[84:87], v[76:79], v[44:47]
    s_add_u32 m0, s47, 24576
    v_mfma_f32_16x16x32_bf16 v[44:47], a[92:95], v[80:83], v[44:47]
    ds_read_b128 v[12:15], v1 offset:9216
    v_mfma_f32_16x16x32_bf16 v[60:63], v[208:211], v[76:79], v[60:63]
    buffer_load_dwordx4 v136, s[4:7], s25 offen sc1 lds
    v_mfma_f32_16x16x32_bf16 v[60:63], v[212:215], v[80:83], v[60:63]
    s_waitcnt lgkmcnt(2)
    s_add_u32 m0, s47, 28672
    v_mfma_f32_16x16x32_bf16 v[28:31], a[96:99], v[84:87], v[28:31]
    ds_read_b128 v[76:79], v1 offset:10240
    s_waitcnt vmcnt(5)
    v_add_f32 v126, v126, v128
    v_add_f32 v127, v127, v129
    v_mfma_f32_16x16x32_bf16 v[28:31], a[104:107], v[88:91], v[28:31]
    s_waitcnt vmcnt(4)
    v_add_f32 v130, v130, v132
    v_add_f32 v131, v131, v133
    v_mfma_f32_16x16x32_bf16 v[44:47], a[100:103], v[84:87], v[44:47]
    buffer_load_dwordx4 v136, s[4:7], s26 offen sc1 lds
    v_add_f32 v126, v126, v130
    v_add_f32 v127, v127, v131
    v_mfma_f32_16x16x32_bf16 v[44:47], a[108:111], v[88:91], v[44:47]
    ds_read_b128 v[80:83], v1 offset:11264
    s_add_u32 m0, s47, 36864
    v_add_u32 v136, 16384, v136
    v_mfma_f32_16x16x32_bf16 v[60:63], v[216:219], v[84:87], v[60:63]
    v_mov_b32 v128, v126
    v_mov_b32 v129, v127
    v_mfma_f32_16x16x32_bf16 v[60:63], v[220:223], v[88:91], v[60:63]
    s_waitcnt lgkmcnt(2)
    v_permlane32_swap_b32 v126, v128
    v_mfma_f32_16x16x32_bf16 v[28:31], a[112:115], v[92:95], v[28:31]
    s_waitcnt vmcnt(3)
    s_barrier
    ds_read_b128 v[84:87], v1 offset:12288
    v_permlane32_swap_b32 v127, v129
    v_mfma_f32_16x16x32_bf16 v[28:31], a[120:123], v[12:15], v[28:31]
    buffer_load_dwordx4 v136, s[4:7], s24 offen sc1 lds
    v_mfma_f32_16x16x32_bf16 v[44:47], a[116:119], v[92:95], v[44:47]
    s_add_u32 m0, s47, 40960
    v_add_f32 v126, v126, v128
    v_add_f32 v127, v127, v129
    v_mfma_f32_16x16x32_bf16 v[44:47], a[124:127], v[12:15], v[44:47]
    ds_read_b128 v[88:91], v1 offset:13312
    v_mov_b32 v128, v126
    v_mov_b32 v129, v127
    v_mfma_f32_16x16x32_bf16 v[60:63], v[224:227], v[92:95], v[60:63]
    buffer_load_dwordx4 v136, s[4:7], s25 offen sc1 lds
    v_permlane16_swap_b32 v126, v128
    v_mfma_f32_16x16x32_bf16 v[60:63], v[228:231], v[12:15], v[60:63]
    s_waitcnt lgkmcnt(2)
    s_add_u32 m0, s47, 45056
    v_mfma_f32_16x16x32_bf16 v[28:31], a[128:131], v[76:79], v[28:31]
    ds_read_b128 v[92:95], v1 offset:14336
    v_permlane16_swap_b32 v127, v129
    v_mfma_f32_16x16x32_bf16 v[28:31], a[136:139], v[80:83], v[28:31]
    v_add_f32 v126, v126, v128
    v_add_f32 v127, v127, v129
    v_mfma_f32_16x16x32_bf16 v[44:47], a[132:135], v[76:79], v[44:47]
    buffer_load_dwordx4 v136, s[4:7], s26 offen sc1 lds
    v_mul_f32 v126, 0xbb000000, v126
    v_mul_f32 v127, 0x3b000000, v127
    v_mfma_f32_16x16x32_bf16 v[44:47], a[140:143], v[80:83], v[44:47]
    ds_read_b128 v[12:15], v1 offset:15360
    s_add_u32 m0, s3, 34816
    v_fma_f32 v127, -v126, v126, v127
    v_mfma_f32_16x16x32_bf16 v[60:63], v[232:235], v[76:79], v[60:63]
    v_max_f32 v127, 0, v127
    v_add_f32 v128, 0x3727c5ac, v127
    v_mfma_f32_16x16x32_bf16 v[60:63], v[236:239], v[80:83], v[60:63]
    s_waitcnt lgkmcnt(2)
    v_rsq_f32 v128, v128
    v_mfma_f32_16x16x32_bf16 v[28:31], a[144:147], v[84:87], v[28:31]
    ds_read_b128 v[76:79], v1 offset:2048
    buffer_load_dwordx4 v136, s[4:7], s27 offen sc1 lds
    v_mul_f32 v127, v128, v127
    v_mfma_f32_16x16x32_bf16 v[28:31], a[152:155], v[88:91], v[28:31]
    s_add_u32 m0, s47, 53248
    v_add_u32 v136, 16384, v136
    v_fmaak_f32 v127, v127, v128, 0x3727c5ac
    v_mfma_f32_16x16x32_bf16 v[44:47], a[148:151], v[84:87], v[44:47]
    v_rsq_f32 v127, v127
    v_mfma_f32_16x16x32_bf16 v[44:47], a[156:159], v[88:91], v[44:47]
    ds_read_b128 v[80:83], v1 offset:3072
    v_mul_f32 v128, v128, v127
    s_mov_b32 vcc_lo, 0x0000ffff
    v_mfma_f32_16x16x32_bf16 v[60:63], v[240:243], v[84:87], v[60:63]
    buffer_load_dwordx4 v136, s[4:7], s24 offen sc1 lds
    s_mov_b32 vcc_hi, 0x0000ffff
    v_cndmask_b32 v128, v128, v126, vcc
    v_mfma_f32_16x16x32_bf16 v[60:63], v[244:247], v[88:91], v[60:63]
    s_waitcnt lgkmcnt(2)
    s_add_u32 m0, s47, 57344
    ds_write_b32 v135, v128
    v_mfma_f32_16x16x32_bf16 v[28:31], a[160:163], v[92:95], v[28:31]
    s_waitcnt vmcnt(7)
    s_barrier
    ds_read_b128 v[84:87], v1 offset:20480
    v_mfma_f32_16x16x32_bf16 v[28:31], a[168:171], v[12:15], v[28:31]
    v_bfe_u32 v5, v1, 8, 1
    v_lshrrev_b32 v120, 9, v1
    v_mfma_f32_16x16x32_bf16 v[44:47], a[164:167], v[92:95], v[44:47]
    s_mov_b32 exec_lo, 0x00010001
    s_mov_b32 exec_hi, 0x00010001
    ds_write_b128 v0, v[96:99] offset:128
    s_mov_b64 exec, -1
    v_mfma_f32_16x16x32_bf16 v[44:47], a[172:175], v[12:15], v[44:47]
    ds_read_b128 v[88:91], v1 offset:21504
    v_lshlrev_b32 v5, 12, v5
    v_lshl_add_u32 v5, v120, 8, v5
    v_mfma_f32_16x16x32_bf16 v[60:63], v[248:251], v[92:95], v[60:63]
    buffer_load_dwordx4 v136, s[4:7], s25 offen sc1 lds
    v_mfma_f32_16x16x32_bf16 v[60:63], v[252:255], v[12:15], v[60:63]
    s_waitcnt lgkmcnt(4)
    s_mov_b32 exec_lo, 0x00010001
    s_mov_b32 exec_hi, 0x00010001
    ds_write_b128 v0, v[100:103] offset:192
    s_mov_b64 exec, -1
    v_mfma_f32_16x16x32_bf16 v[28:31], a[64:67], v[76:79], v[28:31]
    ds_read_b128 v[92:95], v1 offset:22528
    s_add_u32 m0, s47, 61440
    v_lshrrev_b32 v120, 1, s47
    v_mfma_f32_16x16x32_bf16 v[28:31], a[72:75], v[80:83], v[28:31]
    buffer_load_dwordx4 v136, s[4:7], s26 offen sc1 lds
    v_mfma_f32_16x16x32_bf16 v[44:47], a[68:71], v[76:79], v[44:47]
    s_mov_b32 exec_lo, 0x00010001
    s_mov_b32 exec_hi, 0x00010001
    ds_write_b128 v0, v[104:107] offset:256
    s_mov_b64 exec, -1
    v_mfma_f32_16x16x32_bf16 v[44:47], a[76:79], v[80:83], v[44:47]
    ds_read_b128 v[12:15], v1 offset:23552
    v_lshrrev_b32 v142, 8, v1
    v_lshl_add_u32 v142, v142, 14, s90
    v_mfma_f32_16x16x32_bf16 v[60:63], v[200:203], v[76:79], v[60:63]
    v_min_u32 v142, M_done-interleave_layers__linear_kernel_hedgehog__mixer_channel_mlp__prompt_kernel-128, v142
    v_add3_u32 v5, v5, v120, v140
    v_mfma_f32_16x16x32_bf16 v[60:63], v[204:207], v[80:83], v[60:63]
    s_waitcnt lgkmcnt(4)
    v_subrev_u32 v5, 16384, v5
    v_mfma_f32_16x16x32_bf16 v[32:35], a[80:83], v[84:87], v[32:35]
    s_waitcnt vmcnt(7)
    s_barrier
    ds_read_b128 v[76:79], v1 offset:24576
    v_mfma_f32_16x16x32_bf16 v[32:35], a[88:91], v[88:91], v[32:35]
    global_load_dword v142, v142, s[88:89]
    v_mfma_f32_16x16x32_bf16 v[48:51], a[84:87], v[84:87], v[48:51]
    ds_read_b128 v[120:123], v140
    ds_read_b128 v[124:127], v140 offset:256
    v_mfma_f32_16x16x32_bf16 v[48:51], a[92:95], v[88:91], v[48:51]
    ds_read_b128 v[80:83], v1 offset:25600
    v_mfma_f32_16x16x32_bf16 v[64:67], v[208:211], v[84:87], v[64:67]
    v_add_u32 v7, s96, v1
    buffer_load_dwordx4 a[0:3], v7, s[4:7], 0 offen
    v_mfma_f32_16x16x32_bf16 v[64:67], v[212:215], v[88:91], v[64:67]
    s_waitcnt lgkmcnt(4)
    v_mfma_f32_16x16x32_bf16 v[32:35], a[96:99], v[92:95], v[32:35]
    ds_read_b128 v[84:87], v1 offset:26624
    v_mfma_f32_16x16x32_bf16 v[32:35], a[104:107], v[12:15], v[32:35]
    v_mfma_f32_16x16x32_bf16 v[48:51], a[100:103], v[92:95], v[48:51]
    buffer_load_dwordx4 a[4:7], v7, s[4:7], 0 offen offset:1024
    v_mfma_f32_16x16x32_bf16 v[48:51], a[108:111], v[12:15], v[48:51]
    ds_read_b128 v[88:91], v1 offset:27648
    v_xor_b32 v7, 2048, v7
    s_waitcnt lgkmcnt(4)
    v_fmac_f32 v28, v96, v120
    v_fmac_f32 v29, v97, v120
    v_fmac_f32 v30, v98, v120
    v_mfma_f32_16x16x32_bf16 v[64:67], v[216:219], v[92:95], v[64:67]
    v_fmac_f32 v31, v99, v120
    s_waitcnt lgkmcnt(3)
    v_fma_f32 v28, v28, v124, v108
    v_fma_f32 v29, v29, v124, v109
    v_fma_f32 v30, v30, v124, v110
    v_mfma_f32_16x16x32_bf16 v[64:67], v[220:223], v[12:15], v[64:67]
    s_waitcnt lgkmcnt(2)
    v_fma_f32 v31, v31, v124, v111
    v_mul_f32 v128, v28, v28
    v_mul_f32 v129, v29, v29
    v_mul_f32 v130, v30, v30
    v_mfma_f32_16x16x32_bf16 v[32:35], a[112:115], v[76:79], v[32:35]
    ds_read_b128 v[92:95], v1 offset:28672
    buffer_load_dwordx4 a[8:11], v7, s[4:7], 0 offen
    v_mul_f32 v131, v31, v31
    v_mfma_f32_16x16x32_bf16 v[32:35], a[120:123], v[80:83], v[32:35]
    v_fmaak_f32 v128, v139, v128, 0xc0135761
    v_fmaak_f32 v129, v139, v129, 0xc0135761
    v_fmaak_f32 v130, v139, v130, 0xc0135761
    v_fmaak_f32 v131, v139, v131, 0xc0135761
    v_mfma_f32_16x16x32_bf16 v[48:51], a[116:119], v[76:79], v[48:51]
    v_mul_f32 v128, v128, v28
    v_mul_f32 v129, v129, v29
    v_mul_f32 v130, v130, v30
    v_mul_f32 v131, v131, v31
    v_mfma_f32_16x16x32_bf16 v[48:51], a[124:127], v[80:83], v[48:51]
    ds_read_b128 v[12:15], v1 offset:29696
    v_exp_f32 v128, v128
    v_exp_f32 v129, v129
    v_mfma_f32_16x16x32_bf16 v[64:67], v[224:227], v[76:79], v[64:67]
    buffer_load_dwordx4 a[12:15], v7, s[4:7], 0 offen offset:1024
    v_exp_f32 v130, v130
    v_mfma_f32_16x16x32_bf16 v[64:67], v[228:231], v[80:83], v[64:67]
    s_waitcnt lgkmcnt(2)
    v_exp_f32 v131, v131
    v_add_f32 v128, 1.0, v128
    v_add_f32 v129, 1.0, v129
    v_mfma_f32_16x16x32_bf16 v[32:35], a[128:131], v[84:87], v[32:35]
    ds_read_b128 v[76:79], v1 offset:30720
    v_add_f32 v130, 1.0, v130
    v_add_f32 v131, 1.0, v131
    v_rcp_f32 v128, v128
    v_mfma_f32_16x16x32_bf16 v[32:35], a[136:139], v[88:91], v[32:35]
    v_rcp_f32 v129, v129
    v_rcp_f32 v130, v130
    v_mfma_f32_16x16x32_bf16 v[48:51], a[132:135], v[84:87], v[48:51]
    buffer_load_dwordx4 a[24:27], v7, s[4:7], s48 offen
    v_rcp_f32 v131, v131
    v_mfma_f32_16x16x32_bf16 v[48:51], a[140:143], v[88:91], v[48:51]
    ds_read_b128 v[80:83], v1 offset:31744
    v_mul_f32 v28, v28, v128
    v_mul_f32 v29, v29, v129
    v_mul_f32 v30, v30, v130
    v_mul_f32 v31, v31, v131
    v_mfma_f32_16x16x32_bf16 v[64:67], v[232:235], v[84:87], v[64:67]
    v_cvt_pk_bf16_f32 v28, v28, v29
    v_cvt_pk_bf16_f32 v29, v30, v31
    v_fmac_f32 v44, v100, v120
    v_fmac_f32 v45, v101, v120
    v_mfma_f32_16x16x32_bf16 v[64:67], v[236:239], v[88:91], v[64:67]
    s_waitcnt lgkmcnt(2)
    v_fmac_f32 v46, v102, v120
    v_fmac_f32 v47, v103, v120
    v_fma_f32 v44, v44, v124, v112
    v_fma_f32 v45, v45, v124, v113
    v_mfma_f32_16x16x32_bf16 v[32:35], a[144:147], v[92:95], v[32:35]
    ds_read_b128 v[84:87], v1 offset:18432
    buffer_load_dwordx4 a[28:31], v7, s[4:7], s48 offen offset:1024
    v_fma_f32 v46, v46, v124, v114
    v_mfma_f32_16x16x32_bf16 v[32:35], a[152:155], v[12:15], v[32:35]
    v_xor_b32 v7, 2048, v7
    v_fma_f32 v47, v47, v124, v115
    v_mul_f32 v132, v44, v44
    v_mul_f32 v133, v45, v45
    v_mfma_f32_16x16x32_bf16 v[48:51], a[148:151], v[92:95], v[48:51]
    v_mul_f32 v134, v46, v46
    v_mul_f32 v135, v47, v47
    v_fmaak_f32 v132, v139, v132, 0xc0135761
    v_fmaak_f32 v133, v139, v133, 0xc0135761
    v_mfma_f32_16x16x32_bf16 v[48:51], a[156:159], v[12:15], v[48:51]
    ds_read_b128 v[88:91], v1 offset:19456
    v_fmaak_f32 v134, v139, v134, 0xc0135761
    v_fmaak_f32 v135, v139, v135, 0xc0135761
    v_mul_f32 v132, v132, v44
    v_mul_f32 v133, v133, v45
    v_mfma_f32_16x16x32_bf16 v[64:67], v[240:243], v[92:95], v[64:67]
    buffer_load_dwordx4 a[16:19], v7, s[4:7], s48 offen
    v_mul_f32 v134, v134, v46
    v_mul_f32 v135, v135, v47
    v_mfma_f32_16x16x32_bf16 v[64:67], v[244:247], v[12:15], v[64:67]
    s_waitcnt lgkmcnt(2)
    v_exp_f32 v132, v132
    v_exp_f32 v133, v133
    v_mfma_f32_16x16x32_bf16 v[32:35], a[160:163], v[76:79], v[32:35]
    s_waitcnt vmcnt(8)
    s_barrier
    ds_read_b128 v[92:95], v1 offset:34816
    v_exp_f32 v134, v134
    v_mfma_f32_16x16x32_bf16 v[32:35], a[168:171], v[80:83], v[32:35]
    v_exp_f32 v135, v135
    v_add_f32 v132, 1.0, v132
    v_add_f32 v133, 1.0, v133
    v_mfma_f32_16x16x32_bf16 v[48:51], a[164:167], v[76:79], v[48:51]
    buffer_load_dwordx4 a[20:23], v7, s[4:7], s48 offen offset:1024
    v_add_f32 v134, 1.0, v134
    v_add_f32 v135, 1.0, v135
    v_mfma_f32_16x16x32_bf16 v[48:51], a[172:175], v[80:83], v[48:51]
    ds_read_b128 v[12:15], v1 offset:35840
    v_rcp_f32 v132, v132
    v_rcp_f32 v133, v133
    v_mfma_f32_16x16x32_bf16 v[64:67], v[248:251], v[76:79], v[64:67]
    v_rcp_f32 v134, v134
    v_rcp_f32 v135, v135
    v_mfma_f32_16x16x32_bf16 v[64:67], v[252:255], v[80:83], v[64:67]
    s_waitcnt lgkmcnt(2)
    v_mul_f32 v44, v44, v132
    v_mul_f32 v45, v45, v133
    v_mul_f32 v46, v46, v134
    v_mul_f32 v47, v47, v135
    v_mfma_f32_16x16x32_bf16 v[32:35], a[64:67], v[84:87], v[32:35]
    ds_read_b128 v[76:79], v1 offset:51200
    buffer_load_dwordx4 a[32:35], v7, s[4:7], s49 offen
    v_cvt_pk_bf16_f32 v44, v44, v45
    v_mfma_f32_16x16x32_bf16 v[32:35], a[72:75], v[88:91], v[32:35]
    v_cvt_pk_bf16_f32 v45, v46, v47
    v_fmac_f32 v60, v104, v120
    v_fmac_f32 v61, v105, v120
    v_fmac_f32 v62, v106, v120
    v_mfma_f32_16x16x32_bf16 v[48:51], a[68:71], v[84:87], v[48:51]
    v_fmac_f32 v63, v107, v120
    v_fma_f32 v60, v60, v124, v116
    v_fma_f32 v61, v61, v124, v117
    v_fma_f32 v62, v62, v124, v118
    v_mfma_f32_16x16x32_bf16 v[48:51], a[76:79], v[88:91], v[48:51]
    ds_read_b128 v[80:83], v1 offset:52224
    v_fma_f32 v63, v63, v124, v119
    v_mul_f32 v128, v60, v60
    v_mul_f32 v129, v61, v61
    v_mul_f32 v130, v62, v62
    v_mfma_f32_16x16x32_bf16 v[64:67], v[200:203], v[84:87], v[64:67]
    buffer_load_dwordx4 a[36:39], v7, s[4:7], s49 offen offset:1024
    v_mul_f32 v131, v63, v63
    v_fmaak_f32 v128, v139, v128, 0xc0135761
    v_mfma_f32_16x16x32_bf16 v[64:67], v[204:207], v[88:91], v[64:67]
    s_waitcnt lgkmcnt(2)
    v_xor_b32 v7, 2048, v7
    v_fmaak_f32 v129, v139, v129, 0xc0135761
    v_fmaak_f32 v130, v139, v130, 0xc0135761
    v_fmaak_f32 v131, v139, v131, 0xc0135761
    v_mfma_f32_16x16x32_bf16 v[36:39], a[64:67], v[92:95], v[36:39]
    ds_read_b128 v[84:87], v1 offset:36864
    v_mul_f32 v128, v128, v60
    v_mul_f32 v129, v129, v61
    v_mul_f32 v130, v130, v62
    v_mul_f32 v131, v131, v63
    v_mfma_f32_16x16x32_bf16 v[36:39], a[72:75], v[12:15], v[36:39]
    v_exp_f32 v128, v128
    v_exp_f32 v129, v129
    v_mfma_f32_16x16x32_bf16 v[52:55], a[68:71], v[92:95], v[52:55]
    buffer_load_dwordx4 a[40:43], v7, s[4:7], s49 offen
    v_exp_f32 v130, v130
    v_mfma_f32_16x16x32_bf16 v[52:55], a[76:79], v[12:15], v[52:55]
    ds_read_b128 v[88:91], v1 offset:37888
    v_exp_f32 v131, v131
    v_add_f32 v128, 1.0, v128
    v_add_f32 v129, 1.0, v129
    v_mfma_f32_16x16x32_bf16 v[68:71], v[200:203], v[92:95], v[68:71]
    v_add_f32 v130, 1.0, v130
    v_add_f32 v131, 1.0, v131
    v_rcp_f32 v128, v128
    v_mfma_f32_16x16x32_bf16 v[68:71], v[204:207], v[12:15], v[68:71]
    s_waitcnt lgkmcnt(2)
    v_rcp_f32 v129, v129
    v_rcp_f32 v130, v130
    v_mfma_f32_16x16x32_bf16 v[40:43], a[64:67], v[76:79], v[40:43]
    ds_read_b128 v[92:95], v1 offset:53248
    buffer_load_dwordx4 a[44:47], v7, s[4:7], s49 offen offset:1024
    v_mfma_f32_16x16x32_bf16 v[40:43], a[72:75], v[80:83], v[40:43]
    v_rcp_f32 v131, v131
    v_mul_f32 v60, v60, v128
    v_mul_f32 v61, v61, v129
    v_mfma_f32_16x16x32_bf16 v[56:59], a[68:71], v[76:79], v[56:59]
    v_mul_f32 v62, v62, v130
    v_mul_f32 v63, v63, v131
    v_cvt_pk_bf16_f32 v60, v60, v61
    v_cvt_pk_bf16_f32 v61, v62, v63
    v_mfma_f32_16x16x32_bf16 v[56:59], a[76:79], v[80:83], v[56:59]
    ds_read_b128 v[12:15], v1 offset:54272
    v_fmac_f32 v64, v104, v121
    v_fmac_f32 v65, v105, v121
    v_fmac_f32 v66, v106, v121
    v_fmac_f32 v67, v107, v121
    v_mfma_f32_16x16x32_bf16 v[72:75], v[200:203], v[76:79], v[72:75]
    buffer_load_dwordx4 a[56:59], v7, s[4:7], s50 offen
    v_fma_f32 v64, v64, v125, v116
    v_fma_f32 v65, v65, v125, v117
    v_mfma_f32_16x16x32_bf16 v[72:75], v[204:207], v[80:83], v[72:75]
    s_waitcnt lgkmcnt(2)
    v_fma_f32 v66, v66, v125, v118
    v_fma_f32 v67, v67, v125, v119
    v_mul_f32 v132, v64, v64
    v_mul_f32 v133, v65, v65
    v_mfma_f32_16x16x32_bf16 v[36:39], a[80:83], v[84:87], v[36:39]
    ds_read_b128 v[76:79], v1 offset:38912
    v_mul_f32 v134, v66, v66
    v_mul_f32 v135, v67, v67
    v_fmaak_f32 v132, v139, v132, 0xc0135761
    v_fmaak_f32 v133, v139, v133, 0xc0135761
    v_mfma_f32_16x16x32_bf16 v[36:39], a[88:91], v[88:91], v[36:39]
    v_fmaak_f32 v134, v139, v134, 0xc0135761
    v_fmaak_f32 v135, v139, v135, 0xc0135761
    v_mul_f32 v132, v132, v64
    v_mul_f32 v133, v133, v65
    v_mfma_f32_16x16x32_bf16 v[52:55], a[84:87], v[84:87], v[52:55]
    buffer_load_dwordx4 a[60:63], v7, s[4:7], s50 offen offset:1024
    v_mul_f32 v134, v134, v66
    v_mul_f32 v135, v135, v67
    v_mfma_f32_16x16x32_bf16 v[52:55], a[92:95], v[88:91], v[52:55]
    ds_read_b128 v[80:83], v1 offset:39936
    v_exp_f32 v132, v132
    v_exp_f32 v133, v133
    v_mfma_f32_16x16x32_bf16 v[68:71], v[208:211], v[84:87], v[68:71]
    v_exp_f32 v134, v134
    v_exp_f32 v135, v135
    v_mfma_f32_16x16x32_bf16 v[68:71], v[212:215], v[88:91], v[68:71]
    s_waitcnt lgkmcnt(2)
    v_add_f32 v132, 1.0, v132
    v_add_f32 v133, 1.0, v133
    v_add_f32 v134, 1.0, v134
    v_add_f32 v135, 1.0, v135
    v_mfma_f32_16x16x32_bf16 v[40:43], a[80:83], v[92:95], v[40:43]
    ds_read_b128 v[84:87], v1 offset:55296
    v_xor_b32 v7, 2048, v7
    buffer_load_dwordx4 a[48:51], v7, s[4:7], s50 offen
    v_mfma_f32_16x16x32_bf16 v[40:43], a[88:91], v[12:15], v[40:43]
    v_rcp_f32 v132, v132
    v_rcp_f32 v133, v133
    v_mfma_f32_16x16x32_bf16 v[56:59], a[84:87], v[92:95], v[56:59]
    v_rcp_f32 v134, v134
    v_rcp_f32 v135, v135
    v_mfma_f32_16x16x32_bf16 v[56:59], a[92:95], v[12:15], v[56:59]
    ds_read_b128 v[88:91], v1 offset:56320
    v_mul_f32 v64, v64, v132
    v_mul_f32 v65, v65, v133
    v_mul_f32 v66, v66, v134
    v_mul_f32 v67, v67, v135
    v_mfma_f32_16x16x32_bf16 v[72:75], v[208:211], v[92:95], v[72:75]
    buffer_load_dwordx4 a[52:55], v7, s[4:7], s50 offen offset:1024
    v_cvt_pk_bf16_f32 v62, v64, v65
    v_cvt_pk_bf16_f32 v63, v66, v67
    v_mfma_f32_16x16x32_bf16 v[72:75], v[212:215], v[12:15], v[72:75]
    s_waitcnt lgkmcnt(2)
    v_permlane16_swap_b32 v60, v62
    v_permlane16_swap_b32 v61, v63
    v_mfma_f32_16x16x32_bf16 v[36:39], a[96:99], v[76:79], v[36:39]
    ds_read_b128 v[92:95], v1 offset:40960
    v_mfma_f32_16x16x32_bf16 v[36:39], a[104:107], v[80:83], v[36:39]
    buffer_store_dwordx4 v[60:63], v138, s[4:7], s55 offen sc1
    v_mfma_f32_16x16x32_bf16 v[52:55], a[100:103], v[76:79], v[52:55]
    buffer_load_dwordx4 a[64:67], v7, s[4:7], s51 offen
    v_fmac_f32 v48, v100, v121
    v_fmac_f32 v49, v101, v121
    v_mfma_f32_16x16x32_bf16 v[52:55], a[108:111], v[80:83], v[52:55]
    ds_read_b128 v[12:15], v1 offset:41984
    v_fmac_f32 v50, v102, v121
    v_fmac_f32 v51, v103, v121
    v_fma_f32 v48, v48, v125, v112
    v_fma_f32 v49, v49, v125, v113
    v_mfma_f32_16x16x32_bf16 v[68:71], v[216:219], v[76:79], v[68:71]
    v_fma_f32 v50, v50, v125, v114
    v_fma_f32 v51, v51, v125, v115
    v_mul_f32 v128, v48, v48
    v_mul_f32 v129, v49, v49
    v_mfma_f32_16x16x32_bf16 v[68:71], v[220:223], v[80:83], v[68:71]
    s_waitcnt lgkmcnt(2)
    v_mul_f32 v130, v50, v50
    v_mul_f32 v131, v51, v51
    v_fmaak_f32 v128, v139, v128, 0xc0135761
    v_fmaak_f32 v129, v139, v129, 0xc0135761
    v_mfma_f32_16x16x32_bf16 v[40:43], a[96:99], v[84:87], v[40:43]
    ds_read_b128 v[76:79], v1 offset:57344
    buffer_load_dwordx4 a[68:71], v7, s[4:7], s51 offen offset:1024
    v_fmaak_f32 v130, v139, v130, 0xc0135761
    v_mfma_f32_16x16x32_bf16 v[40:43], a[104:107], v[88:91], v[40:43]
    v_fmaak_f32 v131, v139, v131, 0xc0135761
    v_mul_f32 v128, v128, v48
    v_mul_f32 v129, v129, v49
    v_mul_f32 v130, v130, v50
    v_mfma_f32_16x16x32_bf16 v[56:59], a[100:103], v[84:87], v[56:59]
    v_mul_f32 v131, v131, v51
    v_exp_f32 v128, v128
    v_mfma_f32_16x16x32_bf16 v[56:59], a[108:111], v[88:91], v[56:59]
    ds_read_b128 v[80:83], v1 offset:58368
    v_exp_f32 v129, v129
    v_exp_f32 v130, v130
    v_mfma_f32_16x16x32_bf16 v[72:75], v[216:219], v[84:87], v[72:75]
    v_xor_b32 v7, 2048, v7
    buffer_load_dwordx4 a[72:75], v7, s[4:7], s51 offen
    v_mfma_f32_16x16x32_bf16 v[72:75], v[220:223], v[88:91], v[72:75]
    s_waitcnt lgkmcnt(2)
    v_exp_f32 v131, v131
    v_add_f32 v128, 1.0, v128
    v_add_f32 v129, 1.0, v129
    v_mfma_f32_16x16x32_bf16 v[36:39], a[112:115], v[92:95], v[36:39]
    ds_read_b128 v[84:87], v1 offset:43008
    v_add_f32 v130, 1.0, v130
    v_add_f32 v131, 1.0, v131
    v_rcp_f32 v128, v128
    v_mfma_f32_16x16x32_bf16 v[36:39], a[120:123], v[12:15], v[36:39]
    v_rcp_f32 v129, v129
    v_rcp_f32 v130, v130
    v_mfma_f32_16x16x32_bf16 v[52:55], a[116:119], v[92:95], v[52:55]
    buffer_load_dwordx4 a[76:79], v7, s[4:7], s51 offen offset:1024
    v_rcp_f32 v131, v131
    v_mfma_f32_16x16x32_bf16 v[52:55], a[124:127], v[12:15], v[52:55]
    ds_read_b128 v[88:91], v1 offset:44032
    v_mul_f32 v48, v48, v128
    v_mul_f32 v49, v49, v129
    v_mul_f32 v50, v50, v130
    v_mul_f32 v51, v51, v131
    v_mfma_f32_16x16x32_bf16 v[68:71], v[224:227], v[92:95], v[68:71]
    v_cvt_pk_bf16_f32 v46, v48, v49
    v_cvt_pk_bf16_f32 v47, v50, v51
    s_nop 0
    v_permlane16_swap_b32 v44, v46
    v_mfma_f32_16x16x32_bf16 v[68:71], v[228:231], v[12:15], v[68:71]
    s_waitcnt lgkmcnt(2)
    v_permlane16_swap_b32 v45, v47
    v_mfma_f32_16x16x32_bf16 v[40:43], a[112:115], v[76:79], v[40:43]
    ds_read_b128 v[92:95], v1 offset:59392
    buffer_load_dwordx4 a[88:91], v7, s[4:7], s52 offen
    v_mfma_f32_16x16x32_bf16 v[40:43], a[120:123], v[80:83], v[40:43]
    buffer_store_dwordx4 v[44:47], v137, s[4:7], s51 offen sc1
    v_mfma_f32_16x16x32_bf16 v[56:59], a[116:119], v[76:79], v[56:59]
    ds_write_b128 v5, v[44:47] offset:2048
    v_mfma_f32_16x16x32_bf16 v[56:59], a[124:127], v[80:83], v[56:59]
    ds_read_b128 v[12:15], v1 offset:60416
    v_fmac_f32 v32, v96, v121
    v_fmac_f32 v33, v97, v121
    v_fmac_f32 v34, v98, v121
    v_fmac_f32 v35, v99, v121
    v_mfma_f32_16x16x32_bf16 v[72:75], v[224:227], v[76:79], v[72:75]
    buffer_load_dwordx4 a[92:95], v7, s[4:7], s52 offen offset:1024
    v_fma_f32 v32, v32, v125, v108
    v_fma_f32 v33, v33, v125, v109
    v_mfma_f32_16x16x32_bf16 v[72:75], v[228:231], v[80:83], v[72:75]
    s_waitcnt lgkmcnt(3)
    v_fma_f32 v34, v34, v125, v110
    v_fma_f32 v35, v35, v125, v111
    v_mul_f32 v132, v32, v32
    v_mul_f32 v133, v33, v33
    v_mfma_f32_16x16x32_bf16 v[36:39], a[128:131], v[84:87], v[36:39]
    ds_read_b128 v[76:79], v1 offset:45056
    v_mul_f32 v134, v34, v34
    v_mul_f32 v135, v35, v35
    v_fmaak_f32 v132, v139, v132, 0xc0135761
    v_fmaak_f32 v133, v139, v133, 0xc0135761
    v_mfma_f32_16x16x32_bf16 v[36:39], a[136:139], v[88:91], v[36:39]
    v_fmaak_f32 v134, v139, v134, 0xc0135761
    v_fmaak_f32 v135, v139, v135, 0xc0135761
    v_mul_f32 v132, v132, v32
    v_mul_f32 v133, v133, v33
    v_mfma_f32_16x16x32_bf16 v[52:55], a[132:135], v[84:87], v[52:55]
    v_xor_b32 v7, 2048, v7
    buffer_load_dwordx4 a[80:83], v7, s[4:7], s52 offen
    v_mfma_f32_16x16x32_bf16 v[52:55], a[140:143], v[88:91], v[52:55]
    ds_read_b128 v[80:83], v1 offset:46080
    v_mul_f32 v134, v134, v34
    v_mul_f32 v135, v135, v35
    v_exp_f32 v132, v132
    v_mfma_f32_16x16x32_bf16 v[68:71], v[232:235], v[84:87], v[68:71]
    v_exp_f32 v133, v133
    v_exp_f32 v134, v134
    v_mfma_f32_16x16x32_bf16 v[68:71], v[236:239], v[88:91], v[68:71]
    s_waitcnt lgkmcnt(2)
    v_exp_f32 v135, v135
    v_add_f32 v132, 1.0, v132
    v_add_f32 v133, 1.0, v133
    v_mfma_f32_16x16x32_bf16 v[40:43], a[128:131], v[92:95], v[40:43]
    ds_read_b128 v[84:87], v1 offset:61440
    buffer_load_dwordx4 a[84:87], v7, s[4:7], s52 offen offset:1024
    v_add_f32 v134, 1.0, v134
    v_mfma_f32_16x16x32_bf16 v[40:43], a[136:139], v[12:15], v[40:43]
    ds_read_b128 v[8:11], v143 offset:0
    v_add_f32 v135, 1.0, v135
    v_rcp_f32 v132, v132
    v_mfma_f32_16x16x32_bf16 v[56:59], a[132:135], v[92:95], v[56:59]
    v_rcp_f32 v133, v133
    v_rcp_f32 v134, v134
    v_mfma_f32_16x16x32_bf16 v[56:59], a[140:143], v[12:15], v[56:59]
    ds_read_b128 v[88:91], v1 offset:62464
    v_rcp_f32 v135, v135
    v_mul_f32 v32, v32, v132
    v_mul_f32 v33, v33, v133
    v_mfma_f32_16x16x32_bf16 v[72:75], v[232:235], v[92:95], v[72:75]
    buffer_load_dwordx4 a[96:99], v7, s[4:7], s53 offen
    v_mul_f32 v34, v34, v134
    v_mul_f32 v35, v35, v135
    v_mfma_f32_16x16x32_bf16 v[72:75], v[236:239], v[12:15], v[72:75]
    s_waitcnt lgkmcnt(3)
    v_cvt_pk_bf16_f32 v30, v32, v33
    v_cvt_pk_bf16_f32 v31, v34, v35
    s_nop 0
    v_permlane16_swap_b32 v28, v30
    v_mfma_f32_16x16x32_bf16 v[36:39], a[144:147], v[76:79], v[36:39]
    ds_read_b128 v[92:95], v1 offset:47104
    v_permlane16_swap_b32 v29, v31
    v_mfma_f32_16x16x32_bf16 v[36:39], a[152:155], v[80:83], v[36:39]
    buffer_store_dwordx4 v[28:31], v137, s[4:7], 0 offen
    v_mfma_f32_16x16x32_bf16 v[52:55], a[148:151], v[76:79], v[52:55]
    buffer_load_dwordx4 a[100:103], v7, s[4:7], s53 offen offset:1024
    v_mfma_f32_16x16x32_bf16 v[52:55], a[156:159], v[80:83], v[52:55]
    ds_read_b128 v[12:15], v1 offset:48128
    ds_write_b128 v5, v[28:31] offset:0
    v_mfma_f32_16x16x32_bf16 v[68:71], v[240:243], v[76:79], v[68:71]
    v_mfma_f32_16x16x32_bf16 v[68:71], v[244:247], v[80:83], v[68:71]
    s_waitcnt lgkmcnt(3)
    v_mfma_f32_16x16x32_bf16 v[40:43], a[144:147], v[84:87], v[40:43]
    ds_read_b128 v[76:79], v1 offset:63488
    v_xor_b32 v7, 2048, v7
    v_mfma_f32_16x16x32_bf16 v[40:43], a[152:155], v[88:91], v[40:43]
    buffer_load_dwordx4 a[104:107], v7, s[4:7], s53 offen
    v_mfma_f32_16x16x32_bf16 v[56:59], a[148:151], v[84:87], v[56:59]
    v_mfma_f32_16x16x32_bf16 v[56:59], a[156:159], v[88:91], v[56:59]
    ds_read_b128 v[80:83], v1 offset:64512
    v_mfma_f32_16x16x32_bf16 v[72:75], v[240:243], v[84:87], v[72:75]
    buffer_load_dwordx4 a[108:111], v7, s[4:7], s53 offen offset:1024
    v_mfma_f32_16x16x32_bf16 v[72:75], v[244:247], v[88:91], v[72:75]
    s_waitcnt lgkmcnt(3)
    v_mfma_f32_16x16x32_bf16 v[36:39], a[160:163], v[92:95], v[36:39]
    v_mfma_f32_16x16x32_bf16 v[36:39], a[168:171], v[12:15], v[36:39]
    v_mfma_f32_16x16x32_bf16 v[52:55], a[164:167], v[92:95], v[52:55]
    buffer_load_dwordx4 a[120:123], v7, s[4:7], s54 offen
    v_mfma_f32_16x16x32_bf16 v[52:55], a[172:175], v[12:15], v[52:55]
    v_mfma_f32_16x16x32_bf16 v[68:71], v[248:251], v[92:95], v[68:71]
    v_mfma_f32_16x16x32_bf16 v[68:71], v[252:255], v[12:15], v[68:71]
    s_waitcnt lgkmcnt(0)
    v_mfma_f32_16x16x32_bf16 v[40:43], a[160:163], v[76:79], v[40:43]
    ds_read_b128 v[12:15], v143 offset:4096
    v_mfma_f32_16x16x32_bf16 v[40:43], a[168:171], v[80:83], v[40:43]
    buffer_load_dwordx4 a[124:127], v7, s[4:7], s54 offen offset:1024
    v_mfma_f32_16x16x32_bf16 v[56:59], a[164:167], v[76:79], v[56:59]
    v_mfma_f32_16x16x32_bf16 v[56:59], a[172:175], v[80:83], v[56:59]
    v_mfma_f32_16x16x32_bf16 v[72:75], v[248:251], v[76:79], v[72:75]
    v_xor_b32 v7, 2048, v7
    v_mfma_f32_16x16x32_bf16 v[72:75], v[252:255], v[80:83], v[72:75]
    buffer_load_dwordx4 a[112:115], v7, s[4:7], s54 offen
    v_add_u32 v93, s99, v1
    v_add_u32 v92, s101, v1
    v_pk_fma_f32 v[68:69], v[104:105], v[122:123], v[68:69] op_sel:[0,0,0] op_sel_hi:[1,0,1]
    v_pk_fma_f32 v[70:71], v[106:107], v[122:123], v[70:71] op_sel:[0,0,0] op_sel_hi:[1,0,1]
    s_nop 2
    v_pk_fma_f32 v[72:73], v[104:105], v[122:123], v[72:73] op_sel:[0,1,0] op_sel_hi:[1,1,1]
    v_pk_fma_f32 v[74:75], v[106:107], v[122:123], v[74:75] op_sel:[0,1,0] op_sel_hi:[1,1,1]
    v_pk_fma_f32 v[68:69], v[68:69], v[126:127], v[116:117] op_sel:[0,0,0] op_sel_hi:[1,0,1]
    v_pk_fma_f32 v[70:71], v[70:71], v[126:127], v[118:119] op_sel:[0,0,0] op_sel_hi:[1,0,1]
    v_pk_fma_f32 v[72:73], v[72:73], v[126:127], v[116:117] op_sel:[0,1,0] op_sel_hi:[1,1,1]
    v_pk_fma_f32 v[74:75], v[74:75], v[126:127], v[118:119] op_sel:[0,1,0] op_sel_hi:[1,1,1]
    v_pk_mul_f32 v[128:129], v[68:69], v[68:69]
    v_pk_mul_f32 v[130:131], v[70:71], v[70:71]
    v_pk_mul_f32 v[132:133], v[72:73], v[72:73]
    v_pk_mul_f32 v[134:135], v[74:75], v[74:75]
    v_add_u32 v6, s45, 2
    s_cmp_eq_u32 s46, 0
    s_mov_b64 exec, s[72:73]
    s_waitcnt vmcnt(6)
    s_cbranch_scc1 L14s
    buffer_store_dword v6, v3, s[4:7], 0 offen
L14:
    s_mov_b64 exec, -1
    buffer_load_dwordx4 a[116:119], v7, s[4:7], s54 offen offset:1024
    v_pk_fma_f32 v[128:129], v[128:129], s[74:75], s[74:75] op_sel:[0,0,1] op_sel_hi:[1,0,1]
    v_pk_fma_f32 v[130:131], v[130:131], s[74:75], s[74:75] op_sel:[0,0,1] op_sel_hi:[1,0,1]
    v_pk_fma_f32 v[132:133], v[132:133], s[74:75], s[74:75] op_sel:[0,0,1] op_sel_hi:[1,0,1]
    v_pk_fma_f32 v[134:135], v[134:135], s[74:75], s[74:75] op_sel:[0,0,1] op_sel_hi:[1,0,1]
    v_pk_mul_f32 v[128:129], v[128:129], v[68:69]
    v_pk_mul_f32 v[130:131], v[130:131], v[70:71]
    v_pk_mul_f32 v[132:133], v[132:133], v[72:73]
    v_pk_mul_f32 v[134:135], v[134:135], v[74:75]
    v_exp_f32 v128, v128
    v_exp_f32 v129, v129
    v_exp_f32 v130, v130
    v_exp_f32 v131, v131
    v_exp_f32 v132, v132
    buffer_load_dwordx4 a[128:131], v7, s[4:7], s55 offen
    v_exp_f32 v133, v133
    v_exp_f32 v134, v134
    v_exp_f32 v135, v135
    v_pk_add_f32 v[128:129], v[128:129], 1.0 op_sel_hi:[1,0]
    v_pk_add_f32 v[130:131], v[130:131], 1.0 op_sel_hi:[1,0]
    v_pk_add_f32 v[132:133], v[132:133], 1.0 op_sel_hi:[1,0]
    v_pk_add_f32 v[134:135], v[134:135], 1.0 op_sel_hi:[1,0]
    v_rcp_f32 v128, v128
    v_rcp_f32 v129, v129
    v_rcp_f32 v130, v130
    buffer_load_dwordx4 a[132:135], v7, s[4:7], s55 offen offset:1024
    v_rcp_f32 v131, v131
    v_rcp_f32 v132, v132
    v_rcp_f32 v133, v133
    v_rcp_f32 v134, v134
    v_rcp_f32_e64 v135, v135
    v_pk_mul_f32 v[68:69], v[68:69], v[128:129]
    v_pk_mul_f32 v[70:71], v[70:71], v[130:131]
    v_pk_mul_f32 v[72:73], v[72:73], v[132:133]
    v_pk_mul_f32 v[74:75], v[74:75], v[134:135]
    v_cvt_pk_bf16_f32 v68, v68, v69
    v_cvt_pk_bf16_f32 v69, v70, v71
    v_xor_b32 v7, 2048, v7
    buffer_load_dwordx4 a[136:139], v7, s[4:7], s55 offen
    v_cvt_pk_bf16_f32 v70, v72, v73
    v_cvt_pk_bf16_f32 v71, v74, v75
    s_nop 0
    v_permlane16_swap_b32 v68, v70
    v_permlane16_swap_b32 v69, v71
    v_add_u32 v138, 88064, v138
    buffer_store_dwordx4 v[68:71], v138, s[4:7], s55 offen sc1
    v_pk_fma_f32 v[52:53], v[100:101], v[122:123], v[52:53] op_sel:[0,0,0] op_sel_hi:[1,0,1]
    v_pk_fma_f32 v[54:55], v[102:103], v[122:123], v[54:55] op_sel:[0,0,0] op_sel_hi:[1,0,1]
    v_pk_fma_f32 v[56:57], v[100:101], v[122:123], v[56:57] op_sel:[0,1,0] op_sel_hi:[1,1,1]
    buffer_load_dwordx4 a[140:143], v7, s[4:7], s55 offen offset:1024
    v_pk_fma_f32 v[58:59], v[102:103], v[122:123], v[58:59] op_sel:[0,1,0] op_sel_hi:[1,1,1]
    v_pk_fma_f32 v[52:53], v[52:53], v[126:127], v[112:113] op_sel:[0,0,0] op_sel_hi:[1,0,1]
    v_pk_fma_f32 v[54:55], v[54:55], v[126:127], v[114:115] op_sel:[0,0,0] op_sel_hi:[1,0,1]
    v_pk_fma_f32 v[56:57], v[56:57], v[126:127], v[112:113] op_sel:[0,1,0] op_sel_hi:[1,1,1]
    v_pk_fma_f32 v[58:59], v[58:59], v[126:127], v[114:115] op_sel:[0,1,0] op_sel_hi:[1,1,1]
    v_pk_mul_f32 v[128:129], v[52:53], v[52:53]
    v_pk_mul_f32 v[130:131], v[54:55], v[54:55]
    v_pk_mul_f32 v[132:133], v[56:57], v[56:57]
    v_pk_mul_f32 v[134:135], v[58:59], v[58:59]
    v_pk_fma_f32 v[128:129], v[128:129], s[74:75], s[74:75] op_sel:[0,0,1] op_sel_hi:[1,0,1]
    v_pk_fma_f32 v[130:131], v[130:131], s[74:75], s[74:75] op_sel:[0,0,1] op_sel_hi:[1,0,1]
    v_pk_fma_f32 v[132:133], v[132:133], s[74:75], s[74:75] op_sel:[0,0,1] op_sel_hi:[1,0,1]
    v_pk_fma_f32 v[134:135], v[134:135], s[74:75], s[74:75] op_sel:[0,0,1] op_sel_hi:[1,0,1]
    v_pk_mul_f32 v[128:129], v[128:129], v[52:53]
    v_pk_mul_f32 v[130:131], v[130:131], v[54:55]
    v_pk_mul_f32 v[132:133], v[132:133], v[56:57]
    buffer_load_dwordx4 a[152:155], v7, s[4:7], s56 offen
    v_pk_mul_f32 v[134:135], v[134:135], v[58:59]
    v_exp_f32 v128, v128
    v_exp_f32 v129, v129
    v_exp_f32 v130, v130
    v_exp_f32 v131, v131
    v_exp_f32 v132, v132
    v_exp_f32 v133, v133
    v_exp_f32 v134, v134
    v_exp_f32 v135, v135
    buffer_load_dwordx4 a[156:159], v7, s[4:7], s56 offen offset:1024
    v_pk_add_f32 v[128:129], v[128:129], 1.0 op_sel_hi:[1,0]
    v_pk_add_f32 v[130:131], v[130:131], 1.0 op_sel_hi:[1,0]
    v_pk_add_f32 v[132:133], v[132:133], 1.0 op_sel_hi:[1,0]
    v_pk_add_f32 v[134:135], v[134:135], 1.0 op_sel_hi:[1,0]
    v_rcp_f32 v128, v128
    v_rcp_f32 v129, v129
    v_rcp_f32 v130, v130
    v_rcp_f32 v131, v131
    v_rcp_f32 v132, v132
    v_rcp_f32 v133, v133
    v_xor_b32 v7, 2048, v7
    buffer_load_dwordx4 a[144:147], v7, s[4:7], s56 offen
    v_rcp_f32 v134, v134
    v_rcp_f32_e64 v135, v135
    v_pk_mul_f32 v[52:53], v[52:53], v[128:129]
    v_pk_mul_f32 v[54:55], v[54:55], v[130:131]
    v_pk_mul_f32 v[56:57], v[56:57], v[132:133]
    v_pk_mul_f32 v[58:59], v[58:59], v[134:135]
    v_cvt_pk_bf16_f32 v52, v52, v53
    v_cvt_pk_bf16_f32 v53, v54, v55
    v_cvt_pk_bf16_f32 v54, v56, v57
    v_cvt_pk_bf16_f32 v55, v58, v59
    s_nop 0
    v_permlane16_swap_b32 v52, v54
    v_permlane16_swap_b32 v53, v55
    buffer_load_dword v94, v3, s[4:7], 0 offen sc1
    buffer_load_dwordx4 a[148:151], v7, s[4:7], s56 offen offset:1024
    v_add_u32 v137, 88064, v137
    buffer_store_dwordx4 v[52:55], v137, s[4:7], s51 offen sc1
    ds_write_b128 v5, v[52:55] offset:24576
    v_pk_fma_f32 v[36:37], v[96:97], v[122:123], v[36:37] op_sel:[0,0,0] op_sel_hi:[1,0,1]
    v_pk_fma_f32 v[38:39], v[98:99], v[122:123], v[38:39] op_sel:[0,0,0] op_sel_hi:[1,0,1]
    v_pk_fma_f32 v[40:41], v[96:97], v[122:123], v[40:41] op_sel:[0,1,0] op_sel_hi:[1,1,1]
    v_add_u32 v7, s97, v1
    buffer_load_dwordx4 a[160:163], v7, s[4:7], s57 offen
    v_pk_fma_f32 v[42:43], v[98:99], v[122:123], v[42:43] op_sel:[0,1,0] op_sel_hi:[1,1,1]
    v_pk_fma_f32 v[36:37], v[36:37], v[126:127], v[108:109] op_sel:[0,0,0] op_sel_hi:[1,0,1]
    v_pk_fma_f32 v[38:39], v[38:39], v[126:127], v[110:111] op_sel:[0,0,0] op_sel_hi:[1,0,1]
    v_pk_fma_f32 v[40:41], v[40:41], v[126:127], v[108:109] op_sel:[0,1,0] op_sel_hi:[1,1,1]
    v_pk_fma_f32 v[42:43], v[42:43], v[126:127], v[110:111] op_sel:[0,1,0] op_sel_hi:[1,1,1]
    v_pk_mul_f32 v[128:129], v[36:37], v[36:37]
    v_pk_mul_f32 v[130:131], v[38:39], v[38:39]
    v_pk_mul_f32 v[132:133], v[40:41], v[40:41]
    v_pk_mul_f32 v[134:135], v[42:43], v[42:43]
    v_pk_fma_f32 v[128:129], v[128:129], s[74:75], s[74:75] op_sel:[0,0,1] op_sel_hi:[1,0,1]
    v_pk_fma_f32 v[130:131], v[130:131], s[74:75], s[74:75] op_sel:[0,0,1] op_sel_hi:[1,0,1]
    v_pk_fma_f32 v[132:133], v[132:133], s[74:75], s[74:75] op_sel:[0,0,1] op_sel_hi:[1,0,1]
    v_pk_fma_f32 v[134:135], v[134:135], s[74:75], s[74:75] op_sel:[0,0,1] op_sel_hi:[1,0,1]
    v_pk_mul_f32 v[128:129], v[128:129], v[36:37]
    v_pk_mul_f32 v[130:131], v[130:131], v[38:39]
    buffer_load_dwordx4 a[164:167], v7, s[4:7], s57 offen offset:1024
    v_pk_mul_f32 v[132:133], v[132:133], v[40:41]
    v_pk_mul_f32 v[134:135], v[134:135], v[42:43]
    v_exp_f32 v128, v128
    v_exp_f32 v129, v129
    v_exp_f32 v130, v130
    v_exp_f32 v131, v131
    v_exp_f32 v132, v132
    v_exp_f32 v133, v133
    v_exp_f32 v134, v134
    v_xor_b32 v7, 2048, v7
    buffer_load_dwordx4 a[168:171], v7, s[4:7], s57 offen
    v_exp_f32 v135, v135
    v_pk_add_f32 v[128:129], v[128:129], 1.0 op_sel_hi:[1,0]
    v_pk_add_f32 v[130:131], v[130:131], 1.0 op_sel_hi:[1,0]
    v_pk_add_f32 v[132:133], v[132:133], 1.0 op_sel_hi:[1,0]
    v_pk_add_f32 v[134:135], v[134:135], 1.0 op_sel_hi:[1,0]
    v_rcp_f32 v128, v128
    v_rcp_f32 v129, v129
    v_rcp_f32 v130, v130
    v_rcp_f32 v131, v131
    v_rcp_f32 v132, v132
    buffer_load_dwordx4 a[172:175], v7, s[4:7], s57 offen offset:1024
    v_rcp_f32 v133, v133
    v_rcp_f32 v134, v134
    v_rcp_f32 v135, v135
    v_pk_mul_f32 v[36:37], v[36:37], v[128:129]
    v_pk_mul_f32 v[38:39], v[38:39], v[130:131]
    v_pk_mul_f32 v[40:41], v[40:41], v[132:133]
    v_pk_mul_f32 v[42:43], v[42:43], v[134:135]
    v_cvt_pk_bf16_f32 v36, v36, v37
    v_cvt_pk_bf16_f32 v37, v38, v39
    v_cvt_pk_bf16_f32 v38, v40, v41
    v_cvt_pk_bf16_f32 v39, v42, v43
    s_add_u32 s82, s1, 2
    s_waitcnt vmcnt(6)
    v_subrev_u32 v94, s82, v94
    v_cmp_lt_u32 s[82:83], 13, v94
    v_permlane16_swap_b32 v36, v38
    v_permlane16_swap_b32 v37, v39
    buffer_store_dwordx4 v[36:39], v137, s[4:7], 0 offen
    ds_write_b128 v5, v[36:39] offset:22528
    s_cmp_lg_u64 s[82:83], 0
    s_cbranch_scc1 L13s
L13:
    buffer_load_dwordx4 v[80:83], v92, s[4:7], s59 offen sc1
    buffer_load_dwordx4 v[64:67], v92, s[4:7], s59 offen offset:1024 sc1
    s_andn2_b32 s34, 2, s28
    s_lshl_b32 s34, s34, 11
    s_add_u32 s34, s34, s47
    s_add_u32 s34, s34, 131072
    v_add_u32 v7, s34, v1
    ds_read_b128 v[76:79], v7 offset:0
    buffer_load_dwordx4 v[96:99], v92, s[4:7], s60 offen sc1
    buffer_load_dwordx4 v[100:103], v92, s[4:7], s60 offen offset:1024 sc1
    buffer_load_dwordx4 v[104:107], v92, s[4:7], s61 offen sc1
    buffer_load_dwordx4 v[108:111], v92, s[4:7], s61 offen offset:1024 sc1
    buffer_load_dwordx4 v[112:115], v92, s[4:7], s62 offen sc1
    s_waitcnt lgkmcnt(0)
    v_mfma_f32_16x16x32_bf16 v[28:31], a[0:3], v[76:79], 0
    buffer_load_dwordx4 v[116:119], v92, s[4:7], s62 offen offset:1024 sc1
    s_waitcnt vmcnt(7)
    v_mfma_f32_16x16x32_bf16 v[28:31], a[16:19], v[80:83], v[28:31]
    v_add_u32 v6, s45, 3
    s_cmp_eq_u32 s46, 0
    s_mov_b64 exec, s[72:73]
    s_cbranch_scc1 L15s
    buffer_store_dword v6, v3, s[4:7], 0 offen
L15:
    s_mov_b64 exec, -1
    v_mfma_f32_16x16x32_bf16 v[32:35], a[4:7], v[76:79], 0
    ds_read_b128 v[60:63], v0 offset:576
    v_add_u32 v142, 88064, v92
    v_add_u32 v143, 88064, v93
    v_mfma_f32_16x16x32_bf16 v[32:35], a[20:23], v[80:83], v[32:35]
    v_lshl_add_u32 v139, s47, 3, v1
    v_xor_b32 v136, 24576, v139
    v_mfma_f32_16x16x32_bf16 v[36:39], a[8:11], v[76:79], 0
    buffer_load_dwordx4 v[120:123], v92, s[4:7], s2 offen sc1
    v_mfma_f32_16x16x32_bf16 v[36:39], a[24:27], v[80:83], v[36:39]
    v_xor_b32 v137, 16384, v139
    v_xor_b32 v138, 8192, v139
    v_mfma_f32_16x16x32_bf16 v[40:43], a[12:15], v[76:79], 0
    s_add_u32 s34, s100, s44
    s_add_u32 s34, s34, 3448832
    v_add_u32 v140, s34, v1
    v_mfma_f32_16x16x32_bf16 v[40:43], a[28:31], v[80:83], v[40:43]
    s_waitcnt vmcnt(7)
    s_lshl_b32 s34, s29, 10
    s_lshr_b32 s35, s28, 1
    v_mfma_f32_16x16x32_bf16 v[28:31], a[32:35], v[64:67], v[28:31]
    buffer_load_dwordx4 v[124:127], v92, s[4:7], s39 offen sc1
    v_mfma_f32_16x16x32_bf16 v[28:31], a[48:51], v[96:99], v[28:31]
    v_xor_b32 v7, 4096, v7
    ds_read_b128 v[128:131], v7 offset:0
    v_mfma_f32_16x16x32_bf16 v[32:35], a[36:39], v[64:67], v[32:35]
    s_lshl_b32 s35, s35, 8
    s_add_u32 s34, s34, s35
    s_and_b32 s35, s28, 1
    v_mfma_f32_16x16x32_bf16 v[32:35], a[52:55], v[96:99], v[32:35]
    s_lshl_b32 s35, s35, 3
    s_add_u32 s34, s34, s35
    s_lshl_b32 s35, s30, 13
    v_mfma_f32_16x16x32_bf16 v[36:39], a[40:43], v[64:67], v[36:39]
    s_add_u32 s34, s34, s35
    s_add_u32 s34, s34, 9740288
    v_bfe_u32 v141, v1, 4, 4
    v_mfma_f32_16x16x32_bf16 v[36:39], a[56:59], v[96:99], v[36:39]
    v_lshl_add_u32 v141, v141, 4, s34
    v_mov_b32 v5, 1879048192
    v_mfma_f32_16x16x32_bf16 v[40:43], a[44:47], v[64:67], v[40:43]
    s_mov_b32 vcc_lo, 0x00f0000f
    s_mov_b32 vcc_hi, 0xf0000f00
    v_cndmask_b32 v141, v5, v141, vcc
    v_mfma_f32_16x16x32_bf16 v[40:43], a[60:63], v[96:99], v[40:43]
    s_waitcnt vmcnt(6)
    s_add_u32 s99, s0, s44
    s_add_u32 s99, s99, 3448832
    v_mfma_f32_16x16x32_bf16 v[28:31], a[64:67], v[100:103], v[28:31]
    buffer_load_dwordx4 v[132:135], v93, s[4:7], s59 offen sc1
    v_mfma_f32_16x16x32_bf16 v[28:31], a[80:83], v[104:107], v[28:31]
    v_lshlrev_b32 v52, 16, v8
    v_and_b32 v53, s41, v8
    v_mfma_f32_16x16x32_bf16 v[32:35], a[68:71], v[100:103], v[32:35]
    s_waitcnt lgkmcnt(1)
    v_lshlrev_b32 v5, 16, v60
    v_and_b32 v95, s41, v60
    v_mfma_f32_16x16x32_bf16 v[32:35], a[84:87], v[104:107], v[32:35]
    v_add_f32 v52, v52, v5
    v_add_f32 v53, v53, v95
    v_mfma_f32_16x16x32_bf16 v[36:39], a[72:75], v[100:103], v[36:39]
    buffer_load_dwordx4 v[96:99], v93, s[4:7], s59 offen offset:1024 sc1
    v_mfma_f32_16x16x32_bf16 v[36:39], a[88:91], v[104:107], v[36:39]
    v_lshlrev_b32 v54, 16, v9
    v_and_b32 v55, s41, v9
    v_mfma_f32_16x16x32_bf16 v[40:43], a[76:79], v[100:103], v[40:43]
    v_lshlrev_b32 v5, 16, v61
    v_and_b32 v95, s41, v61
    v_mfma_f32_16x16x32_bf16 v[40:43], a[92:95], v[104:107], v[40:43]
    s_waitcnt vmcnt(6)
    v_add_f32 v54, v54, v5
    v_add_f32 v55, v55, v95
    v_mfma_f32_16x16x32_bf16 v[28:31], a[96:99], v[108:111], v[28:31]
    buffer_load_dwordx4 v[100:103], v93, s[4:7], s60 offen sc1
    v_mfma_f32_16x16x32_bf16 v[28:31], a[112:115], v[112:115], v[28:31]
    v_lshlrev_b32 v56, 16, v10
    v_and_b32 v57, s41, v10
    v_mfma_f32_16x16x32_bf16 v[32:35], a[100:103], v[108:111], v[32:35]
    v_lshlrev_b32 v5, 16, v62
    v_and_b32 v95, s41, v62
    v_mfma_f32_16x16x32_bf16 v[32:35], a[116:119], v[112:115], v[32:35]
    v_add_f32 v56, v56, v5
    v_add_f32 v57, v57, v95
    v_mfma_f32_16x16x32_bf16 v[36:39], a[104:107], v[108:111], v[36:39]
    buffer_load_dwordx4 v[104:107], v93, s[4:7], s60 offen offset:1024 sc1
    v_mfma_f32_16x16x32_bf16 v[36:39], a[120:123], v[112:115], v[36:39]
    v_lshlrev_b32 v58, 16, v11
    v_and_b32 v59, s41, v11
    v_mfma_f32_16x16x32_bf16 v[40:43], a[108:111], v[108:111], v[40:43]
    v_lshlrev_b32 v5, 16, v63
    v_and_b32 v95, s41, v63
    v_mfma_f32_16x16x32_bf16 v[40:43], a[124:127], v[112:115], v[40:43]
    s_waitcnt vmcnt(5)
    v_add_f32 v58, v58, v5
    v_add_f32 v59, v59, v95
    v_mfma_f32_16x16x32_bf16 v[28:31], a[128:131], v[116:119], v[28:31]
    buffer_load_dwordx4 v[108:111], v93, s[4:7], s61 offen sc1
    v_mfma_f32_16x16x32_bf16 v[28:31], a[144:147], v[120:123], v[28:31]
    v_lshlrev_b32 v84, 16, v12
    v_and_b32 v85, s41, v12
    s_waitcnt vmcnt(5)
    v_mfma_f32_16x16x32_bf16 v[28:31], a[160:163], v[124:127], v[28:31]
    v_lshlrev_b32 v5, 16, v60
    v_and_b32 v95, s41, v60
    v_mfma_f32_16x16x32_bf16 v[32:35], a[132:135], v[116:119], v[32:35]
    v_add_f32 v84, v84, v5
    v_add_f32 v85, v85, v95
    v_mfma_f32_16x16x32_bf16 v[32:35], a[148:151], v[120:123], v[32:35]
    buffer_load_dwordx4 v[112:115], v93, s[4:7], s61 offen offset:1024 sc1
    v_mfma_f32_16x16x32_bf16 v[32:35], a[164:167], v[124:127], v[32:35]
    v_lshlrev_b32 v86, 16, v13
    v_and_b32 v87, s41, v13
    v_mfma_f32_16x16x32_bf16 v[36:39], a[136:139], v[116:119], v[36:39]
    v_lshlrev_b32 v5, 16, v61
    v_and_b32 v95, s41, v61
    v_mfma_f32_16x16x32_bf16 v[36:39], a[152:155], v[120:123], v[36:39]
    v_add_f32 v86, v86, v5
    v_add_f32 v87, v87, v95
    v_mfma_f32_16x16x32_bf16 v[36:39], a[168:171], v[124:127], v[36:39]
    v_lshlrev_b32 v88, 16, v14
    v_and_b32 v89, s41, v14
    v_mfma_f32_16x16x32_bf16 v[40:43], a[140:143], v[116:119], v[40:43]
    s_barrier
    buffer_load_dword v94, v3, s[4:7], 0 offen sc1
    v_mfma_f32_16x16x32_bf16 v[40:43], a[156:159], v[120:123], v[40:43]
    v_lshlrev_b32 v5, 16, v62
    v_and_b32 v95, s41, v62
    v_mfma_f32_16x16x32_bf16 v[40:43], a[172:175], v[124:127], v[40:43]
    s_waitcnt vmcnt(6)
    v_add_f32 v88, v88, v5
    v_add_f32 v89, v89, v95
    s_waitcnt lgkmcnt(0)
    v_mfma_f32_16x16x32_bf16 v[44:47], a[0:3], v[128:131], 0
    buffer_load_dwordx4 v[116:119], v93, s[4:7], s62 offen sc1
    v_mfma_f32_16x16x32_bf16 v[44:47], a[16:19], v[132:135], v[44:47]
    v_lshlrev_b32 v90, 16, v15
    v_and_b32 v91, s41, v15
    v_mfma_f32_16x16x32_bf16 v[48:51], a[4:7], v[128:131], 0
    v_lshlrev_b32 v5, 16, v63
    v_and_b32 v95, s41, v63
    v_mfma_f32_16x16x32_bf16 v[48:51], a[20:23], v[132:135], v[48:51]
    v_add_f32 v90, v90, v5
    v_add_f32 v91, v91, v95
    v_mfma_f32_16x16x32_bf16 v[52:55], a[8:11], v[128:131], v[52:55]
    buffer_load_dwordx4 v[120:123], v93, s[4:7], s62 offen offset:1024 sc1
    v_mfma_f32_16x16x32_bf16 v[52:55], a[24:27], v[132:135], v[52:55]
    v_mfma_f32_16x16x32_bf16 v[56:59], a[12:15], v[128:131], v[56:59]
    ds_write_b128 v136, v[28:31] offset:0
    v_mfma_f32_16x16x32_bf16 v[56:59], a[28:31], v[132:135], v[56:59]
    s_waitcnt vmcnt(6)
    v_mfma_f32_16x16x32_bf16 v[44:47], a[32:35], v[96:99], v[44:47]
    buffer_load_dwordx4 v[124:127], v93, s[4:7], s2 offen sc1
    v_mfma_f32_16x16x32_bf16 v[44:47], a[48:51], v[100:103], v[44:47]
    v_mfma_f32_16x16x32_bf16 v[48:51], a[36:39], v[96:99], v[48:51]
    ds_write_b128 v136, v[32:35] offset:1024
    v_mfma_f32_16x16x32_bf16 v[48:51], a[52:55], v[100:103], v[48:51]
    v_mfma_f32_16x16x32_bf16 v[52:55], a[40:43], v[96:99], v[52:55]
    buffer_load_dwordx4 v[128:131], v93, s[4:7], s39 offen sc1
    v_mfma_f32_16x16x32_bf16 v[52:55], a[56:59], v[100:103], v[52:55]
    v_mfma_f32_16x16x32_bf16 v[56:59], a[44:47], v[96:99], v[56:59]
    ds_write_b128 v137, v[36:39] offset:2048
    v_mfma_f32_16x16x32_bf16 v[56:59], a[60:63], v[100:103], v[56:59]
    s_waitcnt vmcnt(6)
    v_mfma_f32_16x16x32_bf16 v[44:47], a[64:67], v[104:107], v[44:47]
    v_mfma_f32_16x16x32_bf16 v[44:47], a[80:83], v[108:111], v[44:47]
    s_add_u32 s82, s1, 3
    s_waitcnt vmcnt(4)
    v_subrev_u32 v94, s82, v94
    v_cmp_lt_u32 s[82:83], 12, v94
    v_mfma_f32_16x16x32_bf16 v[48:51], a[68:71], v[104:107], v[48:51]
    ds_write_b128 v137, v[40:43] offset:3072
    v_mfma_f32_16x16x32_bf16 v[48:51], a[84:87], v[108:111], v[48:51]
    s_nop 0
    s_cmp_lg_u64 s[82:83], 0
    s_cbranch_scc1 L16s
L16:
    v_mfma_f32_16x16x32_bf16 v[52:55], a[72:75], v[104:107], v[52:55]
    v_xor_b32 v7, 4096, v7
    ds_read_b128 v[132:135], v7 offset:22528
    v_mfma_f32_16x16x32_bf16 v[52:55], a[88:91], v[108:111], v[52:55]
    v_mfma_f32_16x16x32_bf16 v[56:59], a[76:79], v[104:107], v[56:59]
    buffer_load_dwordx4 v[96:99], v142, s[4:7], s59 offen sc1
    v_mfma_f32_16x16x32_bf16 v[56:59], a[92:95], v[108:111], v[56:59]
    s_waitcnt vmcnt(4)
    v_mfma_f32_16x16x32_bf16 v[44:47], a[96:99], v[112:115], v[44:47]
    buffer_load_dwordx4 v[100:103], v142, s[4:7], s59 offen offset:1024 sc1
    v_mfma_f32_16x16x32_bf16 v[44:47], a[112:115], v[116:119], v[44:47]
    v_mfma_f32_16x16x32_bf16 v[48:51], a[100:103], v[112:115], v[48:51]
    v_mfma_f32_16x16x32_bf16 v[48:51], a[116:119], v[116:119], v[48:51]
    v_mfma_f32_16x16x32_bf16 v[52:55], a[104:107], v[112:115], v[52:55]
    buffer_load_dwordx4 v[104:107], v142, s[4:7], s60 offen sc1
    v_mfma_f32_16x16x32_bf16 v[52:55], a[120:123], v[116:119], v[52:55]
    v_mfma_f32_16x16x32_bf16 v[56:59], a[108:111], v[112:115], v[56:59]
    v_mfma_f32_16x16x32_bf16 v[56:59], a[124:127], v[116:119], v[56:59]
    s_waitcnt vmcnt(4)
    v_mfma_f32_16x16x32_bf16 v[44:47], a[128:131], v[120:123], v[44:47]
    buffer_load_dwordx4 v[108:111], v142, s[4:7], s60 offen offset:1024 sc1
    v_mfma_f32_16x16x32_bf16 v[44:47], a[144:147], v[124:127], v[44:47]
    s_waitcnt vmcnt(4)
    v_mfma_f32_16x16x32_bf16 v[44:47], a[160:163], v[128:131], v[44:47]
    v_mfma_f32_16x16x32_bf16 v[48:51], a[132:135], v[120:123], v[48:51]
    v_mfma_f32_16x16x32_bf16 v[48:51], a[148:151], v[124:127], v[48:51]
    buffer_load_dwordx4 v[112:115], v142, s[4:7], s61 offen sc1
    v_mfma_f32_16x16x32_bf16 v[48:51], a[164:167], v[128:131], v[48:51]
    v_mfma_f32_16x16x32_bf16 v[52:55], a[136:139], v[120:123], v[52:55]
    v_mfma_f32_16x16x32_bf16 v[52:55], a[152:155], v[124:127], v[52:55]
    v_mfma_f32_16x16x32_bf16 v[52:55], a[168:171], v[128:131], v[52:55]
    buffer_load_dwordx4 v[116:119], v142, s[4:7], s61 offen offset:1024 sc1
    v_mfma_f32_16x16x32_bf16 v[56:59], a[140:143], v[120:123], v[56:59]
    v_mfma_f32_16x16x32_bf16 v[56:59], a[156:159], v[124:127], v[56:59]
    v_mfma_f32_16x16x32_bf16 v[56:59], a[172:175], v[128:131], v[56:59]
    s_waitcnt vmcnt(5) lgkmcnt(0)
    v_mfma_f32_16x16x32_bf16 v[60:63], a[0:3], v[132:135], 0
    buffer_load_dwordx4 v[120:123], v142, s[4:7], s62 offen sc1
    v_mfma_f32_16x16x32_bf16 v[60:63], a[16:19], v[96:99], v[60:63]
    v_mfma_f32_16x16x32_bf16 v[64:67], a[4:7], v[132:135], 0
    v_mfma_f32_16x16x32_bf16 v[64:67], a[20:23], v[96:99], v[64:67]
    v_mfma_f32_16x16x32_bf16 v[68:71], a[8:11], v[132:135], 0
    buffer_load_dwordx4 v[124:127], v142, s[4:7], s62 offen offset:1024 sc1
    v_mfma_f32_16x16x32_bf16 v[68:71], a[24:27], v[96:99], v[68:71]
    ds_write_b128 v138, v[44:47] offset:4096
    v_mfma_f32_16x16x32_bf16 v[72:75], a[12:15], v[132:135], 0
    v_mfma_f32_16x16x32_bf16 v[72:75], a[28:31], v[96:99], v[72:75]
    s_waitcnt vmcnt(5)
    v_mfma_f32_16x16x32_bf16 v[60:63], a[32:35], v[100:103], v[60:63]
    buffer_load_dwordx4 v[128:131], v142, s[4:7], s2 offen sc1
    v_mfma_f32_16x16x32_bf16 v[60:63], a[48:51], v[104:107], v[60:63]
    ds_write_b128 v138, v[48:51] offset:5120
    v_mfma_f32_16x16x32_bf16 v[64:67], a[36:39], v[100:103], v[64:67]
    v_mfma_f32_16x16x32_bf16 v[64:67], a[52:55], v[104:107], v[64:67]
    v_mfma_f32_16x16x32_bf16 v[68:71], a[40:43], v[100:103], v[68:71]
    buffer_load_dwordx4 v[132:135], v142, s[4:7], s39 offen sc1
    v_mfma_f32_16x16x32_bf16 v[68:71], a[56:59], v[104:107], v[68:71]
    v_xor_b32 v7, 4096, v7
    ds_read_b128 v[96:99], v7 offset:22528
    v_mfma_f32_16x16x32_bf16 v[72:75], a[44:47], v[100:103], v[72:75]
    s_waitcnt lgkmcnt(1)
    s_barrier
    v_mfma_f32_16x16x32_bf16 v[72:75], a[60:63], v[104:107], v[72:75]
    s_waitcnt vmcnt(5)
    ds_read_b128 v[28:31], v139 offset:0
    ds_read_b128 v[32:35], v139 offset:1024
    v_mfma_f32_16x16x32_bf16 v[60:63], a[64:67], v[108:111], v[60:63]
    buffer_load_dwordx4 v[100:103], v143, s[4:7], s59 offen sc1
    v_mfma_f32_16x16x32_bf16 v[60:63], a[80:83], v[112:115], v[60:63]
    ds_read_b128 v[36:39], v139 offset:2048
    ds_read_b128 v[40:43], v139 offset:3072
    ds_read_b128 v[44:47], v139 offset:4096
    v_mfma_f32_16x16x32_bf16 v[64:67], a[68:71], v[108:111], v[64:67]
    ds_read_b128 v[48:51], v139 offset:5120
    v_mfma_f32_16x16x32_bf16 v[64:67], a[84:87], v[112:115], v[64:67]
    v_mfma_f32_16x16x32_bf16 v[68:71], a[72:75], v[108:111], v[68:71]
    buffer_load_dwordx4 v[104:107], v143, s[4:7], s59 offen offset:1024 sc1
    v_mfma_f32_16x16x32_bf16 v[68:71], a[88:91], v[112:115], v[68:71]
    v_mfma_f32_16x16x32_bf16 v[72:75], a[76:79], v[108:111], v[72:75]
    v_mfma_f32_16x16x32_bf16 v[72:75], a[92:95], v[112:115], v[72:75]
    s_waitcnt vmcnt(5) lgkmcnt(5)
    v_add_f32 v52, v52, v28
    v_add_f32 v53, v53, v29
    v_mfma_f32_16x16x32_bf16 v[60:63], a[96:99], v[116:119], v[60:63]
    buffer_load_dwordx4 v[108:111], v143, s[4:7], s60 offen sc1
    v_mfma_f32_16x16x32_bf16 v[60:63], a[112:115], v[120:123], v[60:63]
    v_add_f32 v54, v54, v30
    v_add_f32 v55, v55, v31
    v_mfma_f32_16x16x32_bf16 v[64:67], a[100:103], v[116:119], v[64:67]
    s_waitcnt lgkmcnt(4)
    v_add_f32 v56, v56, v32
    v_add_f32 v57, v57, v33
    v_mfma_f32_16x16x32_bf16 v[64:67], a[116:119], v[120:123], v[64:67]
    v_add_f32 v58, v58, v34
    v_add_f32 v59, v59, v35
    v_mfma_f32_16x16x32_bf16 v[68:71], a[104:107], v[116:119], v[68:71]
    buffer_load_dwordx4 v[112:115], v143, s[4:7], s60 offen offset:1024 sc1
    v_mfma_f32_16x16x32_bf16 v[68:71], a[120:123], v[120:123], v[68:71]
    s_waitcnt lgkmcnt(3)
    v_add_f32 v52, v52, v36
    v_add_f32 v53, v53, v37
    v_mfma_f32_16x16x32_bf16 v[72:75], a[108:111], v[116:119], v[72:75]
    v_add_f32 v54, v54, v38
    v_add_f32 v55, v55, v39
    v_mfma_f32_16x16x32_bf16 v[72:75], a[124:127], v[120:123], v[72:75]
    s_waitcnt vmcnt(5) lgkmcnt(2)
    v_add_f32 v56, v56, v40
    v_add_f32 v57, v57, v41
    v_mfma_f32_16x16x32_bf16 v[60:63], a[128:131], v[124:127], v[60:63]
    buffer_load_dwordx4 v[116:119], v143, s[4:7], s61 offen sc1
    v_mfma_f32_16x16x32_bf16 v[60:63], a[144:147], v[128:131], v[60:63]
    v_add_f32 v58, v58, v42
    v_add_f32 v59, v59, v43
    s_waitcnt vmcnt(5)
    v_mfma_f32_16x16x32_bf16 v[60:63], a[160:163], v[132:135], v[60:63]
    s_waitcnt lgkmcnt(1)
    v_add_f32 v52, v52, v44
    v_add_f32 v53, v53, v45
    v_mfma_f32_16x16x32_bf16 v[64:67], a[132:135], v[124:127], v[64:67]
    v_add_f32 v54, v54, v46
    v_add_f32 v55, v55, v47
    v_mfma_f32_16x16x32_bf16 v[64:67], a[148:151], v[128:131], v[64:67]
    buffer_load_dwordx4 v[120:123], v143, s[4:7], s61 offen offset:1024 sc1
    v_mfma_f32_16x16x32_bf16 v[64:67], a[164:167], v[132:135], v[64:67]
    s_waitcnt lgkmcnt(0)
    v_add_f32 v56, v56, v48
    v_add_f32 v57, v57, v49
    v_mfma_f32_16x16x32_bf16 v[68:71], a[136:139], v[124:127], v[68:71]
    v_add_f32 v58, v58, v50
    v_add_f32 v59, v59, v51
    v_mfma_f32_16x16x32_bf16 v[68:71], a[152:155], v[128:131], v[68:71]
    v_cvt_pk_bf16_f32 v28, v52, v53
    v_cvt_pk_bf16_f32 v29, v54, v55
    v_mfma_f32_16x16x32_bf16 v[68:71], a[168:171], v[132:135], v[68:71]
    v_cvt_pk_bf16_f32 v30, v56, v57
    v_cvt_pk_bf16_f32 v31, v58, v59
    v_mfma_f32_16x16x32_bf16 v[72:75], a[140:143], v[124:127], v[72:75]
    buffer_store_dwordx4 v[28:31], v140, s[4:7], 0 offen
    v_mfma_f32_16x16x32_bf16 v[72:75], a[156:159], v[128:131], v[72:75]
    v_mfma_f32_16x16x32_bf16 v[36:39], v[28:31], v[28:31], 0
    v_mfma_f32_16x16x32_bf16 v[72:75], a[172:175], v[132:135], v[72:75]
    s_waitcnt vmcnt(6)
    v_mfma_f32_16x16x32_bf16 v[40:43], v[24:27], v[28:31], 0
    v_mfma_f32_16x16x32_bf16 v[76:79], a[0:3], v[96:99], 0
    buffer_load_dwordx4 v[124:127], v143, s[4:7], s62 offen sc1
    v_mfma_f32_16x16x32_bf16 v[76:79], a[16:19], v[100:103], v[76:79]
    v_bfe_u32 v5, v1, 7, 2
    v_xor_b32 v5, s28, v5
    v_mfma_f32_16x16x32_bf16 v[80:83], a[4:7], v[96:99], 0
    v_lshlrev_b32 v5, 5, v5
    v_bfe_u32 v95, v1, 6, 2
    v_mfma_f32_16x16x32_bf16 v[80:83], a[20:23], v[100:103], v[80:83]
    buffer_load_dwordx4 v[128:131], v143, s[4:7], s62 offen offset:1024 sc1
    v_mfma_f32_16x16x32_bf16 v[84:87], a[8:11], v[96:99], v[84:87]
    ds_write_b128 v136, v[60:63] offset:32768
    v_mfma_f32_16x16x32_bf16 v[84:87], a[24:27], v[100:103], v[84:87]
    v_cndmask_b32 v36, v36, v37, s[76:77]
    v_cndmask_b32 v36, v36, v38, s[78:79]
    v_mfma_f32_16x16x32_bf16 v[88:91], a[12:15], v[96:99], v[88:91]
    buffer_load_dwordx4 v[132:135], v143, s[4:7], s2 offen sc1
    v_mfma_f32_16x16x32_bf16 v[88:91], a[28:31], v[100:103], v[88:91]
    s_waitcnt vmcnt(7)
    ds_write_b128 v136, v[64:67] offset:33792
    v_mfma_f32_16x16x32_bf16 v[76:79], a[32:35], v[104:107], v[76:79]
    v_cndmask_b32 v41, v36, v39, s[80:81]
    v_mfma_f32_16x16x32_bf16 v[76:79], a[48:51], v[108:111], v[76:79]
    buffer_load_dwordx4 v[96:99], v143, s[4:7], s39 offen sc1
    s_waitcnt vmcnt(7)
    v_mfma_f32_16x16x32_bf16 v[76:79], a[64:67], v[112:115], v[76:79]
    ds_write_b128 v137, v[68:71] offset:34816
    v_mfma_f32_16x16x32_bf16 v[80:83], a[36:39], v[104:107], v[80:83]
    buffer_store_dwordx2 v[40:41], v141, s[4:7], 0 offen
    v_mfma_f32_16x16x32_bf16 v[80:83], a[52:55], v[108:111], v[80:83]
    v_lshl_add_u32 v5, v95, 7, v5
    v_lshrrev_b32 v95, 8, v1
    v_mfma_f32_16x16x32_bf16 v[80:83], a[68:71], v[112:115], v[80:83]
    ds_write_b128 v137, v[72:75] offset:35840
    v_mfma_f32_16x16x32_bf16 v[84:87], a[40:43], v[104:107], v[84:87]
    v_lshl_add_u32 v5, v95, 10, v5
    v_bfe_u32 v95, v1, 4, 2
    v_mfma_f32_16x16x32_bf16 v[84:87], a[56:59], v[108:111], v[84:87]
    v_lshl_add_u32 v5, v95, 3, v5
    v_add_u32 v0, 65536, v5
    v_mfma_f32_16x16x32_bf16 v[84:87], a[72:75], v[112:115], v[84:87]
    v_add_u32 v6, s45, 4
    s_cmp_eq_u32 s46, 0
    s_mov_b64 exec, s[72:73]
    s_waitcnt vmcnt(5)
    s_cbranch_scc1 L17s
    buffer_store_dword v6, v3, s[4:7], 0 offen
L17:
    s_mov_b64 exec, -1
    v_mfma_f32_16x16x32_bf16 v[88:91], a[44:47], v[104:107], v[88:91]
    s_waitcnt lgkmcnt(0)
    s_barrier
    v_mfma_f32_16x16x32_bf16 v[88:91], a[60:63], v[108:111], v[88:91]
    ds_read_b128 v[60:63], v139 offset:32768
    ds_read_b128 v[64:67], v139 offset:33792
    ds_read_b128 v[68:71], v139 offset:34816
    v_mfma_f32_16x16x32_bf16 v[88:91], a[76:79], v[112:115], v[88:91]
    ds_read_b128 v[72:75], v139 offset:35840
    v_mfma_f32_16x16x32_bf16 v[76:79], a[80:83], v[116:119], v[76:79]
    v_mfma_f32_16x16x32_bf16 v[76:79], a[96:99], v[120:123], v[76:79]
    v_mfma_f32_16x16x32_bf16 v[80:83], a[84:87], v[116:119], v[80:83]
    v_mfma_f32_16x16x32_bf16 v[80:83], a[100:103], v[120:123], v[80:83]
    s_waitcnt vmcnt(4)
    v_mfma_f32_16x16x32_bf16 v[76:79], a[112:115], v[124:127], v[76:79]
    v_mfma_f32_16x16x32_bf16 v[76:79], a[128:131], v[128:131], v[76:79]
    v_mfma_f32_16x16x32_bf16 v[80:83], a[116:119], v[124:127], v[80:83]
    s_waitcnt lgkmcnt(1)
    v_add_f32 v60, v60, v68
    v_add_f32 v61, v61, v69
    v_mfma_f32_16x16x32_bf16 v[80:83], a[132:135], v[128:131], v[80:83]
    s_waitcnt vmcnt(2)
    v_add_f32 v62, v62, v70
    v_add_f32 v63, v63, v71
    v_mfma_f32_16x16x32_bf16 v[76:79], a[144:147], v[132:135], v[76:79]
    s_waitcnt lgkmcnt(0)
    v_add_f32 v64, v64, v72
    v_add_f32 v65, v65, v73
    v_mfma_f32_16x16x32_bf16 v[76:79], a[160:163], v[96:99], v[76:79]
    v_add_f32 v66, v66, v74
    v_add_f32 v67, v67, v75
    v_mfma_f32_16x16x32_bf16 v[80:83], a[148:151], v[132:135], v[80:83]
    v_mfma_f32_16x16x32_bf16 v[80:83], a[164:167], v[96:99], v[80:83]
    v_mfma_f32_16x16x32_bf16 v[84:87], a[88:91], v[116:119], v[84:87]
    v_mfma_f32_16x16x32_bf16 v[84:87], a[104:107], v[120:123], v[84:87]
    v_mfma_f32_16x16x32_bf16 v[84:87], a[120:123], v[124:127], v[84:87]
    s_nop 0
    ds_write_b128 v138, v[76:79] offset:36864
    v_mfma_f32_16x16x32_bf16 v[84:87], a[136:139], v[128:131], v[84:87]
    v_mfma_f32_16x16x32_bf16 v[84:87], a[152:155], v[132:135], v[84:87]
    s_nop 0
    ds_write_b128 v138, v[80:83] offset:37888
    buffer_load_dword v94, v3, s[4:7], 0 offen sc1
    v_mfma_f32_16x16x32_bf16 v[84:87], a[168:171], v[96:99], v[84:87]
    v_mfma_f32_16x16x32_bf16 v[88:91], a[92:95], v[116:119], v[88:91]
    v_mfma_f32_16x16x32_bf16 v[88:91], a[108:111], v[120:123], v[88:91]
    v_mfma_f32_16x16x32_bf16 v[88:91], a[124:127], v[124:127], v[88:91]
    s_waitcnt lgkmcnt(0)
    s_barrier
    ds_read_b128 v[76:79], v139 offset:36864
    ds_read_b128 v[80:83], v139 offset:37888
    v_mfma_f32_16x16x32_bf16 v[88:91], a[140:143], v[128:131], v[88:91]
    v_mfma_f32_16x16x32_bf16 v[88:91], a[156:159], v[132:135], v[88:91]
    v_mfma_f32_16x16x32_bf16 v[88:91], a[172:175], v[96:99], v[88:91]
    v_add_u32 v97, s99, v1
    s_add_u32 s82, s1, 4
    s_waitcnt vmcnt(0)
    v_subrev_u32 v94, s82, v94
    v_cmp_lt_u32 s[82:83], 11, v94
    s_nop 3
    s_cmp_lg_u64 s[82:83], 0
    s_cbranch_scc1 L18s
L18:
    s_add_u32 m0, s0, 0
    s_nop 0
    buffer_load_dwordx4 v97, s[4:7], 0 offen sc1 lds
    s_add_u32 m0, s0, 0
    s_nop 0
    buffer_load_dwordx4 v97, s[4:7], 0 offen offset:2048 sc1 lds
    v_pk_add_f32 v[84:85], v[84:85], v[60:61]
    v_pk_add_f32 v[86:87], v[86:87], v[62:63]
    v_pk_add_f32 v[88:89], v[88:89], v[64:65]
    v_pk_add_f32 v[90:91], v[90:91], v[66:67]
    s_waitcnt lgkmcnt(1)
    v_pk_add_f32 v[84:85], v[84:85], v[76:77]
    v_pk_add_f32 v[86:87], v[86:87], v[78:79]
    s_waitcnt lgkmcnt(0)
    v_pk_add_f32 v[88:89], v[88:89], v[80:81]
    v_pk_add_f32 v[90:91], v[90:91], v[82:83]
    v_cvt_pk_bf16_f32 v84, v84, v85
    v_cvt_pk_bf16_f32 v85, v86, v87
    v_cvt_pk_bf16_f32 v86, v88, v89
    v_cvt_pk_bf16_f32 v87, v90, v91
    buffer_store_dwordx4 v[84:87], v140, s[4:7], s55 offen
    s_nop 0
    v_mfma_f32_16x16x32_bf16 v[104:107], v[84:87], v[84:87], 0
    v_mfma_f32_16x16x32_bf16 v[108:111], v[24:27], v[84:87], 0
    s_add_u32 m0, s0, 4096
    s_nop 0
    buffer_load_dwordx4 v97, s[4:7], s48 offen sc1 lds
    s_add_u32 m0, s0, 4096
    s_nop 0
    buffer_load_dwordx4 v97, s[4:7], s48 offen offset:2048 sc1 lds
    s_nop 0
    v_cndmask_b32 v104, v104, v105, s[76:77]
    v_cndmask_b32 v104, v104, v106, s[78:79]
    v_cndmask_b32 v109, v104, v107, s[80:81]
    buffer_store_dwordx2 v[108:109], v141, s[4:7], 0 offen offset:512
    ds_read_b64_tr_b16 v[104:105], v0 offset:0
    ds_read_b64_tr_b16 v[106:107], v0 offset:512
    ds_read_b64_tr_b16 v[108:109], v0 offset:4096
    ds_read_b64_tr_b16 v[110:111], v0 offset:4608
    s_waitcnt vmcnt(4)
    s_barrier
    ds_read_b128 v[60:63], v1 offset:0
    ds_read_b128 v[64:67], v1 offset:1024
    ds_read_b128 v[68:71], v1 offset:16384
    ds_read_b128 v[72:75], v1 offset:17408
    s_waitcnt lgkmcnt(3)
    v_mfma_f32_16x16x32_bf16 v[28:31], a[176:179], v[60:63], 0
    ds_read_b128 v[76:79], v1 offset:2048
    s_add_u32 m0, s0, 8192
    s_lshl_b32 s85, s30, 13
    s_waitcnt lgkmcnt(3)
    v_mfma_f32_16x16x32_bf16 v[28:31], a[180:183], v[64:67], v[28:31]
    ds_read_b64_tr_b16 v[112:113], v0 offset:8192
    s_add_u32 s85, s85, 9740288
    v_bfe_u32 v120, v1, 4, 4
    v_mfma_f32_16x16x32_bf16 v[44:47], v[60:63], v[144:147], 0
    buffer_load_dwordx4 v97, s[4:7], s49 offen sc1 lds
    v_mfma_f32_16x16x32_bf16 v[44:47], v[64:67], v[148:151], v[44:47]
    ds_read_b128 v[132:135], v1 offset:3072
    s_add_u32 m0, s0, 8192
    v_lshrrev_b32 v121, 8, v1
    v_mfma_f32_16x16x32_bf16 v[8:11], v[104:107], v[60:63], 0
    ds_read_b64_tr_b16 v[114:115], v0 offset:8704
    buffer_load_dwordx4 v97, s[4:7], s49 offen offset:2048 sc1 lds
    v_mfma_f32_16x16x32_bf16 v[8:11], v[108:111], v[64:67], v[8:11]
    s_waitcnt lgkmcnt(4)
    s_add_u32 m0, s0, 12288
    v_lshrrev_b32 v122, 8, s47
    v_mfma_f32_16x16x32_bf16 v[32:35], a[176:179], v[68:71], 0
    ds_read_b128 v[60:63], v1 offset:18432
    v_lshlrev_b32 v128, 11, v121
    v_lshl_add_u32 v128, v120, 4, v128
    v_mfma_f32_16x16x32_bf16 v[32:35], a[180:183], v[72:75], v[32:35]
    ds_read_b64_tr_b16 v[116:117], v0 offset:12288
    v_lshl_add_u32 v128, v122, 6, v128
    v_lshl_add_u32 v129, v120, 4, v122
    v_mfma_f32_16x16x32_bf16 v[48:51], v[68:71], v[144:147], 0
    buffer_load_dwordx4 v97, s[4:7], s50 offen sc1 lds
    v_mfma_f32_16x16x32_bf16 v[48:51], v[72:75], v[148:151], v[48:51]
    ds_read_b128 v[64:67], v1 offset:19456
    s_add_u32 m0, s0, 12288
    v_lshlrev_b32 v122, 4, v122
    v_mfma_f32_16x16x32_bf16 v[12:15], v[104:107], v[68:71], 0
    ds_read_b64_tr_b16 v[118:119], v0 offset:12800
    v_lshl_add_u32 v120, v120, 2, v122
    s_mov_b32 vcc_lo, -1
    v_mfma_f32_16x16x32_bf16 v[12:15], v[108:111], v[72:75], v[12:15]
    s_waitcnt lgkmcnt(5)
    s_mov_b32 vcc_hi, 0
    v_cndmask_b32 v129, v120, v129, vcc
    v_mfma_f32_16x16x32_bf16 v[28:31], a[184:187], v[76:79], v[28:31]
    s_waitcnt vmcnt(4)
    s_barrier
    ds_read_b128 v[68:71], v1 offset:4096
    v_mfma_f32_16x16x32_bf16 v[28:31], a[188:191], v[132:135], v[28:31]
    ds_read_b64_tr_b16 v[104:105], v0 offset:16384
    v_lshl_add_u32 v129, v121, 8, v129
    v_add_u32 v129, 147456, v129
    v_mfma_f32_16x16x32_bf16 v[44:47], v[76:79], v[152:155], v[44:47]
    buffer_load_dwordx4 v97, s[4:7], s50 offen offset:2048 sc1 lds
    v_mfma_f32_16x16x32_bf16 v[44:47], v[132:135], v[156:159], v[44:47]
    ds_read_b128 v[72:75], v1 offset:5120
    v_and_b32 v98, 0xf0, v1
    v_add_u32 v98, 147456, v98
    s_waitcnt lgkmcnt(7)
    v_mfma_f32_16x16x32_bf16 v[8:11], v[112:115], v[76:79], v[8:11]
    ds_read_b64_tr_b16 v[106:107], v0 offset:16896
    v_lshrrev_b32 v100, 8, v1
    v_lshl_add_u32 v99, v100, 2, v98
    s_waitcnt lgkmcnt(4)
    v_mfma_f32_16x16x32_bf16 v[8:11], v[116:119], v[132:135], v[8:11]
    v_lshlrev_b32 v100, 4, v100
    v_add_u32 v100, 147968, v100
    v_mfma_f32_16x16x32_bf16 v[32:35], a[184:187], v[60:63], v[32:35]
    ds_read_b128 v[76:79], v1 offset:20480
    v_lshrrev_b32 v5, 8, v1
    v_lshlrev_b32 v5, 4, v5
    v_mfma_f32_16x16x32_bf16 v[32:35], a[188:191], v[64:67], v[32:35]
    ds_read_b64_tr_b16 v[108:109], v0 offset:20480
    s_add_u32 s34, s47, 148480
    v_add_u32 v5, s34, v5
    v_mfma_f32_16x16x32_bf16 v[48:51], v[60:63], v[152:155], v[48:51]
    v_add_u32 v6, s45, 5
    s_cmp_eq_u32 s46, 0
    s_mov_b64 exec, s[72:73]
    s_waitcnt vmcnt(4)
    s_cbranch_scc1 L19s
    buffer_store_dword v6, v3, s[4:7], 0 offen
L19:
    s_mov_b64 exec, -1
    v_mfma_f32_16x16x32_bf16 v[48:51], v[64:67], v[156:159], v[48:51]
    ds_read_b128 v[132:135], v1 offset:21504
    ds_read_b128 v[80:83], v5 offset:0
    ds_read_b128 v[88:91], v5 offset:64
    v_mfma_f32_16x16x32_bf16 v[12:15], v[112:115], v[60:63], v[12:15]
    ds_read_b64_tr_b16 v[110:111], v0 offset:20992
    v_bfe_u32 v5, v1, 4, 4
    v_lshl_add_u32 v5, v5, 2, s34
    v_mfma_f32_16x16x32_bf16 v[12:15], v[116:119], v[64:67], v[12:15]
    s_waitcnt lgkmcnt(7)
    ds_read_b32 v84, v5 offset:320
    s_add_u32 s16, s16, 1048576
    v_mfma_f32_16x16x32_bf16 v[28:31], a[192:195], v[68:71], v[28:31]
    ds_read_b128 v[60:63], v1 offset:6144
    s_add_u32 s19, s19, 1048576
    s_add_u32 s17, s17, 65536
    v_mfma_f32_16x16x32_bf16 v[28:31], a[196:199], v[72:75], v[28:31]
    ds_read_b64_tr_b16 v[112:113], v0 offset:24576
    s_add_u32 s18, s18, 65536
    s_add_u32 s20, s20, 262144
    v_mfma_f32_16x16x32_bf16 v[44:47], v[68:71], v[160:163], v[44:47]
    s_add_u32 s21, s21, 262144
    v_bfe_u32 v137, v1, 5, 2
    v_lshlrev_b32 v137, 4, v137
    v_mfma_f32_16x16x32_bf16 v[44:47], v[72:75], v[164:167], v[44:47]
    ds_read_b128 v[64:67], v1 offset:7168
    v_lshl_add_u32 v136, v1, 2, v137
    v_lshrrev_b32 v140, 6, v1
    s_waitcnt lgkmcnt(10)
    v_mfma_f32_16x16x32_bf16 v[8:11], v[104:107], v[68:71], v[8:11]
    ds_read_b64_tr_b16 v[114:115], v0 offset:25088
    v_bfe_u32 v137, v1, 7, 2
    v_bfe_u32 v138, v1, 5, 1
    s_waitcnt lgkmcnt(5)
    v_mfma_f32_16x16x32_bf16 v[8:11], v[108:111], v[72:75], v[8:11]
    v_xor_b32 v137, v137, v138
    v_lshlrev_b32 v137, 4, v137
    v_mfma_f32_16x16x32_bf16 v[32:35], a[192:195], v[76:79], v[32:35]
    ds_read_b128 v[68:71], v1 offset:22528
    v_lshl_add_u32 v140, v140, 6, v137
    v_bfe_u32 v138, v1, 4, 1
    v_mfma_f32_16x16x32_bf16 v[32:35], a[196:199], v[132:135], v[32:35]
    ds_read_b64_tr_b16 v[116:117], v0 offset:28672
    v_lshl_add_u32 v140, v138, 3, v140
    v_mfma_f32_16x16x32_bf16 v[48:51], v[76:79], v[160:163], v[48:51]
    v_mfma_f32_16x16x32_bf16 v[48:51], v[132:135], v[164:167], v[48:51]
    ds_read_b128 v[72:75], v1 offset:23552
    v_mfma_f32_16x16x32_bf16 v[12:15], v[104:107], v[76:79], v[12:15]
    ds_read_b64_tr_b16 v[118:119], v0 offset:29184
    v_mfma_f32_16x16x32_bf16 v[12:15], v[108:111], v[132:135], v[12:15]
    s_waitcnt lgkmcnt(5)
    v_mfma_f32_16x16x32_bf16 v[28:31], a[200:203], v[60:63], v[28:31]
    s_waitcnt vmcnt(1)
    s_barrier
    ds_read_b128 v[76:79], v1 offset:8192
    v_mfma_f32_16x16x32_bf16 v[28:31], a[204:207], v[64:67], v[28:31]
    ds_read_b64_tr_b16 v[104:105], v0 offset:32768
    v_mfma_f32_16x16x32_bf16 v[44:47], v[60:63], v[168:171], v[44:47]
    buffer_load_dword v103, v3, s[4:7], 0 offen sc1
    v_mfma_f32_16x16x32_bf16 v[44:47], v[64:67], v[172:175], v[44:47]
    ds_read_b128 v[132:135], v1 offset:9216
    s_waitcnt lgkmcnt(7)
    v_mfma_f32_16x16x32_bf16 v[8:11], v[112:115], v[60:63], v[8:11]
    ds_read_b64_tr_b16 v[106:107], v0 offset:33280
    s_waitcnt lgkmcnt(4)
    v_mfma_f32_16x16x32_bf16 v[8:11], v[116:119], v[64:67], v[8:11]
    v_mfma_f32_16x16x32_bf16 v[32:35], a[200:203], v[68:71], v[32:35]
    ds_read_b128 v[60:63], v1 offset:24576
    v_mfma_f32_16x16x32_bf16 v[32:35], a[204:207], v[72:75], v[32:35]
    ds_read_b64_tr_b16 v[108:109], v0 offset:36864
    v_mfma_f32_16x16x32_bf16 v[48:51], v[68:71], v[168:171], v[48:51]
    v_mfma_f32_16x16x32_bf16 v[48:51], v[72:75], v[172:175], v[48:51]
    ds_read_b128 v[64:67], v1 offset:25600
    v_mfma_f32_16x16x32_bf16 v[12:15], v[112:115], v[68:71], v[12:15]
    ds_read_b64_tr_b16 v[110:111], v0 offset:37376
    v_mfma_f32_16x16x32_bf16 v[12:15], v[116:119], v[72:75], v[12:15]
    s_waitcnt lgkmcnt(5)
    v_mfma_f32_16x16x32_bf16 v[28:31], a[208:211], v[76:79], v[28:31]
    ds_read_b128 v[68:71], v1 offset:10240
    v_mfma_f32_16x16x32_bf16 v[28:31], a[212:215], v[132:135], v[28:31]
    ds_read_b64_tr_b16 v[112:113], v0 offset:40960
    v_mfma_f32_16x16x32_bf16 v[44:47], v[76:79], v[176:179], v[44:47]
    v_mfma_f32_16x16x32_bf16 v[44:47], v[132:135], v[180:183], v[44:47]
    ds_read_b128 v[72:75], v1 offset:11264
    s_waitcnt lgkmcnt(7)
    v_mfma_f32_16x16x32_bf16 v[8:11], v[104:107], v[76:79], v[8:11]
    ds_read_b64_tr_b16 v[114:115], v0 offset:41472
    s_waitcnt lgkmcnt(4)
    v_mfma_f32_16x16x32_bf16 v[8:11], v[108:111], v[132:135], v[8:11]
    v_mfma_f32_16x16x32_bf16 v[32:35], a[208:211], v[60:63], v[32:35]
    ds_read_b128 v[76:79], v1 offset:26624
    s_add_u32 s82, s1, 5
    s_waitcnt vmcnt(0)
    v_subrev_u32 v103, s82, v103
    v_cmp_lt_u32 s[82:83], 10, v103
    v_mfma_f32_16x16x32_bf16 v[32:35], a[212:215], v[64:67], v[32:35]
    ds_read_b64_tr_b16 v[116:117], v0 offset:45056
    v_mfma_f32_16x16x32_bf16 v[48:51], v[60:63], v[176:179], v[48:51]
    s_nop 0
    s_cmp_lg_u64 s[82:83], 0
    s_cbranch_scc1 L20s
L20:
    v_mfma_f32_16x16x32_bf16 v[48:51], v[64:67], v[180:183], v[48:51]
    ds_read_b128 v[132:135], v1 offset:27648
    s_add_u32 m0, s0, 32768
    v_mfma_f32_16x16x32_bf16 v[12:15], v[104:107], v[60:63], v[12:15]
    ds_read_b64_tr_b16 v[118:119], v0 offset:45568
    buffer_load_dwordx4 v97, s[4:7], s55 offen sc1 lds
    v_mfma_f32_16x16x32_bf16 v[12:15], v[108:111], v[64:67], v[12:15]
    s_waitcnt lgkmcnt(5)
    v_mfma_f32_16x16x32_bf16 v[28:31], a[216:219], v[68:71], v[28:31]
    ds_read_b128 v[60:63], v1 offset:12288
    v_mfma_f32_16x16x32_bf16 v[28:31], a[220:223], v[72:75], v[28:31]
    ds_read_b64_tr_b16 v[104:105], v0 offset:49152
    v_mfma_f32_16x16x32_bf16 v[44:47], v[68:71], v[184:187], v[44:47]
    buffer_load_dwordx4 v[120:123], v128, s[4:7], s85 offen sc1
    v_mfma_f32_16x16x32_bf16 v[44:47], v[72:75], v[188:191], v[44:47]
    ds_read_b128 v[64:67], v1 offset:13312
    s_waitcnt lgkmcnt(7)
    v_mfma_f32_16x16x32_bf16 v[8:11], v[112:115], v[68:71], v[8:11]
    ds_read_b64_tr_b16 v[106:107], v0 offset:49664
    s_waitcnt lgkmcnt(4)
    v_mfma_f32_16x16x32_bf16 v[8:11], v[116:119], v[72:75], v[8:11]
    buffer_load_dwordx4 v[124:127], v128, s[4:7], s85 offen offset:1024 sc1
    v_mfma_f32_16x16x32_bf16 v[32:35], a[216:219], v[76:79], v[32:35]
    ds_read_b128 v[68:71], v1 offset:28672
    s_add_u32 m0, s0, 32768
    v_mfma_f32_16x16x32_bf16 v[32:35], a[220:223], v[132:135], v[32:35]
    ds_read_b64_tr_b16 v[108:109], v0 offset:53248
    v_mfma_f32_16x16x32_bf16 v[48:51], v[76:79], v[184:187], v[48:51]
    v_mfma_f32_16x16x32_bf16 v[48:51], v[132:135], v[188:191], v[48:51]
    ds_read_b128 v[72:75], v1 offset:29696
    buffer_load_dwordx4 v97, s[4:7], s55 offen offset:2048 sc1 lds
    v_mfma_f32_16x16x32_bf16 v[12:15], v[112:115], v[76:79], v[12:15]
    ds_read_b64_tr_b16 v[110:111], v0 offset:53760
    s_add_u32 m0, s0, 36864
    v_mfma_f32_16x16x32_bf16 v[12:15], v[116:119], v[132:135], v[12:15]
    s_waitcnt lgkmcnt(5)
    v_mfma_f32_16x16x32_bf16 v[28:31], a[224:227], v[60:63], v[28:31]
    ds_read_b128 v[76:79], v1 offset:14336
    v_mfma_f32_16x16x32_bf16 v[28:31], a[228:231], v[64:67], v[28:31]
    ds_read_b64_tr_b16 v[112:113], v0 offset:57344
    v_mfma_f32_16x16x32_bf16 v[44:47], v[60:63], a[240:243], v[44:47]
    buffer_load_dwordx4 v97, s[4:7], s56 offen sc1 lds
    v_mfma_f32_16x16x32_bf16 v[44:47], v[64:67], a[244:247], v[44:47]
    ds_read_b128 v[132:135], v1 offset:15360
    s_add_u32 m0, s0, 36864
    s_waitcnt lgkmcnt(7)
    v_mfma_f32_16x16x32_bf16 v[8:11], v[104:107], v[60:63], v[8:11]
    ds_read_b64_tr_b16 v[114:115], v0 offset:57856
    s_waitcnt lgkmcnt(4)
    v_mfma_f32_16x16x32_bf16 v[8:11], v[108:111], v[64:67], v[8:11]
    buffer_load_dwordx4 v97, s[4:7], s56 offen offset:2048 sc1 lds
    v_mfma_f32_16x16x32_bf16 v[32:35], a[224:227], v[68:71], v[32:35]
    ds_read_b128 v[60:63], v1 offset:30720
    s_add_u32 m0, s0, 40960
    v_mfma_f32_16x16x32_bf16 v[32:35], a[228:231], v[72:75], v[32:35]
    ds_read_b64_tr_b16 v[116:117], v0 offset:61440
    v_mfma_f32_16x16x32_bf16 v[48:51], v[68:71], a[240:243], v[48:51]
    v_mfma_f32_16x16x32_bf16 v[48:51], v[72:75], a[244:247], v[48:51]
    ds_read_b128 v[64:67], v1 offset:31744
    buffer_load_dwordx4 v97, s[4:7], s57 offen sc1 lds
    v_mfma_f32_16x16x32_bf16 v[12:15], v[104:107], v[68:71], v[12:15]
    ds_read_b64_tr_b16 v[118:119], v0 offset:61952
    s_add_u32 m0, s0, 40960
    v_mfma_f32_16x16x32_bf16 v[12:15], v[108:111], v[72:75], v[12:15]
    s_waitcnt lgkmcnt(5)
    v_mfma_f32_16x16x32_bf16 v[28:31], a[232:235], v[76:79], v[28:31]
    s_waitcnt vmcnt(6)
    s_barrier
    ds_read_b128 v[68:71], v1 offset:32768
    v_mfma_f32_16x16x32_bf16 v[28:31], a[236:239], v[132:135], v[28:31]
    buffer_load_dwordx4 v97, s[4:7], s57 offen offset:2048 sc1 lds
    v_mfma_f32_16x16x32_bf16 v[44:47], v[76:79], a[248:251], v[44:47]
    s_add_u32 m0, s0, 45056
    s_waitcnt vmcnt(6)
    v_add_f32 v120, v120, v122
    v_add_f32 v121, v121, v123
    v_mfma_f32_16x16x32_bf16 v[44:47], v[132:135], a[252:255], v[44:47]
    ds_read_b128 v[72:75], v1 offset:33792
    s_waitcnt vmcnt(5)
    v_add_f32 v124, v124, v126
    v_add_f32 v125, v125, v127
    s_waitcnt lgkmcnt(6)
    v_mfma_f32_16x16x32_bf16 v[8:11], v[112:115], v[76:79], v[8:11]
    v_add_f32 v120, v120, v124
    v_add_f32 v121, v121, v125
    s_waitcnt lgkmcnt(2)
    v_mfma_f32_16x16x32_bf16 v[8:11], v[116:119], v[132:135], v[8:11]
    v_mov_b32 v122, v120
    v_mov_b32 v123, v121
    v_mfma_f32_16x16x32_bf16 v[32:35], a[232:235], v[60:63], v[32:35]
    ds_read_b128 v[76:79], v1 offset:49152
    v_permlane32_swap_b32 v120, v122
    v_mfma_f32_16x16x32_bf16 v[32:35], a[236:239], v[64:67], v[32:35]
    buffer_load_dwordx4 v97, s[4:7], s58 offen sc1 lds
    v_mfma_f32_16x16x32_bf16 v[48:51], v[60:63], a[248:251], v[48:51]
    s_add_u32 m0, s0, 45056
    v_permlane32_swap_b32 v121, v123
    v_mfma_f32_16x16x32_bf16 v[48:51], v[64:67], a[252:255], v[48:51]
    ds_read_b128 v[132:135], v1 offset:50176
    v_add_f32 v120, v120, v122
    v_add_f32 v121, v121, v123
    v_mfma_f32_16x16x32_bf16 v[12:15], v[112:115], v[60:63], v[12:15]
    buffer_load_dwordx4 v97, s[4:7], s58 offen offset:2048 sc1 lds
    v_mfma_f32_16x16x32_bf16 v[12:15], v[116:119], v[64:67], v[12:15]
    s_waitcnt lgkmcnt(2)
    v_lshrrev_b32 v142, 8, v1
    v_lshl_add_u32 v142, v142, 14, s90
    v_mfma_f32_16x16x32_bf16 v[36:39], a[176:179], v[68:71], 0
    s_waitcnt vmcnt(6)
    s_barrier
    ds_read_b128 v[60:63], v1 offset:34816
    v_mfma_f32_16x16x32_bf16 v[36:39], a[180:183], v[72:75], v[36:39]
    v_min_u32 v142, M_done-interleave_layers__linear_kernel_hedgehog__mixer_channel_mlp__prompt_kernel-128, v142
    v_mov_b32 v122, v120
    v_mfma_f32_16x16x32_bf16 v[52:55], v[68:71], v[144:147], 0
    ds_read_b128 v[64:67], v1 offset:35840
    global_load_dword v142, v142, s[88:89]
    v_mfma_f32_16x16x32_bf16 v[52:55], v[72:75], v[148:151], v[52:55]
    s_waitcnt lgkmcnt(2)
    v_mov_b32 v123, v121
    v_mfma_f32_16x16x32_bf16 v[40:43], a[176:179], v[76:79], 0
    ds_read_b128 v[68:71], v1 offset:51200
    v_permlane16_swap_b32 v120, v122
    v_mfma_f32_16x16x32_bf16 v[40:43], a[180:183], v[132:135], v[40:43]
    v_permlane16_swap_b32 v121, v123
    v_mfma_f32_16x16x32_bf16 v[56:59], v[76:79], v[144:147], 0
    ds_read_b128 v[72:75], v1 offset:52224
    v_add_f32 v120, v120, v122
    v_add_f32 v121, v121, v123
    v_mfma_f32_16x16x32_bf16 v[56:59], v[132:135], v[148:151], v[56:59]
    s_waitcnt lgkmcnt(2)
    v_mul_f32 v120, 0xbb000000, v120
    v_mul_f32 v121, 0x3b000000, v121
    v_mfma_f32_16x16x32_bf16 v[36:39], a[184:187], v[60:63], v[36:39]
    s_waitcnt vmcnt(5)
    s_barrier
    ds_read_b128 v[76:79], v1 offset:36864
    v_mfma_f32_16x16x32_bf16 v[36:39], a[188:191], v[64:67], v[36:39]
    v_add_u32 v7, s93, v1
    v_fma_f32 v121, -v120, v120, v121
    v_mfma_f32_16x16x32_bf16 v[52:55], v[60:63], v[152:155], v[52:55]
    ds_read_b128 v[132:135], v1 offset:37888
    buffer_load_dwordx4 a[176:179], v7, s[4:7], s8 offen
    v_mfma_f32_16x16x32_bf16 v[52:55], v[64:67], v[156:159], v[52:55]
    s_waitcnt lgkmcnt(2)
    v_max_f32 v121, 0, v121
    v_add_f32 v122, 0x3727c5ac, v121
    v_mfma_f32_16x16x32_bf16 v[40:43], a[184:187], v[68:71], v[40:43]
    ds_read_b128 v[60:63], v1 offset:53248
    v_rsq_f32 v122, v122
    v_mfma_f32_16x16x32_bf16 v[40:43], a[188:191], v[72:75], v[40:43]
    buffer_load_dwordx4 a[180:183], v7, s[4:7], s8 offen offset:1024
    v_mfma_f32_16x16x32_bf16 v[56:59], v[68:71], v[152:155], v[56:59]
    ds_read_b128 v[64:67], v1 offset:54272
    s_mov_b32 vcc_lo, 0x0000ffff
    s_mov_b32 vcc_hi, 0x0000ffff
    v_mfma_f32_16x16x32_bf16 v[56:59], v[72:75], v[156:159], v[56:59]
    s_waitcnt lgkmcnt(2)
    v_cndmask_b32 v122, v122, v120, vcc
    ds_write_b32 v129, v122
    v_mfma_f32_16x16x32_bf16 v[36:39], a[192:195], v[76:79], v[36:39]
    ds_read_b128 v[68:71], v1 offset:38912
    v_mov_b32 v141, 131072
    v_lshl_add_u32 v141, s47, 2, v141
    v_mfma_f32_16x16x32_bf16 v[36:39], a[196:199], v[132:135], v[36:39]
    buffer_load_dwordx4 a[184:187], v7, s[4:7], s9 offen
    v_mfma_f32_16x16x32_bf16 v[52:55], v[76:79], v[160:163], v[52:55]
    ds_read_b128 v[72:75], v1 offset:39936
    v_add_u32 v136, v141, v136
    v_add_u32 v140, v141, v140
    v_mfma_f32_16x16x32_bf16 v[52:55], v[132:135], v[164:167], v[52:55]
    s_waitcnt lgkmcnt(3)
    s_waitcnt lgkmcnt(2)
    s_barrier
    v_mfma_f32_16x16x32_bf16 v[40:43], a[192:195], v[60:63], v[40:43]
    ds_read_b128 v[76:79], v1 offset:55296
    ds_read_b128 v[92:95], v98
    ds_read_b32 v96, v99 offset:256
    v_mfma_f32_16x16x32_bf16 v[40:43], a[196:199], v[64:67], v[40:43]
    buffer_load_dwordx4 a[188:191], v7, s[4:7], s9 offen offset:1024
    v_mfma_f32_16x16x32_bf16 v[56:59], v[60:63], v[160:163], v[56:59]
    ds_read_b128 v[132:135], v1 offset:56320
    ds_read_b128 v[120:123], v100 offset:0
    ds_read_b128 v[104:107], v100 offset:256
    v_mfma_f32_16x16x32_bf16 v[56:59], v[64:67], v[164:167], v[56:59]
    s_waitcnt lgkmcnt(6)
    ds_read_b128 v[124:127], v100 offset:64
    ds_read_b128 v[108:111], v100 offset:320
    v_mfma_f32_16x16x32_bf16 v[36:39], a[200:203], v[68:71], v[36:39]
    s_waitcnt vmcnt(5)
    s_barrier
    ds_read_b128 v[60:63], v1 offset:40960
    v_mfma_f32_16x16x32_bf16 v[36:39], a[204:207], v[72:75], v[36:39]
    buffer_load_dwordx4 a[192:195], v7, s[4:7], s10 offen
    v_mfma_f32_16x16x32_bf16 v[52:55], v[68:71], v[168:171], v[52:55]
    ds_read_b128 v[64:67], v1 offset:41984
    ds_read_b128 v[128:131], v100 offset:128
    ds_read_b128 v[112:115], v100 offset:384
    v_mfma_f32_16x16x32_bf16 v[52:55], v[72:75], v[172:175], v[52:55]
    s_waitcnt lgkmcnt(8)
    ds_read_b128 v[116:119], v100 offset:448
    v_xor_b32 v137, 16, v136
    v_mfma_f32_16x16x32_bf16 v[40:43], a[200:203], v[76:79], v[40:43]
    ds_read_b128 v[68:71], v1 offset:57344
    v_xor_b32 v138, 32, v136
    v_xor_b32 v139, 48, v136
    v_mfma_f32_16x16x32_bf16 v[40:43], a[204:207], v[132:135], v[40:43]
    buffer_load_dwordx4 a[196:199], v7, s[4:7], s10 offen offset:1024
    v_mfma_f32_16x16x32_bf16 v[56:59], v[76:79], v[168:171], v[56:59]
    ds_read_b128 v[72:75], v1 offset:58368
    v_xor_b32 v141, 32, v140
    v_mul_f32 v96, 0x3fb8aa3b, v96
    v_mfma_f32_16x16x32_bf16 v[56:59], v[132:135], v[172:175], v[56:59]
    s_waitcnt lgkmcnt(5)
    v_fmac_f32 v28, v80, v92
    v_fmac_f32 v29, v81, v92
    v_mfma_f32_16x16x32_bf16 v[36:39], a[208:211], v[60:63], v[36:39]
    ds_read_b128 v[76:79], v1 offset:43008
    v_fmac_f32 v30, v82, v92
    v_fmac_f32 v31, v83, v92
    v_mfma_f32_16x16x32_bf16 v[36:39], a[212:215], v[64:67], v[36:39]
    buffer_load_dwordx4 a[200:203], v7, s[4:7], s11 offen
    v_mfma_f32_16x16x32_bf16 v[52:55], v[60:63], v[176:179], v[52:55]
    ds_read_b128 v[132:135], v1 offset:44032
    v_cvt_pk_bf16_f32 v28, v28, v29
    v_cvt_pk_bf16_f32 v29, v30, v31
    v_mfma_f32_16x16x32_bf16 v[52:55], v[64:67], v[180:183], v[52:55]
    s_waitcnt lgkmcnt(2)
    v_fmac_f32 v32, v80, v93
    v_fmac_f32 v33, v81, v93
    v_mfma_f32_16x16x32_bf16 v[40:43], a[208:211], v[68:71], v[40:43]
    ds_read_b128 v[60:63], v1 offset:59392
    v_fmac_f32 v34, v82, v93
    v_fmac_f32 v35, v83, v93
    v_mfma_f32_16x16x32_bf16 v[40:43], a[212:215], v[72:75], v[40:43]
    buffer_load_dwordx4 a[204:207], v7, s[4:7], s11 offen offset:1024
    v_mfma_f32_16x16x32_bf16 v[56:59], v[68:71], v[176:179], v[56:59]
    ds_read_b128 v[64:67], v1 offset:60416
    v_cvt_pk_bf16_f32 v30, v32, v33
    v_cvt_pk_bf16_f32 v31, v34, v35
    v_mfma_f32_16x16x32_bf16 v[56:59], v[72:75], v[180:183], v[56:59]
    s_waitcnt lgkmcnt(2)
    v_fmac_f32 v8, v88, v92
    v_fmac_f32 v9, v89, v92
    v_mfma_f32_16x16x32_bf16 v[36:39], a[216:219], v[76:79], v[36:39]
    ds_read_b128 v[68:71], v1 offset:45056
    v_fmac_f32 v10, v90, v92
    v_fmac_f32 v11, v91, v92
    v_mfma_f32_16x16x32_bf16 v[36:39], a[220:223], v[132:135], v[36:39]
    buffer_load_dwordx4 a[208:211], v7, s[4:7], s33 offen
    v_mfma_f32_16x16x32_bf16 v[52:55], v[76:79], v[184:187], v[52:55]
    ds_read_b128 v[72:75], v1 offset:46080
    v_cvt_pk_bf16_f32 v32, v8, v9
    v_cvt_pk_bf16_f32 v33, v10, v11
    v_mfma_f32_16x16x32_bf16 v[52:55], v[132:135], v[188:191], v[52:55]
    s_waitcnt lgkmcnt(2)
    v_fmac_f32 v12, v88, v93
    v_fmac_f32 v13, v89, v93
    v_mfma_f32_16x16x32_bf16 v[40:43], a[216:219], v[60:63], v[40:43]
    ds_read_b128 v[76:79], v1 offset:61440
    v_fmac_f32 v14, v90, v93
    v_fmac_f32 v15, v91, v93
    v_mfma_f32_16x16x32_bf16 v[40:43], a[220:223], v[64:67], v[40:43]
    buffer_load_dwordx4 a[212:215], v7, s[4:7], s33 offen offset:1024
    v_mfma_f32_16x16x32_bf16 v[56:59], v[60:63], v[184:187], v[56:59]
    ds_read_b128 v[132:135], v1 offset:62464
    v_cvt_pk_bf16_f32 v34, v12, v13
    v_cvt_pk_bf16_f32 v35, v14, v15
    v_mfma_f32_16x16x32_bf16 v[56:59], v[64:67], v[188:191], v[56:59]
    s_waitcnt lgkmcnt(2)
    v_cndmask_b32 v144, 0, v16, s[64:65]
    v_cndmask_b32 v145, 0, v17, s[64:65]
    v_mfma_f32_16x16x32_bf16 v[36:39], a[224:227], v[68:71], v[36:39]
    ds_read_b128 v[60:63], v1 offset:47104
    v_cndmask_b32 v146, 0, v16, s[66:67]
    v_cndmask_b32 v147, 0, v17, s[66:67]
    v_mfma_f32_16x16x32_bf16 v[36:39], a[228:231], v[72:75], v[36:39]
    buffer_load_dwordx4 a[216:219], v7, s[4:7], s40 offen
    v_mfma_f32_16x16x32_bf16 v[52:55], v[68:71], a[240:243], v[52:55]
    ds_read_b128 v[64:67], v1 offset:48128
    v_cndmask_b32 v148, 0, v16, s[68:69]
    v_cndmask_b32 v149, 0, v17, s[68:69]
    v_mfma_f32_16x16x32_bf16 v[52:55], v[72:75], a[244:247], v[52:55]
    s_waitcnt lgkmcnt(2)
    v_cndmask_b32 v150, 0, v16, s[70:71]
    v_cndmask_b32 v151, 0, v17, s[70:71]
    v_mfma_f32_16x16x32_bf16 v[40:43], a[224:227], v[76:79], v[40:43]
    ds_read_b128 v[68:71], v1 offset:63488
    v_cndmask_b32 v152, 0, v18, s[64:65]
    v_cndmask_b32 v153, 0, v19, s[64:65]
    v_mfma_f32_16x16x32_bf16 v[40:43], a[228:231], v[132:135], v[40:43]
    buffer_load_dwordx4 a[220:223], v7, s[4:7], s40 offen offset:1024
    v_mfma_f32_16x16x32_bf16 v[56:59], v[76:79], a[240:243], v[56:59]
    ds_read_b128 v[72:75], v1 offset:64512
    v_cndmask_b32 v154, 0, v18, s[66:67]
    v_cndmask_b32 v155, 0, v19, s[66:67]
    v_mfma_f32_16x16x32_bf16 v[56:59], v[132:135], a[244:247], v[56:59]
    s_waitcnt lgkmcnt(2)
    v_cndmask_b32 v156, 0, v18, s[68:69]
    v_cndmask_b32 v157, 0, v19, s[68:69]
    v_mfma_f32_16x16x32_bf16 v[36:39], a[232:235], v[60:63], v[36:39]
    v_cndmask_b32 v158, 0, v18, s[70:71]
    v_cndmask_b32 v159, 0, v19, s[70:71]
    v_mfma_f32_16x16x32_bf16 v[36:39], a[236:239], v[64:67], v[36:39]
    ds_read_b128 v[132:135], v100 offset:192
    v_cndmask_b32 v160, 0, v20, s[64:65]
    v_cndmask_b32 v161, 0, v21, s[64:65]
    v_mfma_f32_16x16x32_bf16 v[52:55], v[60:63], a[248:251], v[52:55]
    buffer_load_dwordx4 a[224:227], v7, s[4:7], s84 offen
    v_mfma_f32_16x16x32_bf16 v[52:55], v[64:67], a[252:255], v[52:55]
    s_waitcnt lgkmcnt(1)
    v_cndmask_b32 v162, 0, v20, s[66:67]
    v_cndmask_b32 v163, 0, v21, s[66:67]
    v_mfma_f32_16x16x32_bf16 v[40:43], a[232:235], v[68:71], v[40:43]
    v_cndmask_b32 v164, 0, v20, s[68:69]
    v_cndmask_b32 v165, 0, v21, s[68:69]
    v_mfma_f32_16x16x32_bf16 v[40:43], a[236:239], v[72:75], v[40:43]
    buffer_load_dwordx4 a[228:231], v7, s[4:7], s84 offen offset:1024
    v_mfma_f32_16x16x32_bf16 v[56:59], v[68:71], a[248:251], v[56:59]
    v_cndmask_b32 v166, 0, v20, s[70:71]
    v_cndmask_b32 v167, 0, v21, s[70:71]
    v_mfma_f32_16x16x32_bf16 v[56:59], v[72:75], a[252:255], v[56:59]
    v_cndmask_b32 v168, 0, v22, s[64:65]
    v_cndmask_b32 v169, 0, v23, s[64:65]
    v_cndmask_b32 v170, 0, v22, s[66:67]
    v_cndmask_b32 v171, 0, v23, s[66:67]
    v_cndmask_b32 v172, 0, v22, s[68:69]
    v_cndmask_b32 v173, 0, v23, s[68:69]
    v_cndmask_b32 v174, 0, v22, s[70:71]
    v_cndmask_b32 v175, 0, v23, s[70:71]
    v_pk_fma_f32 v[36:37], v[80:81], v[94:95], v[36:37] op_sel:[0,0,0] op_sel_hi:[1,0,1]
    v_pk_fma_f32 v[38:39], v[82:83], v[94:95], v[38:39] op_sel:[0,0,0] op_sel_hi:[1,0,1]
    v_pk_fma_f32 v[40:41], v[80:81], v[94:95], v[40:41] op_sel:[0,1,0] op_sel_hi:[1,1,1]
    v_pk_fma_f32 v[42:43], v[82:83], v[94:95], v[42:43] op_sel:[0,1,0] op_sel_hi:[1,1,1]
    v_pk_fma_f32 v[44:45], v[120:121], v[84:85], v[44:45] op_sel_hi:[1,0,1]
    v_pk_fma_f32 v[46:47], v[122:123], v[84:85], v[46:47] op_sel_hi:[1,0,1]
    v_pk_fma_f32 v[48:49], v[124:125], v[84:85], v[48:49] op_sel_hi:[1,0,1]
    v_pk_fma_f32 v[50:51], v[126:127], v[84:85], v[50:51] op_sel_hi:[1,0,1]
    v_pk_fma_f32 v[52:53], v[128:129], v[84:85], v[52:53] op_sel_hi:[1,0,1]
    v_pk_fma_f32 v[54:55], v[130:131], v[84:85], v[54:55] op_sel_hi:[1,0,1]
    s_waitcnt lgkmcnt(0)
    v_pk_fma_f32 v[56:57], v[132:133], v[84:85], v[56:57] op_sel_hi:[1,0,1]
    v_pk_fma_f32 v[58:59], v[134:135], v[84:85], v[58:59] op_sel_hi:[1,0,1]
    v_cvt_pk_bf16_f32 v36, v36, v37
    v_cvt_pk_bf16_f32 v37, v38, v39
    v_cvt_pk_bf16_f32 v38, v40, v41
    v_cvt_pk_bf16_f32 v39, v42, v43
    v_pk_mul_f32 v[44:45], v[44:45], v[104:105]
    v_pk_mul_f32 v[46:47], v[46:47], v[106:107]
    v_pk_mul_f32 v[48:49], v[48:49], v[108:109]
    v_pk_mul_f32 v[50:51], v[50:51], v[110:111]
    v_pk_mul_f32 v[52:53], v[52:53], v[112:113]
    v_pk_mul_f32 v[54:55], v[54:55], v[114:115]
    v_pk_mul_f32 v[56:57], v[56:57], v[116:117]
    v_pk_mul_f32 v[58:59], v[58:59], v[118:119]
    v_mfma_f32_16x16x32_bf16 v[104:107], v[144:147], v[28:31], 0
    v_cvt_pk_bf16_f32 v44, v44, v45
    v_cvt_pk_bf16_f32 v45, v46, v47
    v_mfma_f32_16x16x32_bf16 v[108:111], v[152:155], v[28:31], 0
    v_cvt_pk_bf16_f32 v46, v48, v49
    v_cvt_pk_bf16_f32 v47, v50, v51
    v_mfma_f32_16x16x32_bf16 v[112:115], v[160:163], v[28:31], 0
    v_cvt_pk_bf16_f32 v52, v52, v53
    v_cvt_pk_bf16_f32 v53, v54, v55
    v_mfma_f32_16x16x32_bf16 v[116:119], v[168:171], v[28:31], 0
    v_cvt_pk_bf16_f32 v54, v56, v57
    v_cvt_pk_bf16_f32 v55, v58, v59
    v_mfma_f32_16x16x32_bf16 v[104:107], v[148:151], v[36:39], v[104:107]
    v_lshlrev_b32 v143, 11, s29
    v_add3_u32 v143, v143, v1, s63
    v_mfma_f32_16x16x32_bf16 v[108:111], v[156:159], v[36:39], v[108:111]
    ds_read_b128 v[8:11], v143 offset:0
    ds_read_b128 v[12:15], v143 offset:1024
    v_mfma_f32_16x16x32_bf16 v[112:115], v[164:167], v[36:39], v[112:115]
    v_mfma_f32_16x16x32_bf16 v[116:119], v[172:175], v[36:39], v[116:119]
    s_nop 0
    v_max3_f32 v98, v104, v105, v106
    v_min3_f32 v99, v104, v105, v106
    s_nop 0
    v_max3_f32 v98, v98, v107, v108
    v_min3_f32 v99, v99, v107, v108
    v_max3_f32 v98, v98, v109, v110
    v_min3_f32 v99, v99, v109, v110
    v_max3_f32 v98, v98, v111, v112
    v_min3_f32 v99, v99, v111, v112
    v_max3_f32 v98, v98, v113, v114
    v_min3_f32 v99, v99, v113, v114
    v_max3_f32 v98, v98, v115, v116
    v_min3_f32 v99, v99, v115, v116
    v_max3_f32 v98, v98, v117, v118
    v_min3_f32 v99, v99, v117, v118
    v_max_f32 v98, v98, v119
    s_waitcnt lgkmcnt(0)
    s_barrier
    buffer_load_dwordx4 a[232:235], v7, s[4:7], s38 offen
    v_min_f32_e64 v99, v99, v119
    v_pk_mul_f32 v[98:99], v[98:99], v[96:97] op_sel_hi:[1,0]
    v_pk_fma_f32 v[120:121], v[104:105], v[96:97], v[98:99] op_sel_hi:[1,0,0] neg_lo:[0,0,1] neg_hi:[0,0,1]
    v_pk_fma_f32 v[122:123], v[106:107], v[96:97], v[98:99] op_sel_hi:[1,0,0] neg_lo:[0,0,1] neg_hi:[0,0,1]
    v_pk_fma_f32 v[124:125], v[108:109], v[96:97], v[98:99] op_sel_hi:[1,0,0] neg_lo:[0,0,1] neg_hi:[0,0,1]
    v_pk_fma_f32 v[126:127], v[110:111], v[96:97], v[98:99] op_sel_hi:[1,0,0] neg_lo:[0,0,1] neg_hi:[0,0,1]
    v_pk_fma_f32 v[128:129], v[112:113], v[96:97], v[98:99] op_sel_hi:[1,0,0] neg_lo:[0,0,1] neg_hi:[0,0,1]
    v_pk_fma_f32 v[130:131], v[114:115], v[96:97], v[98:99] op_sel_hi:[1,0,0] neg_lo:[0,0,1] neg_hi:[0,0,1]
    v_pk_fma_f32 v[132:133], v[116:117], v[96:97], v[98:99] op_sel_hi:[1,0,0] neg_lo:[0,0,1] neg_hi:[0,0,1]
    v_pk_fma_f32 v[134:135], v[118:119], v[96:97], v[98:99] op_sel_hi:[1,0,0] neg_lo:[0,0,1] neg_hi:[0,0,1]
    v_pk_fma_f32 v[104:105], v[104:105], v[96:97], v[98:99] op_sel:[0,0,1] op_sel_hi:[1,0,1] neg_lo:[1,0,0] neg_hi:[1,0,0]
    buffer_load_dwordx4 a[236:239], v7, s[4:7], s38 offen offset:1024
    v_pk_fma_f32 v[106:107], v[106:107], v[96:97], v[98:99] op_sel:[0,0,1] op_sel_hi:[1,0,1] neg_lo:[1,0,0] neg_hi:[1,0,0]
    v_pk_fma_f32 v[108:109], v[108:109], v[96:97], v[98:99] op_sel:[0,0,1] op_sel_hi:[1,0,1] neg_lo:[1,0,0] neg_hi:[1,0,0]
    v_pk_fma_f32 v[110:111], v[110:111], v[96:97], v[98:99] op_sel:[0,0,1] op_sel_hi:[1,0,1] neg_lo:[1,0,0] neg_hi:[1,0,0]
    v_pk_fma_f32 v[112:113], v[112:113], v[96:97], v[98:99] op_sel:[0,0,1] op_sel_hi:[1,0,1] neg_lo:[1,0,0] neg_hi:[1,0,0]
    v_pk_fma_f32 v[114:115], v[114:115], v[96:97], v[98:99] op_sel:[0,0,1] op_sel_hi:[1,0,1] neg_lo:[1,0,0] neg_hi:[1,0,0]
    v_pk_fma_f32 v[116:117], v[116:117], v[96:97], v[98:99] op_sel:[0,0,1] op_sel_hi:[1,0,1] neg_lo:[1,0,0] neg_hi:[1,0,0]
    v_pk_fma_f32 v[118:119], v[118:119], v[96:97], v[98:99] op_sel:[0,0,1] op_sel_hi:[1,0,1] neg_lo:[1,0,0] neg_hi:[1,0,0]
    v_exp_f32 v120, v120
    v_exp_f32 v121, v121
    s_add_u32 m0, s87, 0
    v_add_u32 v7, s98, v1
    buffer_load_dwordx4 v7, s[4:7], 0 offen lds
    v_exp_f32 v122, v122
    v_exp_f32 v123, v123
    v_exp_f32 v124, v124
    v_exp_f32 v125, v125
    v_exp_f32 v126, v126
    buffer_load_dwordx4 v7, s[4:7], 0 offen offset:1024 lds
    v_exp_f32 v127, v127
    v_exp_f32 v128, v128
    v_exp_f32 v129, v129
    v_exp_f32 v130, v130
    v_exp_f32 v131, v131
    buffer_load_dwordx4 v7, s[4:7], 0 offen offset:2048 lds
    v_exp_f32 v132, v132
    v_exp_f32 v133, v133
    v_exp_f32 v134, v134
    v_exp_f32 v135, v135
    v_exp_f32 v104, v104
    buffer_load_dwordx4 v7, s[4:7], 0 offen offset:3072 lds
    v_exp_f32 v105, v105
    v_exp_f32 v106, v106
    v_exp_f32 v107, v107
    v_exp_f32 v108, v108
    v_exp_f32 v109, v109
    v_exp_f32 v110, v110
    s_add_u32 m0, s87, 4096
    s_nop 0
    buffer_load_dwordx4 v7, s[4:7], s48 offen lds
    v_exp_f32 v111, v111
    v_exp_f32 v112, v112
    v_exp_f32 v113, v113
    v_exp_f32 v114, v114
    v_exp_f32 v115, v115
    buffer_load_dwordx4 v7, s[4:7], s48 offen offset:1024 lds
    v_exp_f32 v116, v116
    v_exp_f32 v117, v117
    v_exp_f32 v118, v118
    v_exp_f32_e64 v119, v119
    v_pk_add_f32 v[100:101], v[120:121], v[122:123]
    buffer_load_dwordx4 v7, s[4:7], s48 offen offset:2048 lds
    v_pk_add_f32 v[102:103], v[104:105], v[106:107]
    v_pk_add_f32 v[100:101], v[100:101], v[124:125]
    v_pk_add_f32 v[102:103], v[102:103], v[108:109]
    v_pk_add_f32 v[100:101], v[100:101], v[126:127]
    v_pk_add_f32 v[102:103], v[102:103], v[110:111]
    v_pk_add_f32 v[100:101], v[100:101], v[128:129]
    v_pk_add_f32 v[102:103], v[102:103], v[112:113]
    v_pk_add_f32 v[100:101], v[100:101], v[130:131]
    v_pk_add_f32 v[102:103], v[102:103], v[114:115]
    v_pk_add_f32 v[100:101], v[100:101], v[132:133]
    v_pk_add_f32 v[102:103], v[102:103], v[116:117]
    buffer_load_dwordx4 v7, s[4:7], s48 offen offset:3072 lds
    v_pk_add_f32 v[100:101], v[100:101], v[134:135]
    v_pk_add_f32 v[102:103], v[102:103], v[118:119]
    v_add_f32 v100, v100, v101
    v_add_f32 v102, v102, v103
    v_rcp_f32 v100, v100
    v_rcp_f32 v102, v102
    v_pk_mul_f32 v[120:121], v[120:121], v[100:101] op_sel_hi:[1,0]
    v_pk_mul_f32 v[122:123], v[122:123], v[100:101] op_sel_hi:[1,0]
    v_add_u32_e64 v7, s94, v1
    buffer_load_dwordx4 a[252:255], v7, s[4:7], s38 offen offset:1024
    v_pk_mul_f32 v[124:125], v[124:125], v[100:101] op_sel_hi:[1,0]
    v_pk_mul_f32 v[126:127], v[126:127], v[100:101] op_sel_hi:[1,0]
    v_pk_mul_f32 v[128:129], v[128:129], v[100:101] op_sel_hi:[1,0]
    v_pk_mul_f32 v[130:131], v[130:131], v[100:101] op_sel_hi:[1,0]
    v_pk_mul_f32 v[132:133], v[132:133], v[100:101] op_sel_hi:[1,0]
    v_pk_mul_f32 v[134:135], v[134:135], v[100:101] op_sel_hi:[1,0]
    v_cvt_pk_bf16_f32 v60, v120, v121
    v_cvt_pk_bf16_f32 v61, v122, v123
    v_cvt_pk_bf16_f32 v62, v124, v125
    v_cvt_pk_bf16_f32 v63, v126, v127
    v_cvt_pk_bf16_f32 v64, v128, v129
    buffer_load_dwordx4 a[248:251], v7, s[4:7], s38 offen
    v_cvt_pk_bf16_f32 v65, v130, v131
    v_cvt_pk_bf16_f32 v66, v132, v133
    v_cvt_pk_bf16_f32 v67, v134, v135
    ds_write_b128 v136, v[60:63]
    ds_write_b128 v137, v[64:67]
    buffer_load_dwordx4 a[244:247], v7, s[4:7], s84 offen offset:1024
    ds_read_b64_tr_b16 v[120:121], v140 offset:0
    ds_read_b64_tr_b16 v[122:123], v140 offset:1024
    ds_read_b64_tr_b16 v[124:125], v140 offset:2048
    ds_read_b64_tr_b16 v[126:127], v140 offset:3072
    v_pk_mul_f32 v[104:105], v[104:105], v[102:103] op_sel_hi:[1,0]
    buffer_load_dwordx4 a[240:243], v7, s[4:7], s84 offen
    v_pk_mul_f32 v[106:107], v[106:107], v[102:103] op_sel_hi:[1,0]
    v_pk_mul_f32 v[108:109], v[108:109], v[102:103] op_sel_hi:[1,0]
    v_pk_mul_f32 v[110:111], v[110:111], v[102:103] op_sel_hi:[1,0]
    v_pk_mul_f32 v[112:113], v[112:113], v[102:103] op_sel_hi:[1,0]
    v_pk_mul_f32 v[114:115], v[114:115], v[102:103] op_sel_hi:[1,0]
    v_pk_mul_f32 v[116:117], v[116:117], v[102:103] op_sel_hi:[1,0]
    v_pk_mul_f32 v[118:119], v[118:119], v[102:103] op_sel_hi:[1,0]
    v_cvt_pk_bf16_f32 v68, v104, v105
    v_cvt_pk_bf16_f32 v69, v106, v107
    v_cvt_pk_bf16_f32 v70, v108, v109
    v_cvt_pk_bf16_f32 v71, v110, v111
    buffer_load_dwordx4 v[188:191], v7, s[4:7], s40 offen offset:1024
    v_cvt_pk_bf16_f32 v72, v112, v113
    v_cvt_pk_bf16_f32 v73, v114, v115
    v_cvt_pk_bf16_f32 v74, v116, v117
    v_cvt_pk_bf16_f32 v75, v118, v119
    ds_write_b128 v138, v[68:71]
    buffer_load_dwordx4 v[184:187], v7, s[4:7], s40 offen
    ds_write_b128 v139, v[72:75]
    ds_read_b64_tr_b16 v[128:129], v141 offset:0
    ds_read_b64_tr_b16 v[130:131], v141 offset:1024
    ds_read_b64_tr_b16 v[132:133], v141 offset:2048
    ds_read_b64_tr_b16 v[134:135], v141 offset:3072
    s_waitcnt lgkmcnt(8)
    v_mfma_f32_16x16x32_bf16 v[104:107], v[120:123], v[44:47], 0
    v_lshrrev_b32 v98, 2, v1
    v_lshrrev_b32 v85, 5, v1
    s_waitcnt lgkmcnt(6)
    v_mfma_f32_16x16x32_bf16 v[104:107], v[124:127], v[52:55], v[104:107]
    v_and_b32 v87, 16, v1
    v_lshl_add_u32 v85, v85, 10, v87
    v_mfma_f32_16x16x32_bf16 v[112:115], v[120:123], v[24:27], 0
    v_lshrrev_b32 v5, 8, v1
    v_lshl_add_u32 v87, v5, 3, v87
    v_mfma_f32_16x16x32_bf16 v[112:115], v[124:127], v[24:27], v[112:115]
    v_bfe_u32 v6, v1, 5, 3
    v_lshl_add_u32 v87, v6, 15, v87
    s_waitcnt lgkmcnt(2)
    v_mfma_f32_16x16x32_bf16 v[108:111], v[128:131], v[44:47], 0
    v_bfe_u32 v5, v1, 4, 1
    v_lshlrev_b32 v5, 4, v5
    s_waitcnt lgkmcnt(0)
    v_mfma_f32_16x16x32_bf16 v[108:111], v[132:135], v[52:55], v[108:111]
    v_mov_b32 v86, 0x3f80
    v_lshlrev_b32 v5, v5, v86
    v_mfma_f32_16x16x32_bf16 v[116:119], v[128:131], v[24:27], 0
    v_mfma_f32_16x16x32_bf16 v[116:119], v[132:135], v[24:27], v[116:119]
    v_cvt_pk_bf16_f32 v60, v104, v105
    v_cvt_pk_bf16_f32 v61, v106, v107
    s_nop 1
    v_cvt_pk_bf16_f32 v62, v108, v109
    v_cvt_pk_bf16_f32 v63, v110, v111
    v_min_u32 v60, -2, v60
    v_min_u32 v61, -2, v61
    v_min_u32 v62, -2, v62
    v_min_u32 v63, -2, v63
    buffer_store_dwordx4 v[60:63], v1, s[4:7], s16 offen sc1
    v_cvt_pk_bf16_f32 v112, v112, v113
    v_cvt_pk_bf16_f32 v113, v114, v115
    v_cvt_pk_bf16_f32 v114, v116, v117
    v_cvt_pk_bf16_f32 v115, v118, v119
    v_min_u32 v112, -2, v112
    v_min_u32 v113, -2, v113
    v_min_u32 v114, -2, v114
    v_min_u32 v115, -2, v115
    s_mov_b32 exec_lo, 0x00010001
    s_mov_b32 exec_hi, 0x00010001
    buffer_store_dwordx4 v[112:115], v98, s[4:7], s18 offen sc1
    s_mov_b64 exec, -1
    ds_read_b64_tr_b16 v[104:105], v0 offset:0
    ds_read_b64_tr_b16 v[106:107], v0 offset:512
    ds_read_b64_tr_b16 v[108:109], v0 offset:4096
    ds_read_b64_tr_b16 v[110:111], v0 offset:4608
    ds_read_b128 v[44:47], v1 offset:32768
    ds_read_b128 v[48:51], v1 offset:33792
    ds_read_b128 v[52:55], v1 offset:49152
    ds_read_b128 v[56:59], v1 offset:50176
    ds_read_b64_tr_b16 v[112:113], v0 offset:8192
    ds_read_b64_tr_b16 v[114:115], v0 offset:8704
    ds_read_b64_tr_b16 v[116:117], v0 offset:12288
    ds_read_b64_tr_b16 v[118:119], v0 offset:12800
    ds_read_b128 v[60:63], v1 offset:34816
    ds_read_b128 v[64:67], v1 offset:35840
    s_waitcnt lgkmcnt(9)
    v_mfma_f32_16x16x32_bf16 v[36:39], v[104:107], v[44:47], 0
    ds_read_b64_tr_b16 v[120:121], v0 offset:16384
    ds_read_b128 v[68:71], v1 offset:51200
    buffer_load_dwordx4 v[180:183], v7, s[4:7], s33 offen offset:1024
    s_waitcnt lgkmcnt(10)
    v_mfma_f32_16x16x32_bf16 v[36:39], v[108:111], v[48:51], v[36:39]
    ds_read_b64_tr_b16 v[122:123], v0 offset:16896
    ds_read_b128 v[72:75], v1 offset:52224
    s_waitcnt lgkmcnt(10)
    v_cmp_eq_u32 s[24:25], 0, v6
    v_cmp_eq_u32 s[26:27], 1, v6
    v_mfma_f32_16x16x32_bf16 v[40:43], v[104:107], v[52:55], 0
    ds_read_b64_tr_b16 v[124:125], v0 offset:20480
    ds_read_b128 v[44:47], v1 offset:36864
    v_cndmask_b32 v136, 0, v5, s[24:25]
    v_cndmask_b32 v137, 0, v5, s[26:27]
    v_cmp_eq_u32 s[24:25], 2, v6
    v_mfma_f32_16x16x32_bf16 v[40:43], v[108:111], v[56:59], v[40:43]
    ds_read_b64_tr_b16 v[126:127], v0 offset:20992
    ds_read_b128 v[48:51], v1 offset:37888
    s_waitcnt lgkmcnt(8)
    v_cmp_eq_u32 s[26:27], 3, v6
    v_cndmask_b32 v138, 0, v5, s[24:25]
    v_mfma_f32_16x16x32_bf16 v[36:39], v[112:115], v[60:63], v[36:39]
    ds_read_b64_tr_b16 v[104:105], v0 offset:24576
    ds_read_b128 v[52:55], v1 offset:53248
    v_cndmask_b32 v139, 0, v5, s[26:27]
    v_lshrrev_b32_e64 v86, 8, v1
    v_lshl_add_u32 v86, v86, 14, s90
    v_mfma_f32_16x16x32_bf16 v[36:39], v[116:119], v[64:67], v[36:39]
    ds_read_b64_tr_b16 v[106:107], v0 offset:25088
    ds_read_b128 v[56:59], v1 offset:54272
    s_waitcnt lgkmcnt(8)
    v_min_u32 v86, M_done-interleave_layers__linear_kernel_hedgehog__mixer_channel_mlp__prompt_kernel-128, v86
    v_mfma_f32_16x16x32_bf16 v[40:43], v[112:115], v[68:71], v[40:43]
    ds_read_b64_tr_b16 v[108:109], v0 offset:28672
    ds_read_b128 v[60:63], v1 offset:38912
    global_load_dword v86, v86, s[88:89]
    v_mfma_f32_16x16x32_bf16 v[40:43], v[116:119], v[72:75], v[40:43]
    ds_read_b64_tr_b16 v[110:111], v0 offset:29184
    ds_read_b128 v[64:67], v1 offset:39936
    s_waitcnt lgkmcnt(8)
    v_mfma_f32_16x16x32_bf16 v[36:39], v[120:123], v[44:47], v[36:39]
    ds_read_b64_tr_b16 v[112:113], v0 offset:32768
    ds_read_b128 v[68:71], v1 offset:55296
    v_mfma_f32_16x16x32_bf16 v[36:39], v[124:127], v[48:51], v[36:39]
    ds_read_b64_tr_b16 v[114:115], v0 offset:33280
    ds_read_b128 v[72:75], v1 offset:56320
    s_waitcnt lgkmcnt(8)
    v_mfma_f32_16x16x32_bf16 v[40:43], v[120:123], v[52:55], v[40:43]
    ds_read_b64_tr_b16 v[116:117], v0 offset:36864
    ds_read_b128 v[44:47], v1 offset:40960
    v_mfma_f32_16x16x32_bf16 v[40:43], v[124:127], v[56:59], v[40:43]
    ds_read_b64_tr_b16 v[118:119], v0 offset:37376
    ds_read_b128 v[48:51], v1 offset:41984
    s_waitcnt lgkmcnt(8)
    v_mfma_f32_16x16x32_bf16 v[36:39], v[104:107], v[60:63], v[36:39]
    ds_read_b64_tr_b16 v[120:121], v0 offset:40960
    ds_read_b128 v[52:55], v1 offset:57344
    v_mfma_f32_16x16x32_bf16 v[36:39], v[108:111], v[64:67], v[36:39]
    ds_read_b64_tr_b16 v[122:123], v0 offset:41472
    ds_read_b128 v[56:59], v1 offset:58368
    s_waitcnt lgkmcnt(8)
    v_mfma_f32_16x16x32_bf16 v[40:43], v[104:107], v[68:71], v[40:43]
    ds_read_b64_tr_b16 v[124:125], v0 offset:45056
    ds_read_b128 v[60:63], v1 offset:43008
    v_mfma_f32_16x16x32_bf16 v[40:43], v[108:111], v[72:75], v[40:43]
    ds_read_b64_tr_b16 v[126:127], v0 offset:45568
    ds_read_b128 v[64:67], v1 offset:44032
    s_waitcnt lgkmcnt(8)
    v_mfma_f32_16x16x32_bf16 v[36:39], v[112:115], v[44:47], v[36:39]
    ds_read_b64_tr_b16 v[104:105], v0 offset:49152
    ds_read_b128 v[68:71], v1 offset:59392
    buffer_load_dwordx4 v[176:179], v7, s[4:7], s33 offen
    v_mfma_f32_16x16x32_bf16 v[36:39], v[116:119], v[48:51], v[36:39]
    ds_read_b64_tr_b16 v[106:107], v0 offset:49664
    ds_read_b128 v[72:75], v1 offset:60416
    s_waitcnt lgkmcnt(8)
    v_mfma_f32_16x16x32_bf16 v[40:43], v[112:115], v[52:55], v[40:43]
    ds_read_b64_tr_b16 v[108:109], v0 offset:53248
    ds_read_b128 v[44:47], v1 offset:45056
    v_mfma_f32_16x16x32_bf16 v[40:43], v[116:119], v[56:59], v[40:43]
    ds_read_b64_tr_b16 v[110:111], v0 offset:53760
    ds_read_b128 v[48:51], v1 offset:46080
    s_waitcnt lgkmcnt(8)
    v_mfma_f32_16x16x32_bf16 v[36:39], v[120:123], v[60:63], v[36:39]
    ds_read_b64_tr_b16 v[112:113], v0 offset:57344
    ds_read_b128 v[52:55], v1 offset:61440
    v_mfma_f32_16x16x32_bf16 v[36:39], v[124:127], v[64:67], v[36:39]
    ds_read_b64_tr_b16 v[114:115], v0 offset:57856
    ds_read_b128 v[56:59], v1 offset:62464
    s_waitcnt lgkmcnt(8)
    v_mfma_f32_16x16x32_bf16 v[40:43], v[120:123], v[68:71], v[40:43]
    ds_read_b64_tr_b16 v[116:117], v0 offset:61440
    ds_read_b128 v[60:63], v1 offset:47104
    v_mfma_f32_16x16x32_bf16 v[40:43], v[124:127], v[72:75], v[40:43]
    ds_read_b64_tr_b16 v[118:119], v0 offset:61952
    ds_read_b128 v[64:67], v1 offset:48128
    s_waitcnt lgkmcnt(8)
    v_mfma_f32_16x16x32_bf16 v[36:39], v[104:107], v[44:47], v[36:39]
    ds_read_b128 v[68:71], v1 offset:63488
    v_mfma_f32_16x16x32_bf16 v[36:39], v[108:111], v[48:51], v[36:39]
    ds_read_b128 v[72:75], v1 offset:64512
    s_waitcnt lgkmcnt(6)
    v_mfma_f32_16x16x32_bf16 v[40:43], v[104:107], v[52:55], v[40:43]
    v_mfma_f32_16x16x32_bf16 v[40:43], v[108:111], v[56:59], v[40:43]
    s_waitcnt lgkmcnt(2)
    v_mfma_f32_16x16x32_bf16 v[36:39], v[112:115], v[60:63], v[36:39]
    v_mfma_f32_16x16x32_bf16 v[36:39], v[116:119], v[64:67], v[36:39]
    s_waitcnt lgkmcnt(0)
    v_mfma_f32_16x16x32_bf16 v[40:43], v[112:115], v[68:71], v[40:43]
    v_mfma_f32_16x16x32_bf16 v[40:43], v[116:119], v[72:75], v[40:43]
    buffer_load_dwordx4 v[140:143], v85, s[4:7], s19 offen sc1
    s_barrier
    s_nop 2
    v_pk_fma_f32 v[36:37], v[88:89], v[94:95], v[36:37] op_sel:[0,0,0] op_sel_hi:[1,0,1]
    v_pk_fma_f32 v[38:39], v[90:91], v[94:95], v[38:39] op_sel:[0,0,0] op_sel_hi:[1,0,1]
    s_nop 0
    v_pk_fma_f32 v[40:41], v[88:89], v[94:95], v[40:41] op_sel:[0,1,0] op_sel_hi:[1,1,1]
    v_pk_fma_f32 v[42:43], v[90:91], v[94:95], v[42:43] op_sel:[0,1,0] op_sel_hi:[1,1,1]
    v_cvt_pk_bf16_f32 v36, v36, v37
    v_cvt_pk_bf16_f32 v37, v38, v39
    v_cvt_pk_bf16_f32 v38, v40, v41
    v_cvt_pk_bf16_f32 v39, v42, v43
    v_mfma_f32_16x16x32_bf16 v[104:107], v[144:147], v[32:35], 0
    s_add_u32 m0, s87, 32768
    v_add_u32 v7, s98, v1
    v_mfma_f32_16x16x32_bf16 v[108:111], v[152:155], v[32:35], 0
    buffer_load_dwordx4 v7, s[4:7], s55 offen lds
    v_mfma_f32_16x16x32_bf16 v[112:115], v[160:163], v[32:35], 0
    v_mfma_f32_16x16x32_bf16 v[116:119], v[168:171], v[32:35], 0
    v_mfma_f32_16x16x32_bf16 v[104:107], v[148:151], v[36:39], v[104:107]
    buffer_load_dwordx4 v7, s[4:7], s55 offen offset:1024 lds
    v_mfma_f32_16x16x32_bf16 v[108:111], v[156:159], v[36:39], v[108:111]
    v_mfma_f32_16x16x32_bf16 v[112:115], v[164:167], v[36:39], v[112:115]
    v_mfma_f32_16x16x32_bf16 v[116:119], v[172:175], v[36:39], v[116:119]
    s_mov_b32 s91, 0
    s_waitcnt vmcnt(2)
L21c:
    v_mfma_f32_16x16x32_bf16 v[60:63], v[136:139], v[140:143], 0
    v_max3_u32 v5, v140, v141, v142
    v_max_u32_e64 v5, v5, v143
    v_cmp_eq_u32 vcc, -1, v5
    s_nop 3
    s_cbranch_vccnz L21s
L21:
    buffer_load_dwordx4 v[28:31], v1, s[4:7], s17 offen sc1
    buffer_load_dwordx4 v[32:35], v1, s[4:7], s17 offen offset:1024 sc1
    v_add_f32_dpp v60, v60, v60 row_ror:8 row_mask:0xf bank_mask:0xf
    v_add_f32_dpp v61, v61, v61 row_ror:8 row_mask:0xf bank_mask:0xf
    v_add_f32_dpp v62, v62, v62 row_ror:8 row_mask:0xf bank_mask:0xf
    v_add_f32_dpp v63, v63, v63 row_ror:8 row_mask:0xf bank_mask:0xf
    v_add_f32_dpp v60, v60, v60 row_ror:4 row_mask:0xf bank_mask:0xf
    v_add_f32_dpp v61, v61, v61 row_ror:4 row_mask:0xf bank_mask:0xf
    v_add_f32_dpp v62, v62, v62 row_ror:4 row_mask:0xf bank_mask:0xf
    v_add_f32_dpp v63, v63, v63 row_ror:4 row_mask:0xf bank_mask:0xf
    v_add_f32_dpp v60, v60, v60 row_ror:2 row_mask:0xf bank_mask:0xf
    v_add_f32_dpp v61, v61, v61 row_ror:2 row_mask:0xf bank_mask:0xf
    v_add_f32_dpp v62, v62, v62 row_ror:2 row_mask:0xf bank_mask:0xf
    v_add_f32_dpp v63, v63, v63 row_ror:2 row_mask:0xf bank_mask:0xf
    v_cvt_pk_bf16_f32 v60, v60, v61
    v_cvt_pk_bf16_f32 v61, v62, v63
    v_min_u32 v60, -2, v60
    v_min_u32 v61, -2, v61
    v_mov_b32 v62, v60
    v_mov_b32 v63, v61
    s_nop 0
    v_permlane16_swap_b32 v60, v62
    v_permlane16_swap_b32 v61, v63
    s_mov_b64 exec, 65535
    buffer_store_dwordx4 v[60:63], v87, s[4:7], s20 offen sc1
    s_mov_b64 exec, -1
    buffer_load_dwordx4 v7, s[4:7], s55 offen offset:2048 lds
    v_max3_f32 v98, v104, v105, v106
    v_min3_f32 v99, v104, v105, v106
    v_max3_f32 v98, v98, v107, v108
    v_min3_f32 v99, v99, v107, v108
    v_max3_f32 v98, v98, v109, v110
    v_min3_f32 v99, v99, v109, v110
    v_max3_f32 v98, v98, v111, v112
    v_min3_f32 v99, v99, v111, v112
    v_max3_f32 v98, v98, v113, v114
    v_min3_f32 v99, v99, v113, v114
    v_max3_f32 v98, v98, v115, v116
    v_min3_f32 v99, v99, v115, v116
    v_max3_f32 v98, v98, v117, v118
    buffer_load_dwordx4 v7, s[4:7], s55 offen offset:3072 lds
    v_min3_f32 v99, v99, v117, v118
    v_max_f32 v98, v98, v119
    v_min_f32 v99, v99, v119
    v_pk_mul_f32 v[98:99], v[98:99], v[96:97] op_sel_hi:[1,0]
    v_pk_fma_f32 v[120:121], v[104:105], v[96:97], v[98:99] op_sel_hi:[1,0,0] neg_lo:[0,0,1] neg_hi:[0,0,1]
    v_pk_fma_f32 v[122:123], v[106:107], v[96:97], v[98:99] op_sel_hi:[1,0,0] neg_lo:[0,0,1] neg_hi:[0,0,1]
    v_pk_fma_f32 v[124:125], v[108:109], v[96:97], v[98:99] op_sel_hi:[1,0,0] neg_lo:[0,0,1] neg_hi:[0,0,1]
    v_pk_fma_f32 v[126:127], v[110:111], v[96:97], v[98:99] op_sel_hi:[1,0,0] neg_lo:[0,0,1] neg_hi:[0,0,1]
    v_pk_fma_f32 v[128:129], v[112:113], v[96:97], v[98:99] op_sel_hi:[1,0,0] neg_lo:[0,0,1] neg_hi:[0,0,1]
    v_pk_fma_f32 v[130:131], v[114:115], v[96:97], v[98:99] op_sel_hi:[1,0,0] neg_lo:[0,0,1] neg_hi:[0,0,1]
    v_pk_fma_f32 v[132:133], v[116:117], v[96:97], v[98:99] op_sel_hi:[1,0,0] neg_lo:[0,0,1] neg_hi:[0,0,1]
    v_pk_fma_f32 v[134:135], v[118:119], v[96:97], v[98:99] op_sel_hi:[1,0,0] neg_lo:[0,0,1] neg_hi:[0,0,1]
    s_add_u32 m0, s87, 36864
    s_nop 0
    buffer_load_dwordx4 v7, s[4:7], s56 offen lds
    v_pk_fma_f32 v[104:105], v[104:105], v[96:97], v[98:99] op_sel:[0,0,1] op_sel_hi:[1,0,1] neg_lo:[1,0,0] neg_hi:[1,0,0]
    v_pk_fma_f32 v[106:107], v[106:107], v[96:97], v[98:99] op_sel:[0,0,1] op_sel_hi:[1,0,1] neg_lo:[1,0,0] neg_hi:[1,0,0]
    v_pk_fma_f32 v[108:109], v[108:109], v[96:97], v[98:99] op_sel:[0,0,1] op_sel_hi:[1,0,1] neg_lo:[1,0,0] neg_hi:[1,0,0]
    v_pk_fma_f32 v[110:111], v[110:111], v[96:97], v[98:99] op_sel:[0,0,1] op_sel_hi:[1,0,1] neg_lo:[1,0,0] neg_hi:[1,0,0]
    v_pk_fma_f32 v[112:113], v[112:113], v[96:97], v[98:99] op_sel:[0,0,1] op_sel_hi:[1,0,1] neg_lo:[1,0,0] neg_hi:[1,0,0]
    v_pk_fma_f32 v[114:115], v[114:115], v[96:97], v[98:99] op_sel:[0,0,1] op_sel_hi:[1,0,1] neg_lo:[1,0,0] neg_hi:[1,0,0]
    v_pk_fma_f32 v[116:117], v[116:117], v[96:97], v[98:99] op_sel:[0,0,1] op_sel_hi:[1,0,1] neg_lo:[1,0,0] neg_hi:[1,0,0]
    v_pk_fma_f32 v[118:119], v[118:119], v[96:97], v[98:99] op_sel:[0,0,1] op_sel_hi:[1,0,1] neg_lo:[1,0,0] neg_hi:[1,0,0]
    v_exp_f32 v120, v120
    v_exp_f32 v121, v121
    v_exp_f32 v122, v122
    buffer_load_dwordx4 v7, s[4:7], s56 offen offset:1024 lds
    v_exp_f32 v123, v123
    v_exp_f32 v124, v124
    v_exp_f32 v125, v125
    v_exp_f32 v126, v126
    v_exp_f32 v127, v127
    v_exp_f32 v128, v128
    buffer_load_dwordx4 v7, s[4:7], s56 offen offset:2048 lds
    v_exp_f32 v129, v129
    v_exp_f32 v130, v130
    v_exp_f32 v131, v131
    v_exp_f32 v132, v132
    v_exp_f32 v133, v133
    v_exp_f32 v134, v134
    buffer_load_dwordx4 v7, s[4:7], s56 offen offset:3072 lds
    v_exp_f32 v135, v135
    v_exp_f32 v104, v104
    v_exp_f32 v105, v105
    v_exp_f32 v106, v106
    v_exp_f32 v107, v107
    v_exp_f32 v108, v108
    v_add_u32 v7, s94, v1
    buffer_load_dwordx4 v[144:147], v7, s[4:7], s8 offen
    v_exp_f32 v109, v109
    v_exp_f32 v110, v110
    v_exp_f32 v111, v111
    v_exp_f32 v112, v112
    v_exp_f32 v113, v113
    v_exp_f32 v114, v114
    buffer_load_dwordx4 v[148:151], v7, s[4:7], s8 offen offset:1024
    v_exp_f32 v115, v115
    v_exp_f32 v116, v116
    v_exp_f32 v117, v117
    v_exp_f32 v118, v118
    v_exp_f32 v119, v119
    v_pk_add_f32 v[100:101], v[120:121], v[122:123]
    v_pk_add_f32 v[102:103], v[104:105], v[106:107]
    v_pk_add_f32 v[100:101], v[100:101], v[124:125]
    buffer_load_dwordx4 v[152:155], v7, s[4:7], s9 offen
    v_pk_add_f32 v[102:103], v[102:103], v[108:109]
    v_pk_add_f32 v[100:101], v[100:101], v[126:127]
    v_pk_add_f32 v[102:103], v[102:103], v[110:111]
    v_pk_add_f32 v[100:101], v[100:101], v[128:129]
    v_pk_add_f32 v[102:103], v[102:103], v[112:113]
    v_pk_add_f32 v[100:101], v[100:101], v[130:131]
    v_pk_add_f32 v[102:103], v[102:103], v[114:115]
    v_pk_add_f32 v[100:101], v[100:101], v[132:133]
    v_pk_add_f32 v[102:103], v[102:103], v[116:117]
    v_pk_add_f32 v[100:101], v[100:101], v[134:135]
    v_pk_add_f32 v[102:103], v[102:103], v[118:119]
    v_add_f32 v100, v100, v101
    buffer_load_dwordx4 v[156:159], v7, s[4:7], s9 offen offset:1024
    v_add_f32 v102, v102, v103
    v_rcp_f32 v100, v100
    v_rcp_f32 v102, v102
    v_pk_mul_f32 v[120:121], v[120:121], v[100:101] op_sel_hi:[1,0]
    v_pk_mul_f32 v[122:123], v[122:123], v[100:101] op_sel_hi:[1,0]
    v_pk_mul_f32 v[124:125], v[124:125], v[100:101] op_sel_hi:[1,0]
    v_pk_mul_f32 v[126:127], v[126:127], v[100:101] op_sel_hi:[1,0]
    v_pk_mul_f32 v[128:129], v[128:129], v[100:101] op_sel_hi:[1,0]
    v_pk_mul_f32 v[130:131], v[130:131], v[100:101] op_sel_hi:[1,0]
    v_pk_mul_f32 v[132:133], v[132:133], v[100:101] op_sel_hi:[1,0]
    v_pk_mul_f32 v[134:135], v[134:135], v[100:101] op_sel_hi:[1,0]
    buffer_load_dwordx4 v[160:163], v7, s[4:7], s10 offen
    v_cvt_pk_bf16_f32 v44, v120, v121
    v_cvt_pk_bf16_f32 v45, v122, v123
    v_cvt_pk_bf16_f32 v48, v124, v125
    v_cvt_pk_bf16_f32 v49, v126, v127
    v_cvt_pk_bf16_f32 v52, v128, v129
    v_cvt_pk_bf16_f32 v53, v130, v131
    v_cvt_pk_bf16_f32 v56, v132, v133
    v_cvt_pk_bf16_f32 v57, v134, v135
    v_pk_mul_f32 v[104:105], v[104:105], v[102:103] op_sel_hi:[1,0]
    buffer_load_dwordx4 v[76:79], v1, s[4:7], s21 offen sc1
    v_pk_mul_f32 v[106:107], v[106:107], v[102:103] op_sel_hi:[1,0]
    v_pk_mul_f32 v[108:109], v[108:109], v[102:103] op_sel_hi:[1,0]
    v_pk_mul_f32 v[110:111], v[110:111], v[102:103] op_sel_hi:[1,0]
    buffer_load_dwordx4 v[164:167], v7, s[4:7], s10 offen offset:1024
    v_pk_mul_f32 v[112:113], v[112:113], v[102:103] op_sel_hi:[1,0]
    v_pk_mul_f32 v[114:115], v[114:115], v[102:103] op_sel_hi:[1,0]
    v_pk_mul_f32 v[116:117], v[116:117], v[102:103] op_sel_hi:[1,0]
    v_pk_mul_f32 v[118:119], v[118:119], v[102:103] op_sel_hi:[1,0]
    v_cvt_pk_bf16_f32 v46, v104, v105
    v_cvt_pk_bf16_f32 v47, v106, v107
    v_cvt_pk_bf16_f32 v50, v108, v109
    v_cvt_pk_bf16_f32 v51, v110, v111
    v_cvt_pk_bf16_f32 v54, v112, v113
    v_cvt_pk_bf16_f32 v55, v114, v115
    v_cvt_pk_bf16_f32 v58, v116, v117
    v_cvt_pk_bf16_f32 v59, v118, v119
    s_mov_b32 s91, 0
    s_waitcnt vmcnt(14)
L22c:
    v_max3_u32 v5, v28, v29, v30
    v_max3_u32 v5, v5, v31, v32
    v_max3_u32 v5, v5, v33, v34
    v_max_u32 v5, v5, v35
    v_cmp_eq_u32 vcc, -1, v5
    s_nop 3
    s_cbranch_vccnz L22s
L22:
    buffer_load_dwordx4 v[168:171], v7, s[4:7], s11 offen
    v_mfma_f32_16x16x32_bf16 v[64:67], v[28:31], v[136:139], 0
    v_mfma_f32_16x16x32_bf16 v[64:67], v[32:35], v[136:139], v[64:67]
    v_permlane32_swap_b32 v44, v52
    v_permlane32_swap_b32 v48, v56
    v_permlane32_swap_b32 v45, v53
    v_permlane32_swap_b32 v49, v57
    v_permlane32_swap_b32 v46, v54
    v_permlane32_swap_b32 v50, v58
    v_permlane32_swap_b32 v47, v55
    v_permlane32_swap_b32 v51, v59
    v_add_f32 v64, v64, v65
    buffer_load_dwordx4 v[172:175], v7, s[4:7], s11 offen offset:1024
    v_add_f32 v66, v66, v67
    v_add_f32 v64, v64, v66
    v_permlane16_swap_b32 v44, v48
    v_permlane16_swap_b32 v52, v56
    v_mov_b32_dpp v65, v64 quad_perm:[1,0,3,2] row_mask:0xf bank_mask:0xf
    v_cvt_pk_bf16_f32 v64, v64, v65
    v_permlane16_swap_b32 v45, v49
    v_permlane16_swap_b32 v53, v57
    v_mov_b32_dpp v72, v64 row_newbcast:0 row_mask:0xf bank_mask:0xf
    v_mov_b32_dpp v73, v64 row_newbcast:2 row_mask:0xf bank_mask:0xf
    v_mov_b32_dpp v74, v64 row_newbcast:4 row_mask:0xf bank_mask:0xf
    v_mov_b32_dpp v75, v64 row_newbcast:6 row_mask:0xf bank_mask:0xf
    v_permlane16_swap_b32 v46, v50
    v_permlane16_swap_b32 v54, v58
    v_permlane16_swap_b32 v47, v51
    v_permlane16_swap_b32 v55, v59
    s_nop 0
    v_mfma_f32_16x16x32_bf16 v[96:99], v[72:75], v[44:47], 0
    v_mfma_f32_16x16x32_bf16 v[100:103], v[72:75], v[48:51], 0
    v_mfma_f32_16x16x32_bf16 v[104:107], v[72:75], v[52:55], 0
    v_mfma_f32_16x16x32_bf16 v[108:111], v[72:75], v[56:59], 0
    s_nop 4
    v_add_f32 v96, 0x358637bd, v96
    v_add_f32 v100, 0x358637bd, v100
    v_add_f32 v104, 0x358637bd, v104
    v_add_f32 v108, 0x358637bd, v108
    v_rcp_f32 v96, v96
    v_rcp_f32 v100, v100
    v_rcp_f32 v104, v104
    v_rcp_f32 v108, v108
    s_mov_b32 s91, 0
    s_waitcnt vmcnt(3)
L23c:
    v_mfma_f32_16x16x32_bf16 v[120:123], v[76:79], v[44:47], 0
    v_max3_u32 v5, v76, v77, v78
    v_max_u32 v5, v5, v79
    v_cmp_eq_u32 vcc, -1, v5
    v_mfma_f32_16x16x32_bf16 v[124:127], v[76:79], v[48:51], 0
    v_mfma_f32_16x16x32_bf16 v[128:131], v[76:79], v[52:55], 0
    v_mfma_f32_16x16x32_bf16 v[132:135], v[76:79], v[56:59], 0
    s_nop 0
    s_cbranch_vccnz L23s
L23:
    v_mul_f32 v120, v120, v96
    v_mul_f32 v121, v121, v96
    v_mul_f32 v122, v122, v96
    v_mul_f32_e64 v123, v123, v96
    v_pk_mul_f32 v[124:125], v[124:125], v[100:101] op_sel_hi:[1,0]
    v_pk_mul_f32 v[126:127], v[126:127], v[100:101] op_sel_hi:[1,0]
    v_cvt_pk_bf16_f32 v112, v120, v121
    v_cvt_pk_bf16_f32 v113, v122, v123
    v_cvt_pk_bf16_f32 v114, v124, v125
    v_cvt_pk_bf16_f32 v115, v126, v127
    s_nop 0
    v_permlane16_swap_b32 v112, v114
    v_permlane16_swap_b32 v113, v115
    buffer_store_dwordx4 v[112:115], v2, s[4:7], s22 offen
    v_pk_mul_f32 v[128:129], v[128:129], v[104:105] op_sel_hi:[1,0]
    v_pk_mul_f32 v[130:131], v[130:131], v[104:105] op_sel_hi:[1,0]
    v_pk_mul_f32 v[132:133], v[132:133], v[108:109] op_sel_hi:[1,0]
    v_pk_mul_f32 v[134:135], v[134:135], v[108:109] op_sel_hi:[1,0]
    v_cvt_pk_bf16_f32 v116, v128, v129
    v_cvt_pk_bf16_f32 v117, v130, v131
    v_cvt_pk_bf16_f32 v118, v132, v133
    v_cvt_pk_bf16_f32 v119, v134, v135
    s_nop 0
    v_permlane16_swap_b32 v116, v118
    v_permlane16_swap_b32 v117, v119
    buffer_store_dwordx4 v[116:119], v2, s[4:7], s23 offen
    v_bfe_u32 v142, v1, 8, 1
    v_lshrrev_b32 v143, 9, v1
    v_lshlrev_b32 v142, 11, v142
    v_lshl_add_u32 v142, v143, 8, v142
    v_and_b32 v143, 0xf0, v1
    s_lshl_b32 s34, s28, 9
    s_add_u32 s34, s34, 131072
    v_add3_u32 v142, v142, v143, s34
    ds_write_b128 v142, v[112:115] offset:0
    ds_write_b128 v142, v[116:119] offset:4096
    s_lshl_b32 s34, s28, 11
    s_add_u32 s34, s34, 131072
    v_add_u32 v143, s34, v1
    v_lshlrev_b32 v28, 16, v8
    v_and_b32 v29, s41, v8
    v_lshlrev_b32 v30, 16, v9
    v_and_b32 v31, s41, v9
    v_lshlrev_b32 v32, 16, v10
    v_and_b32 v33, s41, v10
    v_lshlrev_b32 v34, 16, v11
    v_and_b32 v35, s41, v11
    v_lshlrev_b32 v36, 16, v12
    v_and_b32 v37, s41, v12
    v_lshlrev_b32 v38, 16, v13
    v_and_b32 v39, s41, v13
    v_lshlrev_b32 v40, 16, v14
    v_and_b32 v41, s41, v14
    v_lshlrev_b32 v42, 16, v15
    v_and_b32 v43, s41, v15
    s_mul_i32 s34, s28, 44032
    s_add_u32 s34, s34, s86
    s_add_u32 s34, s34, 21798912
    v_add_u32 v140, s34, v1
    s_lshl_b32 s35, s29, 11
    s_add_u32 s99, s63, s35
    s_add_u32 s99, s99, s44
    s_add_u32 s99, s99, 3448832
    s_lshl_b32 s34, s30, 13
    s_lshl_b32 s35, s29, 10
    s_add_u32 s34, s34, s35
    s_lshl_b32 s35, s28, 8
    s_add_u32 s34, s34, s35
    s_add_u32 s34, s34, 9740288
    v_bfe_u32 v141, v1, 4, 4
    v_lshl_add_u32 v141, v141, 4, s34
    v_mov_b32 v5, 1879048192
    s_mov_b32 vcc_lo, 0x00f0000f
    s_mov_b32 vcc_hi, 0xf0000f00
    v_cndmask_b32 v141, v5, v141, vcc
    v_add_u32 v6, s45, 6
    s_cmp_eq_u32 s46, 0
    s_mov_b64 exec, s[72:73]
    s_waitcnt vmcnt(0)
    s_cbranch_scc1 L24s
    buffer_store_dword v6, v3, s[4:7], 0 offen
L24:
    s_mov_b64 exec, -1
    s_waitcnt lgkmcnt(0)
    s_barrier
    ds_read_b128 v[108:111], v143 offset:0
    ds_read_b128 v[112:115], v143 offset:1024
    ds_read_b128 v[44:47], v1 offset:0
    ds_read_b128 v[48:51], v1 offset:4096
    ds_read_b128 v[52:55], v1 offset:1024
    ds_read_b128 v[56:59], v1 offset:5120
    ds_read_b128 v[60:63], v1 offset:2048
    ds_read_b128 v[64:67], v1 offset:6144
    ds_read_b128 v[68:71], v1 offset:3072
    ds_read_b128 v[72:75], v1 offset:7168
    ds_read_b128 v[76:79], v1 offset:8192
    ds_read_b128 v[80:83], v1 offset:12288
    ds_read_b128 v[84:87], v1 offset:9216
    ds_read_b128 v[88:91], v1 offset:13312
    ds_read_b128 v[92:95], v1 offset:10240
    ds_read_b128 v[96:99], v1 offset:14336
    ds_read_b128 v[100:103], v1 offset:11264
    s_cmp_lg_u32 s28, 0
    s_cbranch_scc1 L25
    s_cmp_eq_u32 s46, 0
    s_cbranch_scc1 L25s
    s_mov_b32 s91, 524288
    s_add_u32 s82, s45, 6
L25q:
    buffer_load_dword v5, v3, s[4:7], 0 offen sc1
    s_sub_u32 s91, s91, 1
    s_cbranch_scc1 L25
    s_waitcnt vmcnt(0)
    v_subrev_u32 v5, s82, v5
    v_cmp_lt_u32 vcc, 9, v5
    s_nop 3
    s_cbranch_vccnz L25q
L25:
    s_barrier
    buffer_load_dwordx4 v[116:119], v140, s[4:7], s9 offen sc1
    s_waitcnt lgkmcnt(14)
    v_mfma_f32_16x16x32_bf16 v[28:31], v[44:47], v[108:111], v[28:31]
    ds_read_b128 v[104:107], v1 offset:15360
    s_waitcnt lgkmcnt(14)
    v_mfma_f32_16x16x32_bf16 v[28:31], v[48:51], v[112:115], v[28:31]
    buffer_load_dwordx4 v[120:123], v140, s[4:7], s9 offen offset:1024 sc1
    ds_read_b128 v[44:47], v1 offset:16384
    s_waitcnt lgkmcnt(13)
    v_mfma_f32_16x16x32_bf16 v[32:35], v[52:55], v[108:111], v[32:35]
    buffer_load_dwordx4 v[124:127], v140, s[4:7], s10 offen sc1
    ds_read_b128 v[48:51], v1 offset:20480
    v_mfma_f32_16x16x32_bf16 v[32:35], v[56:59], v[112:115], v[32:35]
    ds_read_b128 v[52:55], v1 offset:17408
    s_waitcnt lgkmcnt(11)
    buffer_load_dwordx4 v[128:131], v140, s[4:7], s10 offen offset:1024 sc1
    v_mfma_f32_16x16x32_bf16 v[36:39], v[60:63], v[108:111], v[36:39]
    ds_read_b128 v[56:59], v1 offset:21504
    v_mfma_f32_16x16x32_bf16 v[36:39], v[64:67], v[112:115], v[36:39]
    buffer_load_dwordx4 v[132:135], v140, s[4:7], s11 offen sc1
    ds_read_b128 v[60:63], v1 offset:18432
    v_mfma_f32_16x16x32_bf16 v[40:43], v[68:71], v[108:111], v[40:43]
    buffer_load_dwordx4 v[136:139], v140, s[4:7], s11 offen offset:1024 sc1
    ds_read_b128 v[64:67], v1 offset:22528
    v_mfma_f32_16x16x32_bf16 v[40:43], v[72:75], v[112:115], v[40:43]
    ds_read_b128 v[68:71], v1 offset:19456
    s_waitcnt vmcnt(5) lgkmcnt(11)
    v_mfma_f32_16x16x32_bf16 v[28:31], v[76:79], v[116:119], v[28:31]
    buffer_load_dwordx4 v[108:111], v140, s[4:7], s33 offen sc1
    s_waitcnt vmcnt(5)
    v_mfma_f32_16x16x32_bf16 v[28:31], v[80:83], v[120:123], v[28:31]
    ds_read_b128 v[72:75], v1 offset:23552
    v_mfma_f32_16x16x32_bf16 v[32:35], v[84:87], v[116:119], v[32:35]
    ds_read_b128 v[76:79], v1 offset:24576
    v_mfma_f32_16x16x32_bf16 v[32:35], v[88:91], v[120:123], v[32:35]
    ds_read_b128 v[80:83], v1 offset:28672
    s_waitcnt lgkmcnt(10)
    v_mfma_f32_16x16x32_bf16 v[36:39], v[92:95], v[116:119], v[36:39]
    buffer_load_dwordx4 v[112:115], v140, s[4:7], s33 offen offset:1024 sc1
    v_mfma_f32_16x16x32_bf16 v[36:39], v[96:99], v[120:123], v[36:39]
    ds_read_b128 v[84:87], v1 offset:25600
    v_mfma_f32_16x16x32_bf16 v[40:43], v[100:103], v[116:119], v[40:43]
    ds_read_b128 v[88:91], v1 offset:29696
    v_mfma_f32_16x16x32_bf16 v[40:43], v[104:107], v[120:123], v[40:43]
    ds_read_b128 v[92:95], v1 offset:26624
    s_waitcnt vmcnt(5) lgkmcnt(9)
    v_mfma_f32_16x16x32_bf16 v[28:31], v[44:47], v[124:127], v[28:31]
    buffer_load_dwordx4 v[116:119], v140, s[4:7], s40 offen sc1
    s_waitcnt vmcnt(5)
    v_mfma_f32_16x16x32_bf16 v[28:31], v[48:51], v[128:131], v[28:31]
    ds_read_b128 v[96:99], v1 offset:30720
    v_mfma_f32_16x16x32_bf16 v[32:35], v[52:55], v[124:127], v[32:35]
    ds_read_b128 v[100:103], v1 offset:27648
    v_mfma_f32_16x16x32_bf16 v[32:35], v[56:59], v[128:131], v[32:35]
    ds_read_b128 v[104:107], v1 offset:31744
    s_waitcnt lgkmcnt(8)
    v_mfma_f32_16x16x32_bf16 v[36:39], v[60:63], v[124:127], v[36:39]
    buffer_load_dwordx4 v[120:123], v140, s[4:7], s40 offen offset:1024 sc1
    v_mfma_f32_16x16x32_bf16 v[36:39], v[64:67], v[128:131], v[36:39]
    ds_read_b128 v[44:47], v1 offset:32768
    v_mfma_f32_16x16x32_bf16 v[40:43], v[68:71], v[124:127], v[40:43]
    ds_read_b128 v[48:51], v1 offset:36864
    v_mfma_f32_16x16x32_bf16 v[40:43], v[72:75], v[128:131], v[40:43]
    ds_read_b128 v[52:55], v1 offset:33792
    s_waitcnt vmcnt(5) lgkmcnt(7)
    v_mfma_f32_16x16x32_bf16 v[28:31], v[76:79], v[132:135], v[28:31]
    buffer_load_dwordx4 v[124:127], v140, s[4:7], s84 offen sc1
    s_waitcnt vmcnt(5)
    v_mfma_f32_16x16x32_bf16 v[28:31], v[80:83], v[136:139], v[28:31]
    ds_read_b128 v[56:59], v1 offset:37888
    v_mfma_f32_16x16x32_bf16 v[32:35], v[84:87], v[132:135], v[32:35]
    ds_read_b128 v[60:63], v1 offset:34816
    v_mfma_f32_16x16x32_bf16 v[32:35], v[88:91], v[136:139], v[32:35]
    ds_read_b128 v[64:67], v1 offset:38912
    s_waitcnt lgkmcnt(6)
    v_mfma_f32_16x16x32_bf16 v[36:39], v[92:95], v[132:135], v[36:39]
    buffer_load_dwordx4 v[128:131], v140, s[4:7], s84 offen offset:1024 sc1
    v_mfma_f32_16x16x32_bf16 v[36:39], v[96:99], v[136:139], v[36:39]
    ds_read_b128 v[68:71], v1 offset:35840
    v_mfma_f32_16x16x32_bf16 v[40:43], v[100:103], v[132:135], v[40:43]
    ds_read_b128 v[72:75], v1 offset:39936
    v_mfma_f32_16x16x32_bf16 v[40:43], v[104:107], v[136:139], v[40:43]
    ds_read_b128 v[76:79], v1 offset:40960
    s_waitcnt vmcnt(5) lgkmcnt(7)
    v_mfma_f32_16x16x32_bf16 v[28:31], v[44:47], v[108:111], v[28:31]
    buffer_load_dwordx4 v[132:135], v140, s[4:7], s38 offen sc1
    s_waitcnt vmcnt(5)
    v_mfma_f32_16x16x32_bf16 v[28:31], v[48:51], v[112:115], v[28:31]
    ds_read_b128 v[80:83], v1 offset:45056
    s_waitcnt lgkmcnt(6)
    v_mfma_f32_16x16x32_bf16 v[32:35], v[52:55], v[108:111], v[32:35]
    ds_read_b128 v[84:87], v1 offset:41984
    v_mfma_f32_16x16x32_bf16 v[32:35], v[56:59], v[112:115], v[32:35]
    ds_read_b128 v[88:91], v1 offset:46080
    s_waitcnt lgkmcnt(6)
    v_mfma_f32_16x16x32_bf16 v[36:39], v[60:63], v[108:111], v[36:39]
    buffer_load_dwordx4 v[136:139], v140, s[4:7], s38 offen offset:1024 sc1
    v_mfma_f32_16x16x32_bf16 v[36:39], v[64:67], v[112:115], v[36:39]
    ds_read_b128 v[92:95], v1 offset:43008
    s_waitcnt lgkmcnt(5)
    v_mfma_f32_16x16x32_bf16 v[40:43], v[68:71], v[108:111], v[40:43]
    ds_read_b128 v[96:99], v1 offset:47104
    v_mfma_f32_16x16x32_bf16 v[40:43], v[72:75], v[112:115], v[40:43]
    ds_read_b128 v[100:103], v1 offset:44032
    s_waitcnt vmcnt(5) lgkmcnt(5)
    v_mfma_f32_16x16x32_bf16 v[28:31], v[76:79], v[116:119], v[28:31]
    ds_read_b128 v[104:107], v1 offset:48128
    s_waitcnt vmcnt(4)
    v_mfma_f32_16x16x32_bf16 v[28:31], v[80:83], v[120:123], v[28:31]
    ds_read_b128 v[44:47], v1 offset:49152
    s_waitcnt lgkmcnt(5)
    v_mfma_f32_16x16x32_bf16 v[32:35], v[84:87], v[116:119], v[32:35]
    ds_read_b128 v[48:51], v1 offset:53248
    v_mfma_f32_16x16x32_bf16 v[32:35], v[88:91], v[120:123], v[32:35]
    ds_read_b128 v[52:55], v1 offset:50176
    s_waitcnt lgkmcnt(5)
    v_mfma_f32_16x16x32_bf16 v[36:39], v[92:95], v[116:119], v[36:39]
    ds_read_b128 v[56:59], v1 offset:54272
    v_mfma_f32_16x16x32_bf16 v[36:39], v[96:99], v[120:123], v[36:39]
    ds_read_b128 v[60:63], v1 offset:51200
    s_waitcnt lgkmcnt(5)
    v_mfma_f32_16x16x32_bf16 v[40:43], v[100:103], v[116:119], v[40:43]
    ds_read_b128 v[64:67], v1 offset:55296
    v_mfma_f32_16x16x32_bf16 v[40:43], v[104:107], v[120:123], v[40:43]
    ds_read_b128 v[68:71], v1 offset:52224
    s_waitcnt vmcnt(3) lgkmcnt(5)
    v_mfma_f32_16x16x32_bf16 v[28:31], v[44:47], v[124:127], v[28:31]
    ds_read_b128 v[72:75], v1 offset:56320
    s_waitcnt vmcnt(2)
    v_mfma_f32_16x16x32_bf16 v[28:31], v[48:51], v[128:131], v[28:31]
    ds_read_b128 v[76:79], v1 offset:57344
    s_waitcnt lgkmcnt(5)
    v_mfma_f32_16x16x32_bf16 v[32:35], v[52:55], v[124:127], v[32:35]
    ds_read_b128 v[80:83], v1 offset:61440
    v_mfma_f32_16x16x32_bf16 v[32:35], v[56:59], v[128:131], v[32:35]
    ds_read_b128 v[84:87], v1 offset:58368
    s_waitcnt lgkmcnt(5)
    v_mfma_f32_16x16x32_bf16 v[36:39], v[60:63], v[124:127], v[36:39]
    ds_read_b128 v[88:91], v1 offset:62464
    v_mfma_f32_16x16x32_bf16 v[36:39], v[64:67], v[128:131], v[36:39]
    ds_read_b128 v[92:95], v1 offset:59392
    s_waitcnt lgkmcnt(5)
    v_mfma_f32_16x16x32_bf16 v[40:43], v[68:71], v[124:127], v[40:43]
    ds_read_b128 v[96:99], v1 offset:63488
    v_mfma_f32_16x16x32_bf16 v[40:43], v[72:75], v[128:131], v[40:43]
    ds_read_b128 v[100:103], v1 offset:60416
    s_waitcnt vmcnt(1) lgkmcnt(5)
    v_mfma_f32_16x16x32_bf16 v[28:31], v[76:79], v[132:135], v[28:31]
    ds_read_b128 v[104:107], v1 offset:64512
    s_waitcnt vmcnt(0)
    v_mfma_f32_16x16x32_bf16 v[28:31], v[80:83], v[136:139], v[28:31]
    s_waitcnt lgkmcnt(4)
    v_mfma_f32_16x16x32_bf16 v[32:35], v[84:87], v[132:135], v[32:35]
    v_mfma_f32_16x16x32_bf16 v[32:35], v[88:91], v[136:139], v[32:35]
    s_waitcnt lgkmcnt(2)
    v_mfma_f32_16x16x32_bf16 v[36:39], v[92:95], v[132:135], v[36:39]
    v_mfma_f32_16x16x32_bf16 v[36:39], v[96:99], v[136:139], v[36:39]
    s_waitcnt lgkmcnt(0)
    v_mfma_f32_16x16x32_bf16 v[40:43], v[100:103], v[132:135], v[40:43]
    v_mfma_f32_16x16x32_bf16 v[40:43], v[104:107], v[136:139], v[40:43]
    v_cvt_pk_bf16_f32 v8, v28, v29
    v_cvt_pk_bf16_f32 v9, v30, v31
    v_cvt_pk_bf16_f32 v10, v32, v33
    v_cvt_pk_bf16_f32 v11, v34, v35
    s_nop 0
    v_cvt_pk_bf16_f32 v12, v36, v37
    v_cvt_pk_bf16_f32 v13, v38, v39
    s_nop 0
    v_cvt_pk_bf16_f32 v14, v40, v41
    v_cvt_pk_bf16_f32 v15, v42, v43
    v_mfma_f32_16x16x32_bf16 v[44:47], v[8:11], v[8:11], 0
    buffer_store_dwordx4 v[8:11], v1, s[4:7], s99 offen
    v_mfma_f32_16x16x32_bf16 v[44:47], v[12:15], v[12:15], v[44:47]
    v_mfma_f32_16x16x32_bf16 v[48:51], v[24:27], v[8:11], 0
    v_mfma_f32_16x16x32_bf16 v[48:51], v[24:27], v[12:15], v[48:51]
    buffer_store_dwordx4 v[12:15], v1, s[4:7], s99 offen offset:1024
    s_nop 4
    v_cndmask_b32 v44, v44, v45, s[76:77]
    v_cndmask_b32 v44, v44, v46, s[78:79]
    v_cndmask_b32 v49, v44, v47, s[80:81]
    v_mov_b32 v50, 0
    v_mov_b32 v51, 0
    buffer_store_dwordx4 v[48:51], v141, s[4:7], 0 offen
    v_add_u32 v142, 139264, v1
    v_lshl_add_u32 v143, s47, 1, v142
    ds_write_b128 v143, v[8:11] offset:0
    ds_write_b128 v143, v[12:15] offset:1024
    s_lshl_b32 s85, s30, 13
    s_add_u32 s85, s85, 9740288
    v_bfe_u32 v126, v1, 4, 4
    v_lshrrev_b32 v127, 8, v1
    v_lshrrev_b32 v128, 8, s47
    v_lshlrev_b32 v134, 11, v127
    v_lshl_add_u32 v134, v126, 4, v134
    v_lshl_add_u32 v134, v128, 6, v134
    v_lshl_add_u32 v135, v126, 4, v128
    v_lshlrev_b32 v128, 4, v128
    v_lshl_add_u32 v126, v126, 2, v128
    s_mov_b32 vcc_lo, -1
    s_mov_b32 vcc_hi, 0
    v_cndmask_b32 v135, v126, v135, vcc
    v_lshl_add_u32 v135, v127, 8, v135
    v_add_u32 v135, 147456, v135
    s_add_u32 s34, s44, 3448832
    v_add_u32 v136, s34, v1
    s_add_u32 s34, s8, s47
    s_add_u32 s24, s34, 4096
    s_and_b32 s24, s24, 0x3fff
    s_add_u32 s25, s34, 8192
    s_and_b32 s25, s25, 0x3fff
    s_add_u32 s26, s34, 12288
    s_and_b32 s26, s26, 0x3fff
    s_lshr_b32 s34, s28, 1
    s_lshl_b32 s34, s34, 4
    s_and_b32 s35, s28, 1
    s_add_u32 s34, s34, s35
    s_lshl_b32 s3, s34, 10
    s_add_u32 s27, s3, s9
    s_lshl_b32 s35, s31, 9
    s_add_u32 s34, s86, s35
    s_add_u32 s34, s34, 21798912
    v_add_u32 v137, s34, v2
    s_lshl_b32 s35, s92, 9
    s_add_u32 s35, s35, s86
    s_add_u32 s35, s35, 21798912
    s_cmp_lt_u32 s92, 22
    s_cselect_b32 s35, s35, 1879048192
    v_add_u32 v138, s35, v2
    v_bfe_u32 v5, v1, 6, 2
    v_mul_u32_u24 v5, 44032, v5
    v_bfe_u32 v6, v1, 4, 2
    v_lshl_add_u32 v5, v6, 7, v5
    v_lshrrev_b32 v6, 8, v1
    v_lshl_add_u32 v5, v6, 14, v5
    v_mov_b32 v141, 1879048192
    s_mov_b32 exec_hi, 0xffff
    v_add_u32 v141, s35, v5
    s_mov_b32 exec_hi, 0
    v_add_u32 v141, s34, v5
    s_mov_b64 exec, -1
    v_mov_b32 v139, s74
    v_and_b32 v140, 0xf0, v1
    v_add_u32 v140, 147456, v140
    s_lshr_b32 s34, s28, 1
    s_and_b32 s35, s28, 1
    s_lshl_b32 s36, s29, 1
    s_add_u32 s35, s35, s36
    s_lshl_b32 s36, s34, 4
    v_add_u32 v6, s45, 7
    s_cmp_eq_u32 s46, 0
    s_mov_b64 exec, s[72:73]
    s_waitcnt vmcnt(0)
    s_cbranch_scc1 L26s
    buffer_store_dword v6, v3, s[4:7], 0 offen
L26:
    s_mov_b64 exec, -1
    s_add_u32 s36, s36, s35
    s_lshl_b32 s100, s36, 10
    v_add_u32 v143, s47, v142
    s_mul_i32 s34, s34, 44032
    s_mul_i32 s35, s28, 0
    s_add_u32 s35, s35, s86
    s_add_u32 s35, s35, 21798912
    s_add_u32 s99, s35, s34
    s_sub_u32 s101, s35, s34
    s_add_u32 s101, s101, 44032
    v_lshrrev_b32 v0, 8, v1
    v_lshlrev_b32 v0, 4, v0
    s_add_u32 s34, s47, 148480
    v_add_u32 v0, s34, v0
    ds_read_b128 v[108:111], v0 offset:384
    ds_read_b128 v[112:115], v0 offset:448
    ds_read_b128 v[116:119], v0 offset:512
    ds_read_b128 v[96:99], v0 offset:128
    ds_read_b128 v[100:103], v0 offset:192
    ds_read_b128 v[104:107], v0 offset:256
    s_waitcnt lgkmcnt(6)
    s_barrier
    ds_read_b128 v[76:79], v142 offset:0
    ds_read_b128 v[80:83], v142 offset:1024
    ds_read_b128 v[84:87], v142 offset:2048
    ds_read_b128 v[88:91], v142 offset:3072
    s_cmp_lg_u32 s28, 0
    s_cbranch_scc1 L27
    s_cmp_eq_u32 s46, 0
    s_cbranch_scc1 L27s
    s_mov_b32 s91, 524288
    s_add_u32 s82, s45, 7
L27q:
    buffer_load_dword v5, v3, s[4:7], 0 offen sc1
    s_sub_u32 s91, s91, 1
    s_cbranch_scc1 L27
    s_waitcnt vmcnt(0)
    v_subrev_u32 v5, s82, v5
    v_cmp_lt_u32 vcc, 8, v5
    s_nop 3
    s_cbranch_vccnz L27q
L27:
    s_barrier
    s_add_u32 m0, s47, 4096
    s_nop 0
    buffer_load_dwordx4 v136, s[4:7], s24 offen sc1 lds
    s_waitcnt lgkmcnt(3)
    v_mfma_f32_16x16x32_bf16 v[28:31], a[176:179], v[76:79], 0
    ds_read_b128 v[92:95], v142 offset:4096
    s_add_u32 m0, s47, 8192
    s_waitcnt lgkmcnt(3)
    v_mfma_f32_16x16x32_bf16 v[28:31], a[180:183], v[80:83], v[28:31]
    buffer_load_dwordx4 v136, s[4:7], s25 offen sc1 lds
    v_mfma_f32_16x16x32_bf16 v[44:47], v[144:147], v[76:79], 0
    v_mfma_f32_16x16x32_bf16 v[44:47], v[148:151], v[80:83], v[44:47]
    ds_read_b128 v[12:15], v142 offset:5120
    v_mfma_f32_16x16x32_bf16 v[60:63], v[192:195], v[76:79], 0
    buffer_load_dwordx4 v[126:129], v134, s[4:7], s85 offen sc1
    v_mfma_f32_16x16x32_bf16 v[60:63], v[196:199], v[80:83], v[60:63]
    s_waitcnt lgkmcnt(2)
    v_mfma_f32_16x16x32_bf16 v[32:35], a[176:179], v[84:87], 0
    ds_read_b128 v[76:79], v142 offset:6144
    v_mfma_f32_16x16x32_bf16 v[32:35], a[180:183], v[88:91], v[32:35]
    buffer_load_dwordx4 v[130:133], v134, s[4:7], s85 offen offset:1024 sc1
    v_mfma_f32_16x16x32_bf16 v[48:51], v[144:147], v[84:87], 0
    s_add_u32 m0, s47, 12288
    v_mfma_f32_16x16x32_bf16 v[48:51], v[148:151], v[88:91], v[48:51]
    ds_read_b128 v[80:83], v142 offset:7168
    v_mfma_f32_16x16x32_bf16 v[64:67], v[192:195], v[84:87], 0
    buffer_load_dwordx4 v136, s[4:7], s26 offen sc1 lds
    v_mfma_f32_16x16x32_bf16 v[64:67], v[196:199], v[88:91], v[64:67]
    s_waitcnt lgkmcnt(2)
    s_add_u32 m0, s3, 2048
    v_mfma_f32_16x16x32_bf16 v[36:39], a[176:179], v[92:95], 0
    v_mfma_f32_16x16x32_bf16 v[36:39], a[180:183], v[12:15], v[36:39]
    v_mfma_f32_16x16x32_bf16 v[52:55], v[144:147], v[92:95], 0
    buffer_load_dwordx4 v136, s[4:7], s27 offen sc1 lds
    v_mfma_f32_16x16x32_bf16 v[52:55], v[148:151], v[12:15], v[52:55]
    s_add_u32 m0, s47, 20480
    v_add_u32 v136, 16384, v136
    v_mfma_f32_16x16x32_bf16 v[68:71], v[192:195], v[92:95], 0
    v_mfma_f32_16x16x32_bf16 v[68:71], v[196:199], v[12:15], v[68:71]
    s_waitcnt lgkmcnt(0)
    v_mfma_f32_16x16x32_bf16 v[40:43], a[176:179], v[76:79], 0
    buffer_load_dwordx4 v136, s[4:7], s24 offen sc1 lds
    v_mfma_f32_16x16x32_bf16 v[40:43], a[180:183], v[80:83], v[40:43]
    v_mfma_f32_16x16x32_bf16 v[56:59], v[144:147], v[76:79], 0
    v_mfma_f32_16x16x32_bf16 v[56:59], v[148:151], v[80:83], v[56:59]
    v_mfma_f32_16x16x32_bf16 v[72:75], v[192:195], v[76:79], 0
    v_mfma_f32_16x16x32_bf16 v[72:75], v[196:199], v[80:83], v[72:75]
    s_waitcnt vmcnt(6)
    s_barrier
    ds_read_b128 v[76:79], v1 offset:4096
    ds_read_b128 v[80:83], v1 offset:5120
    ds_read_b128 v[84:87], v1 offset:6144
    ds_read_b128 v[88:91], v1 offset:7168
    s_waitcnt lgkmcnt(3)
    v_mfma_f32_16x16x32_bf16 v[28:31], a[192:195], v[76:79], v[28:31]
    s_waitcnt vmcnt(5)
    s_barrier
    ds_read_b128 v[92:95], v1 offset:8192
    s_add_u32 m0, s47, 24576
    s_waitcnt lgkmcnt(3)
    v_mfma_f32_16x16x32_bf16 v[28:31], a[196:199], v[80:83], v[28:31]
    buffer_load_dwordx4 v136, s[4:7], s25 offen sc1 lds
    v_mfma_f32_16x16x32_bf16 v[44:47], v[160:163], v[76:79], v[44:47]
    s_add_u32 m0, s47, 28672
    v_mfma_f32_16x16x32_bf16 v[44:47], v[164:167], v[80:83], v[44:47]
    ds_read_b128 v[12:15], v1 offset:9216
    v_mfma_f32_16x16x32_bf16 v[60:63], v[208:211], v[76:79], v[60:63]
    buffer_load_dwordx4 v136, s[4:7], s26 offen sc1 lds
    v_mfma_f32_16x16x32_bf16 v[60:63], v[212:215], v[80:83], v[60:63]
    s_waitcnt lgkmcnt(2)
    s_add_u32 m0, s47, 36864
    v_add_u32 v136, 16384, v136
    v_mfma_f32_16x16x32_bf16 v[28:31], a[200:203], v[84:87], v[28:31]
    ds_read_b128 v[76:79], v1 offset:10240
    s_waitcnt vmcnt(6)
    v_add_f32 v126, v126, v128
    v_add_f32 v127, v127, v129
    v_mfma_f32_16x16x32_bf16 v[28:31], a[204:207], v[88:91], v[28:31]
    s_waitcnt vmcnt(5)
    v_add_f32 v130, v130, v132
    v_add_f32 v131, v131, v133
    v_mfma_f32_16x16x32_bf16 v[44:47], v[168:171], v[84:87], v[44:47]
    buffer_load_dwordx4 v136, s[4:7], s24 offen sc1 lds
    v_add_f32 v126, v126, v130
    v_add_f32 v127, v127, v131
    v_mfma_f32_16x16x32_bf16 v[44:47], v[172:175], v[88:91], v[44:47]
    ds_read_b128 v[80:83], v1 offset:11264
    s_add_u32 m0, s47, 40960
    v_mov_b32 v128, v126
    v_mfma_f32_16x16x32_bf16 v[60:63], v[216:219], v[84:87], v[60:63]
    v_mov_b32 v129, v127
    v_mfma_f32_16x16x32_bf16 v[60:63], v[220:223], v[88:91], v[60:63]
    s_waitcnt lgkmcnt(2)
    v_permlane32_swap_b32 v126, v128
    v_mfma_f32_16x16x32_bf16 v[28:31], a[208:211], v[92:95], v[28:31]
    s_waitcnt vmcnt(4)
    s_barrier
    ds_read_b128 v[84:87], v1 offset:12288
    v_permlane32_swap_b32 v127, v129
    v_mfma_f32_16x16x32_bf16 v[28:31], a[212:215], v[12:15], v[28:31]
    buffer_load_dwordx4 v136, s[4:7], s25 offen sc1 lds
    v_mfma_f32_16x16x32_bf16 v[44:47], v[176:179], v[92:95], v[44:47]
    s_add_u32 m0, s47, 45056
    v_add_f32 v126, v126, v128
    v_add_f32 v127, v127, v129
    v_mfma_f32_16x16x32_bf16 v[44:47], v[180:183], v[12:15], v[44:47]
    ds_read_b128 v[88:91], v1 offset:13312
    v_mov_b32 v128, v126
    v_mov_b32 v129, v127
    v_mfma_f32_16x16x32_bf16 v[60:63], v[224:227], v[92:95], v[60:63]
    buffer_load_dwordx4 v136, s[4:7], s26 offen sc1 lds
    v_permlane16_swap_b32 v126, v128
    v_mfma_f32_16x16x32_bf16 v[60:63], v[228:231], v[12:15], v[60:63]
    s_waitcnt lgkmcnt(2)
    s_add_u32 m0, s3, 34816
    v_mfma_f32_16x16x32_bf16 v[28:31], a[216:219], v[76:79], v[28:31]
    ds_read_b128 v[92:95], v1 offset:14336
    v_permlane16_swap_b32 v127, v129
    v_mfma_f32_16x16x32_bf16 v[28:31], a[220:223], v[80:83], v[28:31]
    v_add_f32 v126, v126, v128
    v_add_f32 v127, v127, v129
    v_mfma_f32_16x16x32_bf16 v[44:47], v[184:187], v[76:79], v[44:47]
    buffer_load_dwordx4 v136, s[4:7], s27 offen sc1 lds
    v_mul_f32 v126, 0xbb000000, v126
    v_mul_f32 v127, 0x3b000000, v127
    v_mfma_f32_16x16x32_bf16 v[44:47], v[188:191], v[80:83], v[44:47]
    ds_read_b128 v[12:15], v1 offset:15360
    s_add_u32 m0, s47, 53248
    v_add_u32 v136, 16384, v136
    v_mfma_f32_16x16x32_bf16 v[60:63], v[232:235], v[76:79], v[60:63]
    v_fma_f32 v127, -v126, v126, v127
    v_max_f32 v127, 0, v127
    v_mfma_f32_16x16x32_bf16 v[60:63], v[236:239], v[80:83], v[60:63]
    s_waitcnt lgkmcnt(2)
    v_add_f32 v128, 0x3727c5ac, v127
    v_mfma_f32_16x16x32_bf16 v[28:31], a[224:227], v[84:87], v[28:31]
    ds_read_b128 v[76:79], v1 offset:2048
    buffer_load_dwordx4 v136, s[4:7], s24 offen sc1 lds
    v_mfma_f32_16x16x32_bf16 v[28:31], a[228:231], v[88:91], v[28:31]
    s_add_u32 m0, s47, 57344
    v_rsq_f32 v128, v128
    v_mfma_f32_16x16x32_bf16 v[44:47], a[240:243], v[84:87], v[44:47]
    v_mul_f32 v127, v128, v127
    v_fmaak_f32 v127, v127, v128, 0x3727c5ac
    v_mfma_f32_16x16x32_bf16 v[44:47], a[244:247], v[88:91], v[44:47]
    ds_read_b128 v[80:83], v1 offset:3072
    v_rsq_f32 v127, v127
    v_mfma_f32_16x16x32_bf16 v[60:63], v[240:243], v[84:87], v[60:63]
    buffer_load_dwordx4 v136, s[4:7], s25 offen sc1 lds
    v_mul_f32 v128, v128, v127
    s_mov_b32 vcc_lo, 0x0000ffff
    v_mfma_f32_16x16x32_bf16 v[60:63], v[244:247], v[88:91], v[60:63]
    s_waitcnt lgkmcnt(2)
    s_add_u32 m0, s47, 61440
    s_mov_b32 vcc_hi, 0x0000ffff
    v_mfma_f32_16x16x32_bf16 v[28:31], a[232:235], v[92:95], v[28:31]
    s_waitcnt vmcnt(8)
    s_barrier
    ds_read_b128 v[84:87], v1 offset:20480
    v_mfma_f32_16x16x32_bf16 v[28:31], a[236:239], v[12:15], v[28:31]
    v_cndmask_b32 v128, v128, v126, vcc
    ds_write_b32 v135, v128
    v_mfma_f32_16x16x32_bf16 v[44:47], a[248:251], v[92:95], v[44:47]
    buffer_load_dwordx4 v136, s[4:7], s26 offen sc1 lds
    v_bfe_u32 v5, v1, 8, 1
    v_lshrrev_b32 v120, 9, v1
    v_mfma_f32_16x16x32_bf16 v[44:47], a[252:255], v[12:15], v[44:47]
    ds_read_b128 v[88:91], v1 offset:21504
    v_lshlrev_b32 v5, 12, v5
    v_lshl_add_u32 v5, v120, 8, v5
    v_mfma_f32_16x16x32_bf16 v[60:63], v[248:251], v[92:95], v[60:63]
    v_lshrrev_b32 v120, 1, s47
    v_add3_u32 v5, v5, v120, v140
    v_mfma_f32_16x16x32_bf16 v[60:63], v[252:255], v[12:15], v[60:63]
    s_waitcnt lgkmcnt(3)
    v_subrev_u32 v5, 16384, v5
    v_mfma_f32_16x16x32_bf16 v[28:31], a[184:187], v[76:79], v[28:31]
    ds_read_b128 v[92:95], v1 offset:22528
    v_mfma_f32_16x16x32_bf16 v[28:31], a[188:191], v[80:83], v[28:31]
    buffer_load_dword v141, v141, s[4:7], 0 offen sc1
    v_mfma_f32_16x16x32_bf16 v[44:47], v[152:155], v[76:79], v[44:47]
    v_lshrrev_b32 v142, 8, v1
    v_lshl_add_u32 v142, v142, 14, s90
    v_mfma_f32_16x16x32_bf16 v[44:47], v[156:159], v[80:83], v[44:47]
    ds_read_b128 v[12:15], v1 offset:23552
    v_min_u32 v142, M_done-interleave_layers__linear_kernel_hedgehog__mixer_channel_mlp__prompt_kernel-128, v142
    v_mfma_f32_16x16x32_bf16 v[60:63], v[200:203], v[76:79], v[60:63]
    global_load_dword v142, v142, s[88:89]
    v_mfma_f32_16x16x32_bf16 v[60:63], v[204:207], v[80:83], v[60:63]
    s_waitcnt lgkmcnt(2)
    v_mfma_f32_16x16x32_bf16 v[32:35], a[192:195], v[84:87], v[32:35]
    s_waitcnt vmcnt(9)
    s_barrier
    ds_read_b128 v[76:79], v1 offset:24576
    v_mfma_f32_16x16x32_bf16 v[32:35], a[196:199], v[88:91], v[32:35]
    ds_read_b128 v[120:123], v140
    ds_read_b128 v[124:127], v140 offset:256
    v_mfma_f32_16x16x32_bf16 v[48:51], v[160:163], v[84:87], v[48:51]
    v_mfma_f32_16x16x32_bf16 v[48:51], v[164:167], v[88:91], v[48:51]
    ds_read_b128 v[80:83], v1 offset:25600
    v_mfma_f32_16x16x32_bf16 v[64:67], v[208:211], v[84:87], v[64:67]
    v_mfma_f32_16x16x32_bf16 v[64:67], v[212:215], v[88:91], v[64:67]
    s_waitcnt lgkmcnt(4)
    v_mfma_f32_16x16x32_bf16 v[32:35], a[200:203], v[92:95], v[32:35]
    ds_read_b128 v[84:87], v1 offset:26624
    v_mfma_f32_16x16x32_bf16 v[32:35], a[204:207], v[12:15], v[32:35]
    v_mfma_f32_16x16x32_bf16 v[48:51], v[168:171], v[92:95], v[48:51]
    v_mfma_f32_16x16x32_bf16 v[48:51], v[172:175], v[12:15], v[48:51]
    ds_read_b128 v[88:91], v1 offset:27648
    s_waitcnt lgkmcnt(4)
    v_fmac_f32 v28, v96, v120
    v_fmac_f32 v29, v97, v120
    v_mfma_f32_16x16x32_bf16 v[64:67], v[216:219], v[92:95], v[64:67]
    v_fmac_f32 v30, v98, v120
    v_fmac_f32 v31, v99, v120
    v_mfma_f32_16x16x32_bf16 v[64:67], v[220:223], v[12:15], v[64:67]
    s_waitcnt lgkmcnt(2)
    v_fma_f32 v28, v28, v124, v108
    v_fma_f32 v29, v29, v124, v109
    v_mfma_f32_16x16x32_bf16 v[32:35], a[208:211], v[76:79], v[32:35]
    ds_read_b128 v[92:95], v1 offset:28672
    v_fma_f32 v30, v30, v124, v110
    v_fma_f32 v31, v31, v124, v111
    v_mfma_f32_16x16x32_bf16 v[32:35], a[212:215], v[80:83], v[32:35]
    v_mul_f32 v128, v28, v28
    v_mul_f32 v129, v29, v29
    v_mfma_f32_16x16x32_bf16 v[48:51], v[176:179], v[76:79], v[48:51]
    v_mul_f32 v130, v30, v30
    v_mul_f32 v131, v31, v31
    v_mfma_f32_16x16x32_bf16 v[48:51], v[180:183], v[80:83], v[48:51]
    ds_read_b128 v[12:15], v1 offset:29696
    v_fmaak_f32 v128, v139, v128, 0xc0135761
    v_fmaak_f32 v129, v139, v129, 0xc0135761
    v_mfma_f32_16x16x32_bf16 v[64:67], v[224:227], v[76:79], v[64:67]
    v_fmaak_f32 v130, v139, v130, 0xc0135761
    v_fmaak_f32 v131, v139, v131, 0xc0135761
    v_mfma_f32_16x16x32_bf16 v[64:67], v[228:231], v[80:83], v[64:67]
    s_waitcnt lgkmcnt(2)
    v_mul_f32 v128, v128, v28
    v_mul_f32 v129, v129, v29
    v_mfma_f32_16x16x32_bf16 v[32:35], a[216:219], v[84:87], v[32:35]
    ds_read_b128 v[76:79], v1 offset:30720
    v_mul_f32 v130, v130, v30
    v_mul_f32 v131, v131, v31
    v_mfma_f32_16x16x32_bf16 v[32:35], a[220:223], v[88:91], v[32:35]
    v_exp_f32 v128, v128
    v_mfma_f32_16x16x32_bf16 v[48:51], v[184:187], v[84:87], v[48:51]
    v_exp_f32 v129, v129
    v_mfma_f32_16x16x32_bf16 v[48:51], v[188:191], v[88:91], v[48:51]
    ds_read_b128 v[80:83], v1 offset:31744
    v_exp_f32 v130, v130
    v_mfma_f32_16x16x32_bf16 v[64:67], v[232:235], v[84:87], v[64:67]
    v_exp_f32 v131, v131
    v_mfma_f32_16x16x32_bf16 v[64:67], v[236:239], v[88:91], v[64:67]
    s_waitcnt lgkmcnt(2)
    v_add_f32 v128, 1.0, v128
    v_add_f32 v129, 1.0, v129
    v_mfma_f32_16x16x32_bf16 v[32:35], a[224:227], v[92:95], v[32:35]
    ds_read_b128 v[84:87], v1 offset:18432
    v_add_f32 v130, 1.0, v130
    v_add_f32 v131, 1.0, v131
    v_mfma_f32_16x16x32_bf16 v[32:35], a[228:231], v[12:15], v[32:35]
    v_rcp_f32 v128, v128
    v_mfma_f32_16x16x32_bf16 v[48:51], a[240:243], v[92:95], v[48:51]
    v_rcp_f32 v129, v129
    v_mfma_f32_16x16x32_bf16 v[48:51], a[244:247], v[12:15], v[48:51]
    ds_read_b128 v[88:91], v1 offset:19456
    v_rcp_f32 v130, v130
    v_mfma_f32_16x16x32_bf16 v[64:67], v[240:243], v[92:95], v[64:67]
    v_rcp_f32 v131, v131
    v_mul_f32 v28, v28, v128
    v_mul_f32 v29, v29, v129
    v_mfma_f32_16x16x32_bf16 v[64:67], v[244:247], v[12:15], v[64:67]
    s_waitcnt lgkmcnt(2)
    v_mul_f32 v30, v30, v130
    v_mul_f32 v31, v31, v131
    v_cvt_pk_bf16_f32 v28, v28, v29
    v_cvt_pk_bf16_f32 v29, v30, v31
    v_mfma_f32_16x16x32_bf16 v[32:35], a[232:235], v[76:79], v[32:35]
    s_waitcnt vmcnt(2)
    s_barrier
    ds_read_b128 v[92:95], v1 offset:36864
    v_fmac_f32 v44, v100, v120
    v_fmac_f32 v45, v101, v120
    v_mfma_f32_16x16x32_bf16 v[32:35], a[236:239], v[80:83], v[32:35]
    v_fmac_f32 v46, v102, v120
    v_fmac_f32 v47, v103, v120
    v_fma_f32 v44, v44, v124, v112
    v_fma_f32 v45, v45, v124, v113
    v_mfma_f32_16x16x32_bf16 v[48:51], a[248:251], v[76:79], v[48:51]
    v_fma_f32 v46, v46, v124, v114
    v_fma_f32 v47, v47, v124, v115
    v_mul_f32 v132, v44, v44
    v_mul_f32 v133, v45, v45
    v_mfma_f32_16x16x32_bf16 v[48:51], a[252:255], v[80:83], v[48:51]
    ds_read_b128 v[12:15], v1 offset:37888
    v_mul_f32 v134, v46, v46
    v_mul_f32 v135, v47, v47
    v_fmaak_f32 v132, v139, v132, 0xc0135761
    v_fmaak_f32 v133, v139, v133, 0xc0135761
    v_mfma_f32_16x16x32_bf16 v[64:67], v[248:251], v[76:79], v[64:67]
    v_fmaak_f32 v134, v139, v134, 0xc0135761
    v_fmaak_f32 v135, v139, v135, 0xc0135761
    v_mul_f32 v132, v132, v44
    v_mul_f32 v133, v133, v45
    v_mfma_f32_16x16x32_bf16 v[64:67], v[252:255], v[80:83], v[64:67]
    s_waitcnt lgkmcnt(2)
    v_mul_f32 v134, v134, v46
    v_mul_f32 v135, v135, v47
    v_exp_f32 v132, v132
    v_mfma_f32_16x16x32_bf16 v[32:35], a[184:187], v[84:87], v[32:35]
    ds_read_b128 v[76:79], v1 offset:38912
    v_exp_f32 v133, v133
    v_exp_f32 v134, v134
    v_mfma_f32_16x16x32_bf16 v[32:35], a[188:191], v[88:91], v[32:35]
    v_exp_f32 v135, v135
    v_add_f32 v132, 1.0, v132
    v_add_f32 v133, 1.0, v133
    v_mfma_f32_16x16x32_bf16 v[48:51], v[152:155], v[84:87], v[48:51]
    v_add_f32 v134, 1.0, v134
    v_add_f32 v135, 1.0, v135
    v_rcp_f32 v132, v132
    v_mfma_f32_16x16x32_bf16 v[48:51], v[156:159], v[88:91], v[48:51]
    ds_read_b128 v[80:83], v1 offset:39936
    v_rcp_f32 v133, v133
    v_rcp_f32 v134, v134
    v_mfma_f32_16x16x32_bf16 v[64:67], v[200:203], v[84:87], v[64:67]
    v_rcp_f32 v135, v135
    v_mul_f32 v44, v44, v132
    v_mul_f32 v45, v45, v133
    v_mfma_f32_16x16x32_bf16 v[64:67], v[204:207], v[88:91], v[64:67]
    s_waitcnt lgkmcnt(2)
    v_mul_f32 v46, v46, v134
    v_mul_f32 v47, v47, v135
    v_cvt_pk_bf16_f32 v44, v44, v45
    v_cvt_pk_bf16_f32 v45, v46, v47
    v_mfma_f32_16x16x32_bf16 v[36:39], a[192:195], v[92:95], v[36:39]
    ds_read_b128 v[84:87], v1 offset:40960
    v_fmac_f32 v60, v104, v120
    v_fmac_f32 v61, v105, v120
    v_fmac_f32 v62, v106, v120
    v_fmac_f32 v63, v107, v120
    v_mfma_f32_16x16x32_bf16 v[36:39], a[196:199], v[12:15], v[36:39]
    v_fma_f32 v60, v60, v124, v116
    v_fma_f32 v61, v61, v124, v117
    v_fma_f32 v62, v62, v124, v118
    v_fma_f32 v63, v63, v124, v119
    v_mfma_f32_16x16x32_bf16 v[52:55], v[160:163], v[92:95], v[52:55]
    v_mul_f32 v128, v60, v60
    v_mul_f32 v129, v61, v61
    v_mul_f32 v130, v62, v62
    v_mul_f32 v131, v63, v63
    v_mfma_f32_16x16x32_bf16 v[52:55], v[164:167], v[12:15], v[52:55]
    ds_read_b128 v[88:91], v1 offset:41984
    v_fmaak_f32 v128, v139, v128, 0xc0135761
    v_fmaak_f32 v129, v139, v129, 0xc0135761
    v_fmaak_f32 v130, v139, v130, 0xc0135761
    v_fmaak_f32 v131, v139, v131, 0xc0135761
    v_mfma_f32_16x16x32_bf16 v[68:71], v[208:211], v[92:95], v[68:71]
    v_mul_f32 v128, v128, v60
    v_mul_f32 v129, v129, v61
    v_mul_f32 v130, v130, v62
    v_mul_f32 v131, v131, v63
    v_mfma_f32_16x16x32_bf16 v[68:71], v[212:215], v[12:15], v[68:71]
    s_waitcnt lgkmcnt(2)
    v_exp_f32 v128, v128
    v_exp_f32 v129, v129
    v_mfma_f32_16x16x32_bf16 v[36:39], a[200:203], v[76:79], v[36:39]
    ds_read_b128 v[92:95], v1 offset:43008
    v_exp_f32 v130, v130
    v_exp_f32 v131, v131
    v_mfma_f32_16x16x32_bf16 v[36:39], a[204:207], v[80:83], v[36:39]
    v_add_f32 v128, 1.0, v128
    v_add_f32 v129, 1.0, v129
    v_add_f32 v130, 1.0, v130
    v_add_f32 v131, 1.0, v131
    v_mfma_f32_16x16x32_bf16 v[52:55], v[168:171], v[76:79], v[52:55]
    v_rcp_f32 v128, v128
    v_rcp_f32 v129, v129
    v_mfma_f32_16x16x32_bf16 v[52:55], v[172:175], v[80:83], v[52:55]
    ds_read_b128 v[12:15], v1 offset:44032
    v_rcp_f32 v130, v130
    v_rcp_f32 v131, v131
    v_mfma_f32_16x16x32_bf16 v[68:71], v[216:219], v[76:79], v[68:71]
    v_mul_f32 v60, v60, v128
    v_mul_f32 v61, v61, v129
    v_mul_f32 v62, v62, v130
    v_mul_f32 v63, v63, v131
    v_mfma_f32_16x16x32_bf16 v[68:71], v[220:223], v[80:83], v[68:71]
    s_waitcnt lgkmcnt(2)
    v_cvt_pk_bf16_f32 v60, v60, v61
    v_cvt_pk_bf16_f32 v61, v62, v63
    v_fmac_f32 v32, v96, v121
    v_fmac_f32 v33, v97, v121
    v_mfma_f32_16x16x32_bf16 v[36:39], a[208:211], v[84:87], v[36:39]
    ds_read_b128 v[76:79], v1 offset:45056
    v_fmac_f32 v34, v98, v121
    v_fmac_f32 v35, v99, v121
    v_fma_f32 v32, v32, v125, v108
    v_fma_f32 v33, v33, v125, v109
    v_mfma_f32_16x16x32_bf16 v[36:39], a[212:215], v[88:91], v[36:39]
    v_fma_f32 v34, v34, v125, v110
    v_fma_f32 v35, v35, v125, v111
    v_mul_f32 v132, v32, v32
    v_mul_f32 v133, v33, v33
    v_mfma_f32_16x16x32_bf16 v[52:55], v[176:179], v[84:87], v[52:55]
    v_mul_f32 v134, v34, v34
    v_mul_f32 v135, v35, v35
    v_fmaak_f32 v132, v139, v132, 0xc0135761
    v_fmaak_f32 v133, v139, v133, 0xc0135761
    v_mfma_f32_16x16x32_bf16 v[52:55], v[180:183], v[88:91], v[52:55]
    ds_read_b128 v[80:83], v1 offset:46080
    v_fmaak_f32 v134, v139, v134, 0xc0135761
    v_fmaak_f32 v135, v139, v135, 0xc0135761
    v_mul_f32 v132, v132, v32
    v_mul_f32 v133, v133, v33
    v_mfma_f32_16x16x32_bf16 v[68:71], v[224:227], v[84:87], v[68:71]
    v_mul_f32 v134, v134, v34
    v_mul_f32 v135, v135, v35
    v_exp_f32 v132, v132
    v_mfma_f32_16x16x32_bf16 v[68:71], v[228:231], v[88:91], v[68:71]
    s_waitcnt lgkmcnt(2)
    v_exp_f32 v133, v133
    v_exp_f32 v134, v134
    v_mfma_f32_16x16x32_bf16 v[36:39], a[216:219], v[92:95], v[36:39]
    ds_read_b128 v[84:87], v1 offset:47104
    v_exp_f32 v135, v135
    v_add_f32 v132, 1.0, v132
    v_add_f32 v133, 1.0, v133
    v_mfma_f32_16x16x32_bf16 v[36:39], a[220:223], v[12:15], v[36:39]
    v_add_f32 v134, 1.0, v134
    v_add_f32 v135, 1.0, v135
    v_rcp_f32 v132, v132
    v_mfma_f32_16x16x32_bf16 v[52:55], v[184:187], v[92:95], v[52:55]
    v_rcp_f32 v133, v133
    v_rcp_f32 v134, v134
    v_mfma_f32_16x16x32_bf16 v[52:55], v[188:191], v[12:15], v[52:55]
    ds_read_b128 v[88:91], v1 offset:48128
    v_rcp_f32 v135, v135
    v_mul_f32 v32, v32, v132
    v_mul_f32 v33, v33, v133
    v_mfma_f32_16x16x32_bf16 v[68:71], v[232:235], v[92:95], v[68:71]
    v_mul_f32 v34, v34, v134
    v_mul_f32 v35, v35, v135
    v_cvt_pk_bf16_f32 v30, v32, v33
    v_cvt_pk_bf16_f32 v31, v34, v35
    v_mfma_f32_16x16x32_bf16 v[68:71], v[236:239], v[12:15], v[68:71]
    s_waitcnt lgkmcnt(2)
    v_permlane16_swap_b32 v28, v30
    v_permlane16_swap_b32 v29, v31
    v_mfma_f32_16x16x32_bf16 v[36:39], a[224:227], v[76:79], v[36:39]
    ds_read_b128 v[92:95], v1 offset:34816
    v_mfma_f32_16x16x32_bf16 v[36:39], a[228:231], v[80:83], v[36:39]
    buffer_store_dwordx4 v[28:31], v137, s[4:7], 0 offen
    v_mfma_f32_16x16x32_bf16 v[52:55], a[240:243], v[76:79], v[52:55]
    ds_write_b128 v5, v[28:31] offset:0
    v_mfma_f32_16x16x32_bf16 v[52:55], a[244:247], v[80:83], v[52:55]
    ds_read_b128 v[12:15], v1 offset:35840
    v_fmac_f32 v48, v100, v121
    v_fmac_f32 v49, v101, v121
    v_fmac_f32 v50, v102, v121
    v_fmac_f32 v51, v103, v121
    v_mfma_f32_16x16x32_bf16 v[68:71], v[240:243], v[76:79], v[68:71]
    v_fma_f32 v48, v48, v125, v112
    v_fma_f32 v49, v49, v125, v113
    v_fma_f32 v50, v50, v125, v114
    v_fma_f32 v51, v51, v125, v115
    v_mfma_f32_16x16x32_bf16 v[68:71], v[244:247], v[80:83], v[68:71]
    s_waitcnt lgkmcnt(3)
    v_mul_f32 v128, v48, v48
    v_mul_f32 v129, v49, v49
    v_mul_f32 v130, v50, v50
    v_mul_f32 v131, v51, v51
    v_mfma_f32_16x16x32_bf16 v[36:39], a[232:235], v[84:87], v[36:39]
    ds_read_b128 v[76:79], v1 offset:53248
    v_fmaak_f32 v128, v139, v128, 0xc0135761
    v_fmaak_f32 v129, v139, v129, 0xc0135761
    v_fmaak_f32 v130, v139, v130, 0xc0135761
    v_fmaak_f32 v131, v139, v131, 0xc0135761
    v_mfma_f32_16x16x32_bf16 v[36:39], a[236:239], v[88:91], v[36:39]
    v_mul_f32 v128, v128, v48
    v_mul_f32 v129, v129, v49
    v_mul_f32 v130, v130, v50
    v_mul_f32 v131, v131, v51
    v_mfma_f32_16x16x32_bf16 v[52:55], a[248:251], v[84:87], v[52:55]
    v_exp_f32 v128, v128
    v_exp_f32 v129, v129
    v_mfma_f32_16x16x32_bf16 v[52:55], a[252:255], v[88:91], v[52:55]
    ds_read_b128 v[80:83], v1 offset:54272
    v_exp_f32 v130, v130
    v_exp_f32 v131, v131
    v_mfma_f32_16x16x32_bf16 v[68:71], v[248:251], v[84:87], v[68:71]
    v_add_f32 v128, 1.0, v128
    v_add_f32 v129, 1.0, v129
    v_add_f32 v130, 1.0, v130
    v_add_f32 v131, 1.0, v131
    v_mfma_f32_16x16x32_bf16 v[68:71], v[252:255], v[88:91], v[68:71]
    s_waitcnt lgkmcnt(2)
    v_rcp_f32 v128, v128
    v_rcp_f32 v129, v129
    v_mfma_f32_16x16x32_bf16 v[36:39], a[184:187], v[92:95], v[36:39]
    ds_read_b128 v[84:87], v1 offset:55296
    v_rcp_f32 v130, v130
    v_rcp_f32 v131, v131
    v_mfma_f32_16x16x32_bf16 v[36:39], a[188:191], v[12:15], v[36:39]
    v_mul_f32 v48, v48, v128
    v_mul_f32 v49, v49, v129
    v_mul_f32 v50, v50, v130
    v_mul_f32 v51, v51, v131
    v_mfma_f32_16x16x32_bf16 v[52:55], v[152:155], v[92:95], v[52:55]
    v_cvt_pk_bf16_f32 v46, v48, v49
    v_cvt_pk_bf16_f32 v47, v50, v51
    s_nop 0
    v_permlane16_swap_b32 v44, v46
    v_mfma_f32_16x16x32_bf16 v[52:55], v[156:159], v[12:15], v[52:55]
    ds_read_b128 v[88:91], v1 offset:56320
    v_permlane16_swap_b32 v45, v47
    v_mfma_f32_16x16x32_bf16 v[68:71], v[200:203], v[92:95], v[68:71]
    buffer_store_dwordx4 v[44:47], v137, s[4:7], s51 offen
    v_mfma_f32_16x16x32_bf16 v[68:71], v[204:207], v[12:15], v[68:71]
    s_waitcnt lgkmcnt(2)
    ds_write_b128 v5, v[44:47] offset:2048
    v_mfma_f32_16x16x32_bf16 v[40:43], a[192:195], v[76:79], v[40:43]
    ds_read_b128 v[92:95], v1 offset:57344
    v_fmac_f32 v64, v104, v121
    v_fmac_f32 v65, v105, v121
    v_fmac_f32 v66, v106, v121
    v_fmac_f32 v67, v107, v121
    v_mfma_f32_16x16x32_bf16 v[40:43], a[196:199], v[80:83], v[40:43]
    v_fma_f32 v64, v64, v125, v116
    v_fma_f32 v65, v65, v125, v117
    v_fma_f32 v66, v66, v125, v118
    v_fma_f32 v67, v67, v125, v119
    v_mfma_f32_16x16x32_bf16 v[56:59], v[160:163], v[76:79], v[56:59]
    v_mul_f32 v132, v64, v64
    v_mul_f32 v133, v65, v65
    v_mul_f32 v134, v66, v66
    v_mul_f32 v135, v67, v67
    v_mfma_f32_16x16x32_bf16 v[56:59], v[164:167], v[80:83], v[56:59]
    ds_read_b128 v[12:15], v1 offset:58368
    v_fmaak_f32 v132, v139, v132, 0xc0135761
    v_fmaak_f32 v133, v139, v133, 0xc0135761
    v_fmaak_f32 v134, v139, v134, 0xc0135761
    v_fmaak_f32 v135, v139, v135, 0xc0135761
    v_mfma_f32_16x16x32_bf16 v[72:75], v[208:211], v[76:79], v[72:75]
    v_mul_f32 v132, v132, v64
    v_mul_f32 v133, v133, v65
    v_mfma_f32_16x16x32_bf16 v[72:75], v[212:215], v[80:83], v[72:75]
    s_waitcnt lgkmcnt(3)
    v_mul_f32 v134, v134, v66
    v_mul_f32 v135, v135, v67
    v_mfma_f32_16x16x32_bf16 v[40:43], a[200:203], v[84:87], v[40:43]
    ds_read_b128 v[76:79], v1 offset:59392
    v_exp_f32 v132, v132
    v_mfma_f32_16x16x32_bf16 v[40:43], a[204:207], v[88:91], v[40:43]
    v_exp_f32 v133, v133
    v_mfma_f32_16x16x32_bf16 v[56:59], v[168:171], v[84:87], v[56:59]
    v_exp_f32 v134, v134
    v_mfma_f32_16x16x32_bf16 v[56:59], v[172:175], v[88:91], v[56:59]
    ds_read_b128 v[80:83], v1 offset:60416
    v_exp_f32 v135, v135
    v_mfma_f32_16x16x32_bf16 v[72:75], v[216:219], v[84:87], v[72:75]
    v_add_f32 v132, 1.0, v132
    v_add_f32 v133, 1.0, v133
    v_mfma_f32_16x16x32_bf16 v[72:75], v[220:223], v[88:91], v[72:75]
    s_waitcnt lgkmcnt(2)
    v_add_f32 v134, 1.0, v134
    v_add_f32 v135, 1.0, v135
    v_mfma_f32_16x16x32_bf16 v[40:43], a[208:211], v[92:95], v[40:43]
    ds_read_b128 v[84:87], v1 offset:61440
    v_rcp_f32 v132, v132
    v_mfma_f32_16x16x32_bf16 v[40:43], a[212:215], v[12:15], v[40:43]
    ds_read_b128 v[8:11], v143 offset:0
    v_rcp_f32 v133, v133
    v_mfma_f32_16x16x32_bf16 v[56:59], v[176:179], v[92:95], v[56:59]
    v_rcp_f32 v134, v134
    v_mfma_f32_16x16x32_bf16 v[56:59], v[180:183], v[12:15], v[56:59]
    ds_read_b128 v[88:91], v1 offset:62464
    v_rcp_f32 v135, v135
    v_mfma_f32_16x16x32_bf16 v[72:75], v[224:227], v[92:95], v[72:75]
    v_mul_f32 v64, v64, v132
    v_mul_f32 v65, v65, v133
    v_mfma_f32_16x16x32_bf16 v[72:75], v[228:231], v[12:15], v[72:75]
    s_waitcnt lgkmcnt(3)
    v_mul_f32 v66, v66, v134
    v_mul_f32 v67, v67, v135
    v_mfma_f32_16x16x32_bf16 v[40:43], a[216:219], v[76:79], v[40:43]
    ds_read_b128 v[92:95], v1 offset:63488
    v_cvt_pk_bf16_f32 v62, v64, v65
    v_cvt_pk_bf16_f32 v63, v66, v67
    v_mfma_f32_16x16x32_bf16 v[40:43], a[220:223], v[80:83], v[40:43]
    v_permlane16_swap_b32 v60, v62
    v_mfma_f32_16x16x32_bf16 v[56:59], v[184:187], v[76:79], v[56:59]
    v_permlane16_swap_b32 v61, v63
    v_mfma_f32_16x16x32_bf16 v[56:59], v[188:191], v[80:83], v[56:59]
    ds_read_b128 v[12:15], v1 offset:64512
    v_mfma_f32_16x16x32_bf16 v[72:75], v[232:235], v[76:79], v[72:75]
    buffer_store_dwordx4 v[60:63], v138, s[4:7], s55 offen
    v_mfma_f32_16x16x32_bf16 v[72:75], v[236:239], v[80:83], v[72:75]
    s_waitcnt lgkmcnt(2)
    v_fmac_f32 v36, v96, v122
    v_fmac_f32 v37, v97, v122
    v_mfma_f32_16x16x32_bf16 v[40:43], a[224:227], v[84:87], v[40:43]
    ds_read_b128 v[76:79], v1 offset:51200
    v_fmac_f32 v38, v98, v122
    v_fmac_f32 v39, v99, v122
    v_mfma_f32_16x16x32_bf16 v[40:43], a[228:231], v[88:91], v[40:43]
    v_fma_f32 v36, v36, v126, v108
    v_fma_f32 v37, v37, v126, v109
    v_mfma_f32_16x16x32_bf16 v[56:59], a[240:243], v[84:87], v[56:59]
    v_fma_f32 v38, v38, v126, v110
    v_fma_f32 v39, v39, v126, v111
    v_mfma_f32_16x16x32_bf16 v[56:59], a[244:247], v[88:91], v[56:59]
    ds_read_b128 v[80:83], v1 offset:52224
    v_mul_f32 v128, v36, v36
    v_mul_f32 v129, v37, v37
    v_mfma_f32_16x16x32_bf16 v[72:75], v[240:243], v[84:87], v[72:75]
    v_mul_f32 v130, v38, v38
    v_mul_f32 v131, v39, v39
    v_mfma_f32_16x16x32_bf16 v[72:75], v[244:247], v[88:91], v[72:75]
    s_waitcnt lgkmcnt(2)
    v_fmaak_f32 v128, v139, v128, 0xc0135761
    v_fmaak_f32 v129, v139, v129, 0xc0135761
    v_mfma_f32_16x16x32_bf16 v[40:43], a[232:235], v[92:95], v[40:43]
    v_fmaak_f32 v130, v139, v130, 0xc0135761
    v_fmaak_f32 v131, v139, v131, 0xc0135761
    v_mfma_f32_16x16x32_bf16 v[40:43], a[236:239], v[12:15], v[40:43]
    v_mul_f32 v128, v128, v36
    v_mul_f32 v129, v129, v37
    v_mfma_f32_16x16x32_bf16 v[56:59], a[248:251], v[92:95], v[56:59]
    v_mul_f32 v130, v130, v38
    v_mul_f32 v131, v131, v39
    v_mfma_f32_16x16x32_bf16 v[56:59], a[252:255], v[12:15], v[56:59]
    v_exp_f32 v128, v128
    v_mfma_f32_16x16x32_bf16 v[72:75], v[248:251], v[92:95], v[72:75]
    v_exp_f32 v129, v129
    v_mfma_f32_16x16x32_bf16 v[72:75], v[252:255], v[12:15], v[72:75]
    s_waitcnt lgkmcnt(0)
    v_exp_f32 v130, v130
    v_mfma_f32_16x16x32_bf16 v[40:43], a[184:187], v[76:79], v[40:43]
    ds_read_b128 v[12:15], v143 offset:4096
    v_exp_f32 v131, v131
    v_mfma_f32_16x16x32_bf16 v[40:43], a[188:191], v[80:83], v[40:43]
    v_add_f32 v128, 1.0, v128
    v_add_f32 v129, 1.0, v129
    v_mfma_f32_16x16x32_bf16 v[56:59], v[152:155], v[76:79], v[56:59]
    v_add_u32 v6, s45, 8
    s_cmp_eq_u32 s46, 0
    s_mov_b64 exec, s[72:73]
    s_waitcnt vmcnt(0)
    s_cbranch_scc1 L28s
    buffer_store_dword v6, v3, s[4:7], 0 offen
L28:
    s_mov_b64 exec, -1
    v_mfma_f32_16x16x32_bf16 v[56:59], v[156:159], v[80:83], v[56:59]
    v_add_f32 v130, 1.0, v130
    v_add_f32 v131, 1.0, v131
    v_mfma_f32_16x16x32_bf16 v[72:75], v[200:203], v[76:79], v[72:75]
    v_rcp_f32 v128, v128
    v_mfma_f32_16x16x32_bf16 v[72:75], v[204:207], v[80:83], v[72:75]
    v_rcp_f32 v129, v129
    v_add_u32 v93, s99, v1
    v_add_u32 v92, s101, v1
    v_rcp_f32 v130, v130
    v_rcp_f32 v131, v131
    v_mul_f32 v36, v36, v128
    v_mul_f32 v37, v37, v129
    v_mul_f32 v38, v38, v130
    v_mul_f32 v39, v39, v131
    v_cvt_pk_bf16_f32 v36, v36, v37
    v_cvt_pk_bf16_f32 v37, v38, v39
    v_pk_fma_f32 v[40:41], v[96:97], v[122:123], v[40:41] op_sel:[0,1,0] op_sel_hi:[1,1,1]
    v_pk_fma_f32 v[42:43], v[98:99], v[122:123], v[42:43] op_sel:[0,1,0] op_sel_hi:[1,1,1]
    v_pk_fma_f32 v[40:41], v[40:41], v[126:127], v[108:109] op_sel:[0,1,0] op_sel_hi:[1,1,1]
    v_pk_fma_f32 v[42:43], v[42:43], v[126:127], v[110:111] op_sel:[0,1,0] op_sel_hi:[1,1,1]
    v_pk_mul_f32 v[132:133], v[40:41], v[40:41]
    v_pk_mul_f32 v[134:135], v[42:43], v[42:43]
    v_pk_fma_f32 v[132:133], v[132:133], s[74:75], s[74:75] op_sel:[0,0,1] op_sel_hi:[1,0,1]
    v_pk_fma_f32 v[134:135], v[134:135], s[74:75], s[74:75] op_sel:[0,0,1] op_sel_hi:[1,0,1]
    v_pk_mul_f32 v[132:133], v[132:133], v[40:41]
    v_pk_mul_f32 v[134:135], v[134:135], v[42:43]
    v_exp_f32 v132, v132
    v_exp_f32 v133, v133
    v_exp_f32 v134, v134
    v_exp_f32 v135, v135
    v_pk_add_f32 v[132:133], v[132:133], 1.0 op_sel_hi:[1,0]
    v_pk_add_f32 v[134:135], v[134:135], 1.0 op_sel_hi:[1,0]
    v_rcp_f32 v132, v132
    v_rcp_f32 v133, v133
    v_rcp_f32 v134, v134
    v_rcp_f32_e64 v135, v135
    v_pk_mul_f32 v[40:41], v[40:41], v[132:133]
    v_pk_mul_f32 v[42:43], v[42:43], v[134:135]
    v_cvt_pk_bf16_f32 v38, v40, v41
    v_cvt_pk_bf16_f32 v39, v42, v43
    s_nop 0
    v_permlane16_swap_b32 v36, v38
    v_permlane16_swap_b32 v37, v39
    v_add_u32 v137, 88064, v137
    buffer_store_dwordx4 v[36:39], v137, s[4:7], 0 offen
    buffer_load_dword v94, v3, s[4:7], 0 offen sc1
    ds_write_b128 v5, v[36:39] offset:22528
    v_pk_fma_f32 v[52:53], v[100:101], v[122:123], v[52:53] op_sel:[0,0,0] op_sel_hi:[1,0,1]
    v_pk_fma_f32 v[54:55], v[102:103], v[122:123], v[54:55] op_sel:[0,0,0] op_sel_hi:[1,0,1]
    v_pk_fma_f32 v[56:57], v[100:101], v[122:123], v[56:57] op_sel:[0,1,0] op_sel_hi:[1,1,1]
    v_pk_fma_f32 v[58:59], v[102:103], v[122:123], v[58:59] op_sel:[0,1,0] op_sel_hi:[1,1,1]
    v_pk_fma_f32 v[52:53], v[52:53], v[126:127], v[112:113] op_sel:[0,0,0] op_sel_hi:[1,0,1]
    v_pk_fma_f32 v[54:55], v[54:55], v[126:127], v[114:115] op_sel:[0,0,0] op_sel_hi:[1,0,1]
    v_pk_fma_f32 v[56:57], v[56:57], v[126:127], v[112:113] op_sel:[0,1,0] op_sel_hi:[1,1,1]
    v_pk_fma_f32 v[58:59], v[58:59], v[126:127], v[114:115] op_sel:[0,1,0] op_sel_hi:[1,1,1]
    v_pk_mul_f32 v[128:129], v[52:53], v[52:53]
    v_pk_mul_f32 v[130:131], v[54:55], v[54:55]
    v_pk_mul_f32 v[132:133], v[56:57], v[56:57]
    v_pk_mul_f32 v[134:135], v[58:59], v[58:59]
    v_pk_fma_f32 v[128:129], v[128:129], s[74:75], s[74:75] op_sel:[0,0,1] op_sel_hi:[1,0,1]
    v_pk_fma_f32 v[130:131], v[130:131], s[74:75], s[74:75] op_sel:[0,0,1] op_sel_hi:[1,0,1]
    v_pk_fma_f32 v[132:133], v[132:133], s[74:75], s[74:75] op_sel:[0,0,1] op_sel_hi:[1,0,1]
    v_pk_fma_f32 v[134:135], v[134:135], s[74:75], s[74:75] op_sel:[0,0,1] op_sel_hi:[1,0,1]
    v_pk_mul_f32 v[128:129], v[128:129], v[52:53]
    v_pk_mul_f32 v[130:131], v[130:131], v[54:55]
    v_pk_mul_f32 v[132:133], v[132:133], v[56:57]
    v_pk_mul_f32 v[134:135], v[134:135], v[58:59]
    v_exp_f32 v128, v128
    v_exp_f32 v129, v129
    v_exp_f32 v130, v130
    v_exp_f32 v131, v131
    v_exp_f32 v132, v132
    v_exp_f32 v133, v133
    v_exp_f32 v134, v134
    v_exp_f32 v135, v135
    v_pk_add_f32 v[128:129], v[128:129], 1.0 op_sel_hi:[1,0]
    v_pk_add_f32 v[130:131], v[130:131], 1.0 op_sel_hi:[1,0]
    v_pk_add_f32 v[132:133], v[132:133], 1.0 op_sel_hi:[1,0]
    v_pk_add_f32 v[134:135], v[134:135], 1.0 op_sel_hi:[1,0]
    v_rcp_f32 v128, v128
    v_rcp_f32 v129, v129
    v_rcp_f32 v130, v130
    v_rcp_f32 v131, v131
    v_rcp_f32 v132, v132
    v_rcp_f32 v133, v133
    v_rcp_f32 v134, v134
    s_add_u32 s82, s1, 8
    s_waitcnt vmcnt(0)
    v_subrev_u32 v94, s82, v94
    v_cmp_lt_u32 s[82:83], 7, v94
    v_rcp_f32 v135, v135
    v_pk_mul_f32 v[52:53], v[52:53], v[128:129]
    v_pk_mul_f32 v[54:55], v[54:55], v[130:131]
    v_pk_mul_f32 v[56:57], v[56:57], v[132:133]
    s_cmp_lg_u64 s[82:83], 0
    s_cbranch_scc1 L29s
L29:
    s_andn2_b32 s34, 2, s28
    s_lshl_b32 s34, s34, 11
    s_add_u32 s34, s34, s47
    s_add_u32 s34, s34, 131072
    v_add_u32 v7, s34, v1
    ds_read_b128 v[192:195], v7 offset:0
    buffer_load_dwordx4 v[196:199], v92, s[4:7], s59 offen sc1
    v_pk_mul_f32 v[58:59], v[58:59], v[134:135]
    v_cvt_pk_bf16_f32 v52, v52, v53
    v_cvt_pk_bf16_f32 v53, v54, v55
    v_cvt_pk_bf16_f32 v54, v56, v57
    v_cvt_pk_bf16_f32 v55, v58, v59
    s_nop 0
    v_permlane16_swap_b32 v52, v54
    v_permlane16_swap_b32 v53, v55
    buffer_store_dwordx4 v[52:55], v137, s[4:7], s51 offen
    ds_write_b128 v5, v[52:55] offset:24576
    buffer_load_dwordx4 v[200:203], v92, s[4:7], s59 offen offset:1024 sc1
    v_pk_fma_f32 v[68:69], v[104:105], v[122:123], v[68:69] op_sel:[0,0,0] op_sel_hi:[1,0,1]
    v_pk_fma_f32 v[70:71], v[106:107], v[122:123], v[70:71] op_sel:[0,0,0] op_sel_hi:[1,0,1]
    v_pk_fma_f32 v[72:73], v[104:105], v[122:123], v[72:73] op_sel:[0,1,0] op_sel_hi:[1,1,1]
    v_pk_fma_f32 v[74:75], v[106:107], v[122:123], v[74:75] op_sel:[0,1,0] op_sel_hi:[1,1,1]
    v_pk_fma_f32 v[68:69], v[68:69], v[126:127], v[116:117] op_sel:[0,0,0] op_sel_hi:[1,0,1]
    v_pk_fma_f32 v[70:71], v[70:71], v[126:127], v[118:119] op_sel:[0,0,0] op_sel_hi:[1,0,1]
    v_pk_fma_f32 v[72:73], v[72:73], v[126:127], v[116:117] op_sel:[0,1,0] op_sel_hi:[1,1,1]
    v_pk_fma_f32 v[74:75], v[74:75], v[126:127], v[118:119] op_sel:[0,1,0] op_sel_hi:[1,1,1]
    v_pk_mul_f32 v[128:129], v[68:69], v[68:69]
    v_pk_mul_f32 v[130:131], v[70:71], v[70:71]
    v_pk_mul_f32 v[132:133], v[72:73], v[72:73]
    v_pk_mul_f32 v[134:135], v[74:75], v[74:75]
    v_pk_fma_f32 v[128:129], v[128:129], s[74:75], s[74:75] op_sel:[0,0,1] op_sel_hi:[1,0,1]
    v_pk_fma_f32 v[130:131], v[130:131], s[74:75], s[74:75] op_sel:[0,0,1] op_sel_hi:[1,0,1]
    v_pk_fma_f32 v[132:133], v[132:133], s[74:75], s[74:75] op_sel:[0,0,1] op_sel_hi:[1,0,1]
    v_pk_fma_f32 v[134:135], v[134:135], s[74:75], s[74:75] op_sel:[0,0,1] op_sel_hi:[1,0,1]
    v_pk_mul_f32 v[128:129], v[128:129], v[68:69]
    v_pk_mul_f32 v[130:131], v[130:131], v[70:71]
    buffer_load_dwordx4 v[204:207], v92, s[4:7], s60 offen sc1
    v_pk_mul_f32 v[132:133], v[132:133], v[72:73]
    v_pk_mul_f32 v[134:135], v[134:135], v[74:75]
    v_exp_f32 v128, v128
    v_exp_f32 v129, v129
    v_exp_f32 v130, v130
    v_exp_f32 v131, v131
    v_exp_f32 v132, v132
    v_exp_f32 v133, v133
    v_exp_f32 v134, v134
    v_exp_f32 v135, v135
    v_pk_add_f32 v[128:129], v[128:129], 1.0 op_sel_hi:[1,0]
    buffer_load_dwordx4 v[208:211], v92, s[4:7], s60 offen offset:1024 sc1
    v_pk_add_f32 v[130:131], v[130:131], 1.0 op_sel_hi:[1,0]
    v_pk_add_f32 v[132:133], v[132:133], 1.0 op_sel_hi:[1,0]
    v_pk_add_f32 v[134:135], v[134:135], 1.0 op_sel_hi:[1,0]
    v_rcp_f32 v128, v128
    v_rcp_f32 v129, v129
    v_rcp_f32 v130, v130
    v_rcp_f32 v131, v131
    v_rcp_f32 v132, v132
    v_rcp_f32 v133, v133
    v_rcp_f32 v134, v134
    v_rcp_f32 v135, v135
    buffer_load_dwordx4 v[212:215], v92, s[4:7], s61 offen sc1
    v_pk_mul_f32 v[68:69], v[68:69], v[128:129]
    v_pk_mul_f32 v[70:71], v[70:71], v[130:131]
    v_pk_mul_f32 v[72:73], v[72:73], v[132:133]
    v_pk_mul_f32 v[74:75], v[74:75], v[134:135]
    v_cvt_pk_bf16_f32 v68, v68, v69
    v_cvt_pk_bf16_f32 v69, v70, v71
    v_cvt_pk_bf16_f32 v70, v72, v73
    v_cvt_pk_bf16_f32 v71, v74, v75
    s_nop 0
    v_permlane16_swap_b32 v68, v70
    v_permlane16_swap_b32 v69, v71
    v_add_u32 v138, 88064, v138
    buffer_store_dwordx4 v[68:71], v138, s[4:7], s55 offen
    buffer_load_dwordx4 v[216:219], v92, s[4:7], s61 offen offset:1024 sc1
    buffer_load_dwordx4 v[220:223], v92, s[4:7], s62 offen sc1
    s_waitcnt lgkmcnt(1)
    v_mfma_f32_16x16x32_bf16 v[28:31], a[0:3], v[192:195], 0
    buffer_load_dwordx4 v[224:227], v92, s[4:7], s62 offen offset:1024 sc1
    s_waitcnt vmcnt(9)
    v_mfma_f32_16x16x32_bf16 v[28:31], a[16:19], v[196:199], v[28:31]
    ds_read_b128 v[60:63], v0 offset:576
    v_add_u32 v142, 88064, v92
    v_add_u32 v143, 88064, v93
    v_mfma_f32_16x16x32_bf16 v[32:35], a[4:7], v[192:195], 0
    v_lshl_add_u32 v139, s47, 3, v1
    v_xor_b32 v136, 24576, v139
    v_mfma_f32_16x16x32_bf16 v[32:35], a[20:23], v[196:199], v[32:35]
    v_xor_b32 v137, 16384, v139
    v_xor_b32 v138, 8192, v139
    v_mfma_f32_16x16x32_bf16 v[36:39], a[8:11], v[192:195], 0
    buffer_load_dwordx4 v[228:231], v92, s[4:7], s2 offen sc1
    v_mfma_f32_16x16x32_bf16 v[36:39], a[24:27], v[196:199], v[36:39]
    s_and_b32 s34, s100, 0x3c00
    s_lshr_b32 s34, s34, 4
    s_and_b32 s35, s100, 0x4000
    v_mfma_f32_16x16x32_bf16 v[40:43], a[12:15], v[192:195], 0
    s_add_u32 s34, s34, s35
    s_add_u32 s34, s34, s44
    v_bfe_u32 v140, v1, 4, 4
    v_mfma_f32_16x16x32_bf16 v[40:43], a[28:31], v[196:199], v[40:43]
    s_waitcnt vmcnt(7)
    v_lshrrev_b32 v5, 8, v1
    v_lshlrev_b32 v5, 4, v5
    v_mfma_f32_16x16x32_bf16 v[28:31], a[32:35], v[200:203], v[28:31]
    buffer_load_dwordx4 v[232:235], v92, s[4:7], s39 offen sc1
    v_mfma_f32_16x16x32_bf16 v[28:31], a[48:51], v[204:207], v[28:31]
    v_xor_b32 v7, 4096, v7
    ds_read_b128 v[236:239], v7 offset:0
    v_mfma_f32_16x16x32_bf16 v[32:35], a[36:39], v[200:203], v[32:35]
    v_lshl_add_u32 v140, v140, 10, v5
    v_add_u32 v140, s34, v140
    v_mfma_f32_16x16x32_bf16 v[32:35], a[52:55], v[204:207], v[32:35]
    v_lshlrev_b32 v52, 16, v8
    v_and_b32 v53, s41, v8
    v_mfma_f32_16x16x32_bf16 v[36:39], a[40:43], v[200:203], v[36:39]
    buffer_load_dwordx4 v[240:243], v93, s[4:7], s59 offen sc1
    v_mfma_f32_16x16x32_bf16 v[36:39], a[56:59], v[204:207], v[36:39]
    s_waitcnt lgkmcnt(1)
    v_lshlrev_b32 v5, 16, v60
    v_and_b32 v95, s41, v60
    v_mfma_f32_16x16x32_bf16 v[40:43], a[44:47], v[200:203], v[40:43]
    v_add_f32 v52, v52, v5
    v_add_f32 v53, v53, v95
    v_mfma_f32_16x16x32_bf16 v[40:43], a[60:63], v[204:207], v[40:43]
    s_waitcnt vmcnt(7)
    v_lshlrev_b32 v54, 16, v9
    v_and_b32 v55, s41, v9
    v_mfma_f32_16x16x32_bf16 v[28:31], a[64:67], v[208:211], v[28:31]
    buffer_load_dwordx4 v[244:247], v93, s[4:7], s59 offen offset:1024 sc1
    v_mfma_f32_16x16x32_bf16 v[28:31], a[80:83], v[212:215], v[28:31]
    v_add_u32 v6, s45, 9
    s_cmp_eq_u32 s46, 0
    s_mov_b64 exec, s[72:73]
    s_waitcnt vmcnt(7)
    s_cbranch_scc1 L30s
    buffer_store_dword v6, v3, s[4:7], 0 offen
L30:
    s_mov_b64 exec, -1
    v_mfma_f32_16x16x32_bf16 v[32:35], a[68:71], v[208:211], v[32:35]
    v_lshlrev_b32 v5, 16, v61
    v_and_b32 v95, s41, v61
    v_mfma_f32_16x16x32_bf16 v[32:35], a[84:87], v[212:215], v[32:35]
    v_add_f32 v54, v54, v5
    v_add_f32 v55, v55, v95
    v_mfma_f32_16x16x32_bf16 v[36:39], a[72:75], v[208:211], v[36:39]
    buffer_load_dwordx4 v[248:251], v93, s[4:7], s60 offen sc1
    v_mfma_f32_16x16x32_bf16 v[36:39], a[88:91], v[212:215], v[36:39]
    v_lshlrev_b32 v56, 16, v10
    v_and_b32 v57, s41, v10
    v_mfma_f32_16x16x32_bf16 v[40:43], a[76:79], v[208:211], v[40:43]
    v_lshlrev_b32 v5, 16, v62
    v_and_b32 v95, s41, v62
    v_mfma_f32_16x16x32_bf16 v[40:43], a[92:95], v[212:215], v[40:43]
    s_waitcnt vmcnt(7)
    v_add_f32 v56, v56, v5
    v_add_f32 v57, v57, v95
    v_mfma_f32_16x16x32_bf16 v[28:31], a[96:99], v[216:219], v[28:31]
    buffer_load_dwordx4 v[252:255], v93, s[4:7], s60 offen offset:1024 sc1
    v_mfma_f32_16x16x32_bf16 v[28:31], a[112:115], v[220:223], v[28:31]
    v_lshlrev_b32 v58, 16, v11
    v_and_b32 v59, s41, v11
    v_mfma_f32_16x16x32_bf16 v[32:35], a[100:103], v[216:219], v[32:35]
    v_lshlrev_b32 v5, 16, v63
    v_and_b32 v95, s41, v63
    v_mfma_f32_16x16x32_bf16 v[32:35], a[116:119], v[220:223], v[32:35]
    v_add_f32 v58, v58, v5
    v_add_f32 v59, v59, v95
    v_mfma_f32_16x16x32_bf16 v[36:39], a[104:107], v[216:219], v[36:39]
    buffer_load_dwordx4 v[192:195], v93, s[4:7], s61 offen sc1
    v_mfma_f32_16x16x32_bf16 v[36:39], a[120:123], v[220:223], v[36:39]
    v_lshlrev_b32 v84, 16, v12
    v_and_b32 v85, s41, v12
    v_mfma_f32_16x16x32_bf16 v[40:43], a[108:111], v[216:219], v[40:43]
    v_lshlrev_b32 v5, 16, v60
    v_and_b32 v95, s41, v60
    v_mfma_f32_16x16x32_bf16 v[40:43], a[124:127], v[220:223], v[40:43]
    s_waitcnt vmcnt(7)
    v_add_f32 v84, v84, v5
    v_add_f32 v85, v85, v95
    v_mfma_f32_16x16x32_bf16 v[28:31], a[128:131], v[224:227], v[28:31]
    buffer_load_dwordx4 v[196:199], v93, s[4:7], s61 offen offset:1024 sc1
    v_mfma_f32_16x16x32_bf16 v[28:31], a[144:147], v[228:231], v[28:31]
    v_lshlrev_b32 v86, 16, v13
    v_and_b32 v87, s41, v13
    s_waitcnt vmcnt(7)
    v_mfma_f32_16x16x32_bf16 v[28:31], a[160:163], v[232:235], v[28:31]
    v_lshlrev_b32 v5, 16, v61
    v_and_b32 v95, s41, v61
    v_mfma_f32_16x16x32_bf16 v[32:35], a[132:135], v[224:227], v[32:35]
    v_add_f32 v86, v86, v5
    v_add_f32 v87, v87, v95
    v_mfma_f32_16x16x32_bf16 v[32:35], a[148:151], v[228:231], v[32:35]
    buffer_load_dwordx4 v[200:203], v93, s[4:7], s62 offen sc1
    v_mfma_f32_16x16x32_bf16 v[32:35], a[164:167], v[232:235], v[32:35]
    v_lshlrev_b32 v88, 16, v14
    v_and_b32 v89, s41, v14
    v_mfma_f32_16x16x32_bf16 v[36:39], a[136:139], v[224:227], v[36:39]
    v_lshlrev_b32 v5, 16, v62
    v_and_b32 v95, s41, v62
    v_mfma_f32_16x16x32_bf16 v[36:39], a[152:155], v[228:231], v[36:39]
    v_add_f32 v88, v88, v5
    v_add_f32 v89, v89, v95
    v_mfma_f32_16x16x32_bf16 v[36:39], a[168:171], v[232:235], v[36:39]
    buffer_load_dwordx4 v[204:207], v93, s[4:7], s62 offen offset:1024 sc1
    v_mfma_f32_16x16x32_bf16 v[40:43], a[140:143], v[224:227], v[40:43]
    s_barrier
    buffer_load_dword v94, v3, s[4:7], 0 offen sc1
    v_mfma_f32_16x16x32_bf16 v[40:43], a[156:159], v[228:231], v[40:43]
    v_lshlrev_b32 v90, 16, v15
    v_and_b32 v91, s41, v15
    v_mfma_f32_16x16x32_bf16 v[40:43], a[172:175], v[232:235], v[40:43]
    s_waitcnt vmcnt(9)
    v_lshlrev_b32 v5, 16, v63
    v_and_b32 v95, s41, v63
    s_waitcnt lgkmcnt(0)
    v_mfma_f32_16x16x32_bf16 v[44:47], a[0:3], v[236:239], 0
    buffer_load_dwordx4 v[208:211], v93, s[4:7], s2 offen sc1
    v_mfma_f32_16x16x32_bf16 v[44:47], a[16:19], v[240:243], v[44:47]
    v_add_f32 v90, v90, v5
    v_add_f32 v91, v91, v95
    v_mfma_f32_16x16x32_bf16 v[48:51], a[4:7], v[236:239], 0
    v_mfma_f32_16x16x32_bf16 v[48:51], a[20:23], v[240:243], v[48:51]
    v_mfma_f32_16x16x32_bf16 v[52:55], a[8:11], v[236:239], v[52:55]
    buffer_load_dwordx4 v[212:215], v93, s[4:7], s39 offen sc1
    v_mfma_f32_16x16x32_bf16 v[52:55], a[24:27], v[240:243], v[52:55]
    v_mfma_f32_16x16x32_bf16 v[56:59], a[12:15], v[236:239], v[56:59]
    ds_write_b128 v136, v[28:31] offset:0
    v_mfma_f32_16x16x32_bf16 v[56:59], a[28:31], v[240:243], v[56:59]
    s_waitcnt vmcnt(8)
    v_mfma_f32_16x16x32_bf16 v[44:47], a[32:35], v[244:247], v[44:47]
    v_mfma_f32_16x16x32_bf16 v[44:47], a[48:51], v[248:251], v[44:47]
    v_mfma_f32_16x16x32_bf16 v[48:51], a[36:39], v[244:247], v[48:51]
    ds_write_b128 v136, v[32:35] offset:1024
    v_mfma_f32_16x16x32_bf16 v[48:51], a[52:55], v[248:251], v[48:51]
    v_mfma_f32_16x16x32_bf16 v[52:55], a[40:43], v[244:247], v[52:55]
    v_mfma_f32_16x16x32_bf16 v[52:55], a[56:59], v[248:251], v[52:55]
    s_add_u32 s82, s1, 9
    s_waitcnt vmcnt(2)
    v_subrev_u32 v94, s82, v94
    v_cmp_lt_u32 s[82:83], 6, v94
    v_mfma_f32_16x16x32_bf16 v[56:59], a[44:47], v[244:247], v[56:59]
    ds_write_b128 v137, v[36:39] offset:2048
    v_mfma_f32_16x16x32_bf16 v[56:59], a[60:63], v[248:251], v[56:59]
    s_nop 0
    s_cmp_lg_u64 s[82:83], 0
    s_cbranch_scc1 L31s
L31:
    v_mfma_f32_16x16x32_bf16 v[44:47], a[64:67], v[252:255], v[44:47]
    v_xor_b32 v7, 4096, v7
    ds_read_b128 v[216:219], v7 offset:22528
    v_mfma_f32_16x16x32_bf16 v[44:47], a[80:83], v[192:195], v[44:47]
    v_mfma_f32_16x16x32_bf16 v[48:51], a[68:71], v[252:255], v[48:51]
    ds_write_b128 v137, v[40:43] offset:3072
    v_mfma_f32_16x16x32_bf16 v[48:51], a[84:87], v[192:195], v[48:51]
    v_mfma_f32_16x16x32_bf16 v[52:55], a[72:75], v[252:255], v[52:55]
    buffer_load_dwordx4 v[220:223], v142, s[4:7], s59 offen sc1
    v_mfma_f32_16x16x32_bf16 v[52:55], a[88:91], v[192:195], v[52:55]
    v_mfma_f32_16x16x32_bf16 v[56:59], a[76:79], v[252:255], v[56:59]
    v_mfma_f32_16x16x32_bf16 v[56:59], a[92:95], v[192:195], v[56:59]
    v_mfma_f32_16x16x32_bf16 v[44:47], a[96:99], v[196:199], v[44:47]
    buffer_load_dwordx4 v[224:227], v142, s[4:7], s59 offen offset:1024 sc1
    v_mfma_f32_16x16x32_bf16 v[44:47], a[112:115], v[200:203], v[44:47]
    v_mfma_f32_16x16x32_bf16 v[48:51], a[100:103], v[196:199], v[48:51]
    v_mfma_f32_16x16x32_bf16 v[48:51], a[116:119], v[200:203], v[48:51]
    v_mfma_f32_16x16x32_bf16 v[52:55], a[104:107], v[196:199], v[52:55]
    buffer_load_dwordx4 v[228:231], v142, s[4:7], s60 offen sc1
    v_mfma_f32_16x16x32_bf16 v[52:55], a[120:123], v[200:203], v[52:55]
    v_mfma_f32_16x16x32_bf16 v[56:59], a[108:111], v[196:199], v[56:59]
    v_mfma_f32_16x16x32_bf16 v[56:59], a[124:127], v[200:203], v[56:59]
    s_waitcnt vmcnt(4)
    v_mfma_f32_16x16x32_bf16 v[44:47], a[128:131], v[204:207], v[44:47]
    buffer_load_dwordx4 v[232:235], v142, s[4:7], s60 offen offset:1024 sc1
    v_mfma_f32_16x16x32_bf16 v[44:47], a[144:147], v[208:211], v[44:47]
    s_waitcnt vmcnt(4)
    v_mfma_f32_16x16x32_bf16 v[44:47], a[160:163], v[212:215], v[44:47]
    v_mfma_f32_16x16x32_bf16 v[48:51], a[132:135], v[204:207], v[48:51]
    v_mfma_f32_16x16x32_bf16 v[48:51], a[148:151], v[208:211], v[48:51]
    buffer_load_dwordx4 v[236:239], v142, s[4:7], s61 offen sc1
    v_mfma_f32_16x16x32_bf16 v[48:51], a[164:167], v[212:215], v[48:51]
    v_mfma_f32_16x16x32_bf16 v[52:55], a[136:139], v[204:207], v[52:55]
    v_mfma_f32_16x16x32_bf16 v[52:55], a[152:155], v[208:211], v[52:55]
    v_mfma_f32_16x16x32_bf16 v[52:55], a[168:171], v[212:215], v[52:55]
    buffer_load_dwordx4 v[240:243], v142, s[4:7], s61 offen offset:1024 sc1
    v_mfma_f32_16x16x32_bf16 v[56:59], a[140:143], v[204:207], v[56:59]
    v_mfma_f32_16x16x32_bf16 v[56:59], a[156:159], v[208:211], v[56:59]
    v_mfma_f32_16x16x32_bf16 v[56:59], a[172:175], v[212:215], v[56:59]
    s_waitcnt vmcnt(5) lgkmcnt(1)
    v_mfma_f32_16x16x32_bf16 v[60:63], a[0:3], v[216:219], 0
    buffer_load_dwordx4 v[244:247], v142, s[4:7], s62 offen sc1
    v_mfma_f32_16x16x32_bf16 v[60:63], a[16:19], v[220:223], v[60:63]
    v_mfma_f32_16x16x32_bf16 v[64:67], a[4:7], v[216:219], 0
    v_mfma_f32_16x16x32_bf16 v[64:67], a[20:23], v[220:223], v[64:67]
    v_mfma_f32_16x16x32_bf16 v[68:71], a[8:11], v[216:219], 0
    buffer_load_dwordx4 v[248:251], v142, s[4:7], s62 offen offset:1024 sc1
    v_mfma_f32_16x16x32_bf16 v[68:71], a[24:27], v[220:223], v[68:71]
    ds_write_b128 v138, v[44:47] offset:4096
    v_mfma_f32_16x16x32_bf16 v[72:75], a[12:15], v[216:219], 0
    v_mfma_f32_16x16x32_bf16 v[72:75], a[28:31], v[220:223], v[72:75]
    s_waitcnt vmcnt(5)
    v_mfma_f32_16x16x32_bf16 v[60:63], a[32:35], v[224:227], v[60:63]
    buffer_load_dwordx4 v[252:255], v142, s[4:7], s2 offen sc1
    v_mfma_f32_16x16x32_bf16 v[60:63], a[48:51], v[228:231], v[60:63]
    ds_write_b128 v138, v[48:51] offset:5120
    v_mfma_f32_16x16x32_bf16 v[64:67], a[36:39], v[224:227], v[64:67]
    v_mfma_f32_16x16x32_bf16 v[64:67], a[52:55], v[228:231], v[64:67]
    v_mfma_f32_16x16x32_bf16 v[68:71], a[40:43], v[224:227], v[68:71]
    buffer_load_dwordx4 v[192:195], v142, s[4:7], s39 offen sc1
    v_mfma_f32_16x16x32_bf16 v[68:71], a[56:59], v[228:231], v[68:71]
    v_xor_b32 v7, 4096, v7
    ds_read_b128 v[196:199], v7 offset:22528
    v_mfma_f32_16x16x32_bf16 v[72:75], a[44:47], v[224:227], v[72:75]
    s_waitcnt lgkmcnt(1)
    s_barrier
    v_mfma_f32_16x16x32_bf16 v[72:75], a[60:63], v[228:231], v[72:75]
    s_waitcnt vmcnt(5)
    ds_read_b128 v[28:31], v139 offset:0
    ds_read_b128 v[32:35], v139 offset:1024
    v_mfma_f32_16x16x32_bf16 v[60:63], a[64:67], v[232:235], v[60:63]
    buffer_load_dwordx4 v[200:203], v143, s[4:7], s59 offen sc1
    v_mfma_f32_16x16x32_bf16 v[60:63], a[80:83], v[236:239], v[60:63]
    ds_read_b128 v[36:39], v139 offset:2048
    ds_read_b128 v[40:43], v139 offset:3072
    ds_read_b128 v[44:47], v139 offset:4096
    v_mfma_f32_16x16x32_bf16 v[64:67], a[68:71], v[232:235], v[64:67]
    ds_read_b128 v[48:51], v139 offset:5120
    v_mfma_f32_16x16x32_bf16 v[64:67], a[84:87], v[236:239], v[64:67]
    v_mfma_f32_16x16x32_bf16 v[68:71], a[72:75], v[232:235], v[68:71]
    buffer_load_dwordx4 v[204:207], v143, s[4:7], s59 offen offset:1024 sc1
    v_mfma_f32_16x16x32_bf16 v[68:71], a[88:91], v[236:239], v[68:71]
    v_mfma_f32_16x16x32_bf16 v[72:75], a[76:79], v[232:235], v[72:75]
    v_mfma_f32_16x16x32_bf16 v[72:75], a[92:95], v[236:239], v[72:75]
    s_waitcnt vmcnt(5) lgkmcnt(5)
    v_add_f32 v52, v52, v28
    v_add_f32 v53, v53, v29
    v_mfma_f32_16x16x32_bf16 v[60:63], a[96:99], v[240:243], v[60:63]
    buffer_load_dwordx4 v[208:211], v143, s[4:7], s60 offen sc1
    v_mfma_f32_16x16x32_bf16 v[60:63], a[112:115], v[244:247], v[60:63]
    v_add_f32 v54, v54, v30
    v_add_f32 v55, v55, v31
    v_mfma_f32_16x16x32_bf16 v[64:67], a[100:103], v[240:243], v[64:67]
    s_waitcnt lgkmcnt(4)
    v_add_f32 v56, v56, v32
    v_add_f32 v57, v57, v33
    v_mfma_f32_16x16x32_bf16 v[64:67], a[116:119], v[244:247], v[64:67]
    v_add_f32 v58, v58, v34
    v_add_f32 v59, v59, v35
    v_mfma_f32_16x16x32_bf16 v[68:71], a[104:107], v[240:243], v[68:71]
    buffer_load_dwordx4 v[212:215], v143, s[4:7], s60 offen offset:1024 sc1
    v_mfma_f32_16x16x32_bf16 v[68:71], a[120:123], v[244:247], v[68:71]
    s_waitcnt lgkmcnt(3)
    v_add_f32 v52, v52, v36
    v_add_f32 v53, v53, v37
    v_mfma_f32_16x16x32_bf16 v[72:75], a[108:111], v[240:243], v[72:75]
    v_add_f32 v54, v54, v38
    v_add_f32 v55, v55, v39
    v_mfma_f32_16x16x32_bf16 v[72:75], a[124:127], v[244:247], v[72:75]
    s_waitcnt vmcnt(5) lgkmcnt(2)
    v_add_f32 v56, v56, v40
    v_add_f32 v57, v57, v41
    v_mfma_f32_16x16x32_bf16 v[60:63], a[128:131], v[248:251], v[60:63]
    buffer_load_dwordx4 v[216:219], v143, s[4:7], s61 offen sc1
    v_mfma_f32_16x16x32_bf16 v[60:63], a[144:147], v[252:255], v[60:63]
    v_add_f32 v58, v58, v42
    v_add_f32 v59, v59, v43
    s_waitcnt vmcnt(5)
    v_mfma_f32_16x16x32_bf16 v[60:63], a[160:163], v[192:195], v[60:63]
    s_waitcnt lgkmcnt(1)
    v_add_f32 v52, v52, v44
    v_add_f32 v53, v53, v45
    v_mfma_f32_16x16x32_bf16 v[64:67], a[132:135], v[248:251], v[64:67]
    v_add_f32 v54, v54, v46
    v_add_f32 v55, v55, v47
    v_mfma_f32_16x16x32_bf16 v[64:67], a[148:151], v[252:255], v[64:67]
    buffer_load_dwordx4 v[220:223], v143, s[4:7], s61 offen offset:1024 sc1
    v_mfma_f32_16x16x32_bf16 v[64:67], a[164:167], v[192:195], v[64:67]
    s_waitcnt lgkmcnt(0)
    v_add_f32 v56, v56, v48
    v_add_f32 v57, v57, v49
    v_mfma_f32_16x16x32_bf16 v[68:71], a[136:139], v[248:251], v[68:71]
    v_add_f32 v58, v58, v50
    v_add_f32 v59, v59, v51
    v_mfma_f32_16x16x32_bf16 v[68:71], a[152:155], v[252:255], v[68:71]
    v_cvt_pk_bf16_f32 v28, v52, v53
    v_cvt_pk_bf16_f32 v29, v54, v55
    v_mfma_f32_16x16x32_bf16 v[68:71], a[168:171], v[192:195], v[68:71]
    buffer_load_dwordx4 v[224:227], v143, s[4:7], s62 offen sc1
    v_mfma_f32_16x16x32_bf16 v[72:75], a[140:143], v[248:251], v[72:75]
    v_cvt_pk_bf16_f32 v30, v56, v57
    v_cvt_pk_bf16_f32 v31, v58, v59
    v_mfma_f32_16x16x32_bf16 v[72:75], a[156:159], v[252:255], v[72:75]
    v_mfma_f32_16x16x32_bf16 v[72:75], a[172:175], v[192:195], v[72:75]
    s_waitcnt vmcnt(6)
    v_mfma_f32_16x16x32_bf16 v[76:79], a[0:3], v[196:199], 0
    buffer_load_dwordx4 v[228:231], v143, s[4:7], s62 offen offset:1024 sc1
    v_mfma_f32_16x16x32_bf16 v[76:79], a[16:19], v[200:203], v[76:79]
    v_mfma_f32_16x16x32_bf16 v[80:83], a[4:7], v[196:199], 0
    v_mfma_f32_16x16x32_bf16 v[80:83], a[20:23], v[200:203], v[80:83]
    buffer_load_dwordx4 v[232:235], v143, s[4:7], s2 offen sc1
    v_mfma_f32_16x16x32_bf16 v[84:87], a[8:11], v[196:199], v[84:87]
    ds_write_b128 v136, v[60:63] offset:32768
    v_mfma_f32_16x16x32_bf16 v[84:87], a[24:27], v[200:203], v[84:87]
    v_mfma_f32_16x16x32_bf16 v[88:91], a[12:15], v[196:199], v[88:91]
    buffer_load_dwordx4 v[236:239], v143, s[4:7], s39 offen sc1
    v_mfma_f32_16x16x32_bf16 v[88:91], a[28:31], v[200:203], v[88:91]
    s_waitcnt vmcnt(7)
    ds_write_b128 v136, v[64:67] offset:33792
    v_mfma_f32_16x16x32_bf16 v[76:79], a[32:35], v[204:207], v[76:79]
    v_mfma_f32_16x16x32_bf16 v[76:79], a[48:51], v[208:211], v[76:79]
    s_waitcnt vmcnt(6)
    v_mfma_f32_16x16x32_bf16 v[76:79], a[64:67], v[212:215], v[76:79]
    ds_write_b128 v137, v[68:71] offset:34816
    v_mfma_f32_16x16x32_bf16 v[80:83], a[36:39], v[204:207], v[80:83]
    v_mfma_f32_16x16x32_bf16 v[80:83], a[52:55], v[208:211], v[80:83]
    buffer_store_dwordx4 v[28:31], v140, s[12:15], 0 offen sc1
    v_mfma_f32_16x16x32_bf16 v[80:83], a[68:71], v[212:215], v[80:83]
    ds_write_b128 v137, v[72:75] offset:35840
    v_mfma_f32_16x16x32_bf16 v[84:87], a[40:43], v[204:207], v[84:87]
    v_mfma_f32_16x16x32_bf16 v[84:87], a[56:59], v[208:211], v[84:87]
    v_mfma_f32_16x16x32_bf16 v[84:87], a[72:75], v[212:215], v[84:87]
    v_mfma_f32_16x16x32_bf16 v[88:91], a[44:47], v[204:207], v[88:91]
    s_waitcnt lgkmcnt(0)
    s_barrier
    v_mfma_f32_16x16x32_bf16 v[88:91], a[60:63], v[208:211], v[88:91]
    ds_read_b128 v[60:63], v139 offset:32768
    ds_read_b128 v[64:67], v139 offset:33792
    ds_read_b128 v[68:71], v139 offset:34816
    v_mfma_f32_16x16x32_bf16 v[88:91], a[76:79], v[212:215], v[88:91]
    s_waitcnt vmcnt(5)
    ds_read_b128 v[72:75], v139 offset:35840
    v_mfma_f32_16x16x32_bf16 v[76:79], a[80:83], v[216:219], v[76:79]
    v_mfma_f32_16x16x32_bf16 v[76:79], a[96:99], v[220:223], v[76:79]
    v_mfma_f32_16x16x32_bf16 v[80:83], a[84:87], v[216:219], v[80:83]
    v_mfma_f32_16x16x32_bf16 v[80:83], a[100:103], v[220:223], v[80:83]
    s_waitcnt vmcnt(3)
    v_mfma_f32_16x16x32_bf16 v[76:79], a[112:115], v[224:227], v[76:79]
    v_mfma_f32_16x16x32_bf16 v[76:79], a[128:131], v[228:231], v[76:79]
    v_mfma_f32_16x16x32_bf16 v[80:83], a[116:119], v[224:227], v[80:83]
    s_waitcnt lgkmcnt(1)
    v_add_f32 v60, v60, v68
    v_add_f32 v61, v61, v69
    v_mfma_f32_16x16x32_bf16 v[80:83], a[132:135], v[228:231], v[80:83]
    s_waitcnt vmcnt(1)
    v_add_f32 v62, v62, v70
    v_add_f32 v63, v63, v71
    v_mfma_f32_16x16x32_bf16 v[76:79], a[144:147], v[232:235], v[76:79]
    s_waitcnt lgkmcnt(0)
    v_add_f32 v64, v64, v72
    v_add_f32 v65, v65, v73
    v_mfma_f32_16x16x32_bf16 v[76:79], a[160:163], v[236:239], v[76:79]
    v_add_f32 v66, v66, v74
    v_add_f32_e64 v67, v67, v75
    v_mfma_f32_16x16x32_bf16 v[80:83], a[148:151], v[232:235], v[80:83]
    v_mfma_f32_16x16x32_bf16 v[80:83], a[164:167], v[236:239], v[80:83]
    v_mfma_f32_16x16x32_bf16 v[84:87], a[88:91], v[216:219], v[84:87]
    v_mfma_f32_16x16x32_bf16 v[84:87], a[104:107], v[220:223], v[84:87]
    v_mfma_f32_16x16x32_bf16 v[84:87], a[120:123], v[224:227], v[84:87]
    s_nop 0
    ds_write_b128 v138, v[76:79] offset:36864
    v_mfma_f32_16x16x32_bf16 v[84:87], a[136:139], v[228:231], v[84:87]
    v_mfma_f32_16x16x32_bf16 v[84:87], a[152:155], v[232:235], v[84:87]
    s_nop 0
    ds_write_b128 v138, v[80:83] offset:37888
    v_mfma_f32_16x16x32_bf16 v[84:87], a[168:171], v[236:239], v[84:87]
    v_mfma_f32_16x16x32_bf16 v[88:91], a[92:95], v[216:219], v[88:91]
    v_mfma_f32_16x16x32_bf16 v[88:91], a[108:111], v[220:223], v[88:91]
    v_mfma_f32_16x16x32_bf16 v[88:91], a[124:127], v[224:227], v[88:91]
    s_waitcnt lgkmcnt(0)
    s_barrier
    ds_read_b128 v[76:79], v139 offset:36864
    ds_read_b128 v[80:83], v139 offset:37888
    v_mfma_f32_16x16x32_bf16 v[88:91], a[140:143], v[228:231], v[88:91]
    v_mfma_f32_16x16x32_bf16 v[88:91], a[156:159], v[232:235], v[88:91]
    v_mfma_f32_16x16x32_bf16 v[88:91], a[172:175], v[236:239], v[88:91]
    v_pk_add_f32 v[84:85], v[84:85], v[60:61]
    v_pk_add_f32 v[86:87], v[86:87], v[62:63]
    s_nop 5
    v_pk_add_f32 v[88:89], v[88:89], v[64:65]
    v_pk_add_f32 v[90:91], v[90:91], v[66:67]
    s_waitcnt lgkmcnt(1)
    v_pk_add_f32 v[84:85], v[84:85], v[76:77]
    v_pk_add_f32 v[86:87], v[86:87], v[78:79]
    s_waitcnt lgkmcnt(0)
    v_pk_add_f32 v[88:89], v[88:89], v[80:81]
    v_pk_add_f32 v[90:91], v[90:91], v[82:83]
    v_cvt_pk_bf16_f32 v84, v84, v85
    v_cvt_pk_bf16_f32 v85, v86, v87
    v_cvt_pk_bf16_f32 v86, v88, v89
    v_cvt_pk_bf16_f32 v87, v90, v91
    buffer_store_dwordx4 v[84:87], v140, s[12:15], s55 offen
M_done:
    s_endpgm
    s_waitcnt vmcnt(0) lgkmcnt(0)
L5s:
    buffer_load_dwordx4 v[240:243], v7, s[4:7], 0 offen sc1
    s_add_u32 s91, s91, 1
    s_cmp_lt_u32 s91, 524288
    s_waitcnt vmcnt(0)
    s_cbranch_scc1 L5c
    s_branch L5
L6s:
    buffer_load_dwordx4 v[140:143], v85, s[4:7], s19 offen sc1
    s_add_u32 s91, s91, 1
    s_cmp_lt_u32 s91, 524288
    s_waitcnt vmcnt(0)
    s_cbranch_scc1 L6c
    s_branch L6
L7s:
    buffer_load_dwordx4 v[28:31], v1, s[4:7], s17 offen sc1
    buffer_load_dwordx4 v[32:35], v1, s[4:7], s17 offen offset:1024 sc1
    s_add_u32 s91, s91, 1
    s_cmp_lt_u32 s91, 524288
    s_waitcnt vmcnt(0)
    s_cbranch_scc1 L7c
    s_branch L7
L8s:
    buffer_load_dwordx4 v[76:79], v1, s[4:7], s21 offen sc1
    s_add_u32 s91, s91, 1
    s_cmp_lt_u32 s91, 524288
    s_waitcnt vmcnt(0)
    s_cbranch_scc1 L8c
    s_branch L8
L9s:
    buffer_wbl2 sc1
    s_waitcnt vmcnt(0)
    buffer_store_dword v6, v3, s[4:7], 0 offen sc1
    s_branch L9
L10s:
    s_mov_b32 s91, 0
    s_add_u32 s83, s45, 0
    v_mov_b32 v6, s83
L10p:
    buffer_load_dword v5, v3, s[4:7], 0 offen sc1
    s_add_u32 s91, s91, 1
    s_cmp_gt_u32 s91, 524288
    s_cbranch_scc1 L10x
    s_waitcnt vmcnt(0)
    v_sub_u32 v5, v5, v6
    v_cmp_lt_u32 s[82:83], 15, v5
    s_nop 3
    s_cmp_lg_u64 s[82:83], 0
    s_cbranch_scc1 L10p
L10x:
    s_cmp_lg_u32 s46, 0
    s_cbranch_scc1 L10
    buffer_inv sc1
    s_waitcnt vmcnt(0)
    s_branch L10
L11s:
    buffer_wbl2 sc1
    s_waitcnt vmcnt(0)
    buffer_store_dword v6, v3, s[4:7], 0 offen sc1
    s_branch L11
L12s:
    s_mov_b32 s91, 0
    s_add_u32 s83, s45, 1
    s_nop 1
    v_mov_b32 v6, s83
L12p:
    buffer_load_dword v5, v3, s[4:7], 0 offen sc1
    s_add_u32 s91, s91, 1
    s_cmp_gt_u32 s91, 524288
    s_cbranch_scc1 L12x
    s_waitcnt vmcnt(0)
    v_sub_u32 v5, v5, v6
    v_cmp_lt_u32 s[82:83], 14, v5
    s_nop 3
    s_cmp_lg_u64 s[82:83], 0
    s_cbranch_scc1 L12p
L12x:
    s_cmp_lg_u32 s46, 0
    s_cbranch_scc1 L12
    buffer_inv sc1
    s_waitcnt vmcnt(0)
    s_branch L12
L13s:
    s_mov_b32 s91, 0
    s_add_u32 s83, s45, 2
    s_nop 1
    v_mov_b32 v6, s83
L13p:
    buffer_load_dword v94, v3, s[4:7], 0 offen sc1
    s_add_u32 s91, s91, 1
    s_cmp_gt_u32 s91, 524288
    s_cbranch_scc1 L13x
    s_waitcnt vmcnt(0)
    v_sub_u32 v94, v94, v6
    v_cmp_lt_u32 s[82:83], 13, v94
    s_nop 3
    s_cmp_lg_u64 s[82:83], 0
    s_cbranch_scc1 L13p
L13x:
    s_cmp_lg_u32 s46, 0
    s_cbranch_scc1 L13
    buffer_inv sc1
    s_waitcnt vmcnt(0)
    s_branch L13
L14s:
    buffer_wbl2 sc1
    s_waitcnt vmcnt(0)
    buffer_store_dword v6, v3, s[4:7], 0 offen sc1
    s_branch L14
L15s:
    buffer_wbl2 sc1
    s_waitcnt vmcnt(0)
    buffer_store_dword v6, v3, s[4:7], 0 offen sc1
    s_branch L15
L16s:
    s_mov_b32 s91, 0
    s_add_u32 s83, s45, 3
    s_nop 1
    v_mov_b32 v6, s83
L16p:
    buffer_load_dword v94, v3, s[4:7], 0 offen sc1
    s_add_u32 s91, s91, 1
    s_cmp_gt_u32 s91, 524288
    s_cbranch_scc1 L16x
    s_waitcnt vmcnt(0)
    v_sub_u32 v94, v94, v6
    v_cmp_lt_u32 s[82:83], 12, v94
    s_nop 3
    s_cmp_lg_u64 s[82:83], 0
    s_cbranch_scc1 L16p
L16x:
    s_cmp_lg_u32 s46, 0
    s_cbranch_scc1 L16
    buffer_inv sc1
    s_waitcnt vmcnt(0)
    s_branch L16
L17s:
    buffer_wbl2 sc1
    s_waitcnt vmcnt(0)
    buffer_store_dword v6, v3, s[4:7], 0 offen sc1
    s_branch L17
L18s:
    s_mov_b32 s91, 0
    s_add_u32 s83, s45, 4
    s_nop 1
    v_mov_b32 v6, s83
L18p:
    buffer_load_dword v94, v3, s[4:7], 0 offen sc1
    s_add_u32 s91, s91, 1
    s_cmp_gt_u32 s91, 524288
    s_cbranch_scc1 L18x
    s_waitcnt vmcnt(0)
    v_sub_u32 v94, v94, v6
    v_cmp_lt_u32 s[82:83], 11, v94
    s_nop 3
    s_cmp_lg_u64 s[82:83], 0
    s_cbranch_scc1 L18p
L18x:
    s_cmp_lg_u32 s46, 0
    s_cbranch_scc1 L18
    buffer_inv sc1
    s_waitcnt vmcnt(0)
    s_branch L18
L19s:
    buffer_wbl2 sc1
    s_waitcnt vmcnt(0)
    buffer_store_dword v6, v3, s[4:7], 0 offen sc1
    s_branch L19
L20s:
    s_mov_b32 s91, 0
    s_add_u32 s83, s45, 5
    s_nop 1
    v_mov_b32 v6, s83
L20p:
    buffer_load_dword v103, v3, s[4:7], 0 offen sc1
    s_add_u32 s91, s91, 1
    s_cmp_gt_u32 s91, 524288
    s_cbranch_scc1 L20x
    s_waitcnt vmcnt(0)
    v_sub_u32 v103, v103, v6
    v_cmp_lt_u32 s[82:83], 10, v103
    s_nop 3
    s_cmp_lg_u64 s[82:83], 0
    s_cbranch_scc1 L20p
L20x:
    s_cmp_lg_u32 s46, 0
    s_cbranch_scc1 L20
    buffer_inv sc1
    s_waitcnt vmcnt(0)
    s_branch L20
L21s:
    buffer_load_dwordx4 v[140:143], v85, s[4:7], s19 offen sc1
    s_add_u32 s91, s91, 1
    s_cmp_lt_u32 s91, 524288
    s_waitcnt vmcnt(0)
    s_cbranch_scc1 L21c
    s_branch L21
L22s:
    buffer_load_dwordx4 v[28:31], v1, s[4:7], s17 offen sc1
    buffer_load_dwordx4 v[32:35], v1, s[4:7], s17 offen offset:1024 sc1
    s_add_u32 s91, s91, 1
    s_cmp_lt_u32 s91, 524288
    s_waitcnt vmcnt(0)
    s_cbranch_scc1 L22c
    s_branch L22
L23s:
    buffer_load_dwordx4 v[76:79], v1, s[4:7], s21 offen sc1
    s_add_u32 s91, s91, 1
    s_cmp_lt_u32 s91, 524288
    s_waitcnt vmcnt(0)
    s_cbranch_scc1 L23c
    s_branch L23
L24s:
    buffer_wbl2 sc1
    s_waitcnt vmcnt(0)
    buffer_store_dword v6, v3, s[4:7], 0 offen sc1
    s_branch L24
L25s:
    s_mov_b32 s91, 0
    s_add_u32 s83, s45, 6
    s_nop 1
    v_mov_b32 v6, s83
L25p:
    buffer_load_dword v5, v3, s[4:7], 0 offen sc1
    s_add_u32 s91, s91, 1
    s_cmp_gt_u32 s91, 524288
    s_cbranch_scc1 L25x
    s_waitcnt vmcnt(0)
    v_sub_u32 v5, v5, v6
    v_cmp_lt_u32 s[82:83], 9, v5
    s_nop 3
    s_cmp_lg_u64 s[82:83], 0
    s_cbranch_scc1 L25p
L25x:
    s_cmp_lg_u32 s46, 0
    s_cbranch_scc1 L25
    buffer_inv sc1
    s_waitcnt vmcnt(0)
    s_branch L25
L26s:
    buffer_wbl2 sc1
    s_waitcnt vmcnt(0)
    buffer_store_dword v6, v3, s[4:7], 0 offen sc1
    s_branch L26
L27s:
    s_mov_b32 s91, 0
    s_add_u32 s83, s45, 7
    s_nop 1
    v_mov_b32 v6, s83
L27p:
    buffer_load_dword v5, v3, s[4:7], 0 offen sc1
    s_add_u32 s91, s91, 1
    s_cmp_gt_u32 s91, 524288
    s_cbranch_scc1 L27x
    s_waitcnt vmcnt(0)
    v_sub_u32 v5, v5, v6
    v_cmp_lt_u32 s[82:83], 8, v5
    s_nop 3
    s_cmp_lg_u64 s[82:83], 0
    s_cbranch_scc1 L27p
L27x:
    s_cmp_lg_u32 s46, 0
    s_cbranch_scc1 L27
    buffer_inv sc1
    s_waitcnt vmcnt(0)
    s_branch L27
L28s:
    buffer_wbl2 sc1
    s_waitcnt vmcnt(0)
    buffer_store_dword v6, v3, s[4:7], 0 offen sc1
    s_branch L28
L29s:
    s_mov_b32 s91, 0
    s_add_u32 s83, s45, 8
    s_nop 1
    v_mov_b32 v6, s83
L29p:
    buffer_load_dword v94, v3, s[4:7], 0 offen sc1
    s_add_u32 s91, s91, 1
    s_cmp_gt_u32 s91, 524288
    s_cbranch_scc1 L29x
    s_waitcnt vmcnt(0)
    v_sub_u32 v94, v94, v6
    v_cmp_lt_u32 s[82:83], 7, v94
    s_nop 3
    s_cmp_lg_u64 s[82:83], 0
    s_cbranch_scc1 L29p
L29x:
    s_cmp_lg_u32 s46, 0
    s_cbranch_scc1 L29
    buffer_inv sc1
    s_waitcnt vmcnt(0)
    s_branch L29
L30s:
    buffer_wbl2 sc1
    s_waitcnt vmcnt(0)
    buffer_store_dword v6, v3, s[4:7], 0 offen sc1
    s_branch L30
L31s:
    s_mov_b32 s91, 0
    s_add_u32 s83, s45, 9
    s_nop 1
    v_mov_b32 v6, s83
L31p:
    buffer_load_dword v94, v3, s[4:7], 0 offen sc1
    s_add_u32 s91, s91, 1
    s_cmp_gt_u32 s91, 524288
    s_cbranch_scc1 L31x
    s_waitcnt vmcnt(0)
    v_sub_u32 v94, v94, v6
    v_cmp_lt_u32 s[82:83], 6, v94
    s_nop 3
    s_cmp_lg_u64 s[82:83], 0
    s_cbranch_scc1 L31p
L31x:
    s_cmp_lg_u32 s46, 0
    s_cbranch_scc1 L31
    buffer_inv sc1
    s_waitcnt vmcnt(0)
    s_branch L31
.section .rodata,"a"
.p2align 6
.amdhsa_kernel interleave_layers__linear_kernel_hedgehog__mixer_channel_mlp__prompt_kernel
  .amdhsa_next_free_vgpr 512
  .amdhsa_next_free_sgpr 102
  .amdhsa_accum_offset 256
  .amdhsa_group_segment_fixed_size 0
  .amdhsa_kernarg_size 96
  .amdhsa_user_sgpr_count 2
  .amdhsa_user_sgpr_kernarg_segment_ptr 1
  .amdhsa_system_sgpr_workgroup_id_x 1
.end_amdhsa_kernel
```
